```python
import torch

def _softmax(x, axis=-1):
    return torch.softmax(x, dim=axis)
def _gelu(x):
    return torch.nn.functional.gelu(x, approximate="tanh")
def _silu(x):
    return torch.nn.functional.silu(x)
def _sigmoid(x):
    return torch.sigmoid(x)
def _layernorm(x, axis=-1, eps=1e-5):
    m = x.mean(dim=axis, keepdim=True)
    v = x.var(dim=axis, keepdim=True, unbiased=False)
    return (x - m) / torch.sqrt(v + eps)
def _scatter_add(tgt, idx, src, axis=0):
    return tgt.clone().index_add_(axis, idx, src)
def _segment_sum(src, seg, n):
    out = torch.zeros((n,) + src.shape[1:], dtype=src.dtype)
    return out.index_add_(0, seg, src)
def _pad(x, pw):
    flat = tuple(v for pair in reversed(pw) for v in pair)
    return torch.nn.functional.pad(x, flat)

kernel_name = 'gated_mix__gqa_block_cached__gqa_block_cached__decode'

def setup_inputs():

    _w = (lambda a: (lambda t: t.to(torch.bfloat16) if t.is_floating_point() else t)(torch.as_tensor(a)))
    def _A_setup():
        B, Sq, D = 2, 1, 512
        Hq, Hkv, Sk, Dh = 32, 8, 32768, 128
        assert Hq % Hkv == 0, (Hq, Hkv)
        return {
            "x": _w((lambda *s: torch.randn(*s, dtype=torch.bfloat16) * 0.05)(B, Sq, D)),
            "k_cache": _w((lambda *s: torch.randn(*s, dtype=torch.bfloat16) * 6.4)(B, Hkv, Sk, Dh)),
            "v_cache": _w((lambda *s: torch.randn(*s, dtype=torch.bfloat16) * 0.05)(B, Hkv, Sk, Dh)),
            "wq": _w((lambda *s: torch.randn(*s, dtype=torch.bfloat16) * 6.4)(D, Hq * Dh) * (D ** -0.5)),
            "wo": _w((lambda *s: torch.randn(*s, dtype=torch.bfloat16) * 0.05)(Hq * Dh, D) * ((Hq * Dh) ** -0.5)),
        }
    _A_in = _A_setup()

    def _B_setup():
        B, Sq, D = 2, 1, 512
        Hq, Hkv, Sk, Dh = 32, 8, 32768, 128
        assert Hq % Hkv == 0, (Hq, Hkv)
        return {
            "x": _w((lambda *s: torch.randn(*s, dtype=torch.bfloat16) * 0.05)(B, Sq, D)),
            "k_cache": _w((lambda *s: torch.randn(*s, dtype=torch.bfloat16) * 6.4)(B, Hkv, Sk, Dh)),
            "v_cache": _w((lambda *s: torch.randn(*s, dtype=torch.bfloat16) * 0.05)(B, Hkv, Sk, Dh)),
            "wq": _w((lambda *s: torch.randn(*s, dtype=torch.bfloat16) * 6.4)(D, Hq * Dh) * (D ** -0.5)),
            "wo": _w((lambda *s: torch.randn(*s, dtype=torch.bfloat16) * 0.05)(Hq * Dh, D) * ((Hq * Dh) ** -0.5)),
        }
    _B_in = _B_setup()

    return {
        "A_x": _A_in["x"],
        "A_k_cache": _A_in["k_cache"],
        "A_v_cache": _A_in["v_cache"],
        "A_wq": _A_in["wq"],
        "A_wo": _A_in["wo"],
        "B_x": _B_in["x"],
        "B_k_cache": _B_in["k_cache"],
        "B_v_cache": _B_in["v_cache"],
        "B_wq": _B_in["wq"],
        "B_wo": _B_in["wo"],
        "gate_w": _w((lambda *s: torch.randn(*s, dtype=torch.bfloat16) * 0.1)(512) * 16.0),
    }

def reference(A_x, A_k_cache, A_v_cache, A_wq, A_wo, B_x, B_k_cache, B_v_cache, B_wq, B_wo, gate_w):
    def _A_ref(x, k_cache, v_cache, wq, wo):
        B, Sq, D = x.shape
        Hq, Dh = 32, 128
        Hkv = k_cache.shape[1]
        rep = Hq // Hkv
        q = (lambda x, *d: x.permute(*d))((x @ wq).reshape(B, Sq, Hq, Dh), 0, 2, 1, 3)
        k = (lambda x, n, axis: torch.repeat_interleave(x, n, dim=axis))(k_cache, rep, axis=1)
        v = (lambda x, n, axis: torch.repeat_interleave(x, n, dim=axis))(v_cache, rep, axis=1)
        scores = torch.einsum("bhqd,bhkd->bhqk", q, k) * (Dh ** -0.5)
        p = _softmax(scores, axis=-1)
        o = torch.einsum("bhqk,bhkd->bhqd", p, v)
        return (lambda x, *d: x.permute(*d))(o, 0, 2, 1, 3).reshape(B, Sq, Hq * Dh) @ wo

    def _B_ref(x, k_cache, v_cache, wq, wo):
        B, Sq, D = x.shape
        Hq, Dh = 32, 128
        Hkv = k_cache.shape[1]
        rep = Hq // Hkv
        q = (lambda x, *d: x.permute(*d))((x @ wq).reshape(B, Sq, Hq, Dh), 0, 2, 1, 3)
        k = (lambda x, n, axis: torch.repeat_interleave(x, n, dim=axis))(k_cache, rep, axis=1)
        v = (lambda x, n, axis: torch.repeat_interleave(x, n, dim=axis))(v_cache, rep, axis=1)
        scores = torch.einsum("bhqd,bhkd->bhqk", q, k) * (Dh ** -0.5)
        p = _softmax(scores, axis=-1)
        o = torch.einsum("bhqk,bhkd->bhqd", p, v)
        return (lambda x, *d: x.permute(*d))(o, 0, 2, 1, 3).reshape(B, Sq, Hq * Dh) @ wo

    x = A_x
    g = _sigmoid((x * gate_w).sum(-1, keepdims=True))
    a = _A_ref(x, A_k_cache, A_v_cache, A_wq, A_wo)
    b = _B_ref(x, B_k_cache, B_v_cache, B_wq, B_wo)
    return g * a + (1 - g) * b
```

```asm
; @launch grid=(256,1,1) block=(256,1,1) lds=163840
.amdgcn_target "amdgcn-amd-amdhsa--gfx950"
.text
.globl gated_mix__gqa_block_cached__gqa_block_cached__decode_kernel
.p2align 8
.type gated_mix__gqa_block_cached__gqa_block_cached__decode_kernel,@function
gated_mix__gqa_block_cached__gqa_block_cached__decode_kernel:
  s_cmp_ge_u32 s2, 256
  s_cbranch_scc0 L_go
  s_endpgm
L_go:
  s_lshr_b32 s61, s2, 7
  s_mul_i32 s3, s61, 40
  s_add_u32 s16, s0, s3
  s_addc_u32 s17, s1, 0
  s_load_dwordx2 s[14:15], s[16:17], 24
  s_load_dwordx4 s[4:7], s[0:1], 8
  s_load_dwordx2 s[12:13], s[0:1], 0
  s_load_dwordx2 s[18:19], s[0:1], 104
  s_load_dwordx4 s[8:11], s[0:1], 48
  s_load_dwordx4 s[96:99], s[0:1], 80
  s_getpc_b64 s[82:83]
  v_lshlrev_b32 v138, 7, v0
  v_cmp_gt_u32 vcc, 24, v0
  s_mov_b64 exec, vcc
  s_cbranch_execz L_nocp0
  global_load_dword v139, v138, s[82:83] offset:128
L_nocp0:
  s_mov_b64 exec, -1
  v_lshrrev_b32 v132, 6, v0
  v_and_b32 v1, 63, v0
  v_readfirstlane_b32 s60, v132
  v_lshrrev_b32 v134, 2, v1
  v_lshlrev_b32 v134, 13, v134
  v_and_b32 v132, 3, v1
  v_lshl_add_u32 v134, v132, 4, v134
  s_and_b32 s73, s2, 0x70
  s_and_b32 s74, s2, 7
  s_lshl1_add_u32 s73, s74, s73
  s_bfe_u32 s74, s2, 0x10003
  s_add_u32 s73, s73, s74
  s_lshl_b32 s80, s73, 5
  s_lshl_b32 s75, s60, 1
  s_lshl_b32 s73, s75, 19
  s_lshl1_add_u32 s77, s80, s73
  s_lshl_b32 s67, s60, 13
  s_add_u32 s67, s67, 114688
  s_mov_b32 s38, 0x400000
  s_mov_b32 s39, 0x20000
  s_waitcnt lgkmcnt(0)
  s_mov_b32 s36, s14
  s_and_b32 s37, s15, 0xffff
  s_add_u32 m0, s67, 0
  s_nop 0
  buffer_load_dwordx4 v134, s[36:39], s77 offen nt lds
  s_add_u32 s77, s77, 0x20000
  s_add_u32 m0, s67, 1024
  s_nop 0
  buffer_load_dwordx4 v134, s[36:39], s77 offen nt lds
  s_add_u32 s77, s77, 0x20000
  s_add_u32 m0, s67, 2048
  s_nop 0
  buffer_load_dwordx4 v134, s[36:39], s77 offen nt lds
  s_add_u32 s77, s77, 0x20000
  s_add_u32 m0, s67, 3072
  s_nop 0
  buffer_load_dwordx4 v134, s[36:39], s77 offen nt lds
  s_add_u32 s77, s77, 0x20000
  s_add_u32 m0, s67, 4096
  s_nop 0
  buffer_load_dwordx4 v134, s[36:39], s77 offen nt lds
  s_add_u32 s77, s77, 0x20000
  s_add_u32 m0, s67, 5120
  s_nop 0
  buffer_load_dwordx4 v134, s[36:39], s77 offen nt lds
  s_add_u32 s77, s77, 0x20000
  s_add_u32 m0, s67, 6144
  s_nop 0
  buffer_load_dwordx4 v134, s[36:39], s77 offen nt lds
  s_add_u32 s77, s77, 0x20000
  s_add_u32 m0, s67, 7168
  s_nop 0
  buffer_load_dwordx4 v134, s[36:39], s77 offen nt lds
  s_load_dword s68, s[18:19], 0
  s_mov_b32 s20, s4
  s_and_b32 s21, s5, 0xffff
  s_mov_b32 s22, 0x8000000
  s_mov_b32 s23, 0x20000
  s_mul_i32 s66, s60, 28672
  s_lshr_b32 s64, s2, 4
  s_lshl_b32 s64, s64, 23
  s_bfe_u32 s73, s2, 0x20000
  s_lshl_b32 s73, s73, 15
  s_xor_b32 s64, s64, s73
  s_bfe_u32 s73, s2, 0x10002
  s_lshl_b32 s73, s73, 21
  s_xor_b32 s64, s64, s73
  s_bfe_u32 s73, s2, 0x10003
  s_lshl_b32 s73, s73, 20
  s_xor_b32 s64, s64, s73
  s_bfe_u32 s73, s60, 0x20000
  s_lshl_b32 s73, s73, 12
  s_xor_b32 s64, s64, s73
  v_lshrrev_b32 v2, 4, v1
  v_lshlrev_b32 v135, 1, v2
  v_xor_b32 v135, v135, v1
  v_lshlrev_b32 v10, 4, v135
  v_xor_b32 v11, 0x80, v10
  s_mov_b32 s48, s12
  s_and_b32 s49, s13, 0xffff
  s_mov_b32 s50, 0x800
  s_mov_b32 s51, 0x20000
  v_and_b32 v133, 1, v1
  v_lshlrev_b32 v133, 10, v133
  v_lshl_add_u32 v133, v2, 4, v133
  s_lshl_b32 s75, s75, 7
  buffer_load_dwordx4 v[84:87], v133, s[48:51], s75 offen offset:0
  buffer_load_dwordx4 v[88:91], v133, s[48:51], s75 offen offset:64
  buffer_load_dwordx4 v[92:95], v133, s[48:51], s75 offen offset:128
  buffer_load_dwordx4 v[96:99], v133, s[48:51], s75 offen offset:192
  s_lshr_b32 s73, s60, 1
  s_mul_i32 s73, s73, 40
  s_add_u32 s82, s0, s73
  s_addc_u32 s83, s1, 0
  s_load_dwordx2 s[16:17], s[82:83], 32
  v_and_b32 v3, 15, v1
  v_and_b32 v4, 3, v1
  v_bfe_u32 v5, v1, 2, 2
  s_mov_b32 s52, s96
  s_and_b32 s53, s97, 0xffff
  s_mov_b32 s54, 0x400
  s_mov_b32 s55, 0x20000
  s_mov_b32 s24, s6
  s_and_b32 s25, s7, 0xffff
  s_mov_b32 s26, 0x8000000
  s_mov_b32 s27, 0x20000
  s_mov_b32 s28, s8
  s_and_b32 s29, s9, 0xffff
  s_mov_b32 s30, 0x8000000
  s_mov_b32 s31, 0x20000
  s_mov_b32 s32, s10
  s_and_b32 s33, s11, 0xffff
  s_mov_b32 s34, 0x8000000
  s_mov_b32 s35, 0x20000
  s_mov_b32 s44, s18
  s_and_b32 s45, s19, 0xffff
  s_mov_b32 s46, 0x400000
  s_mov_b32 s47, 0x20000
  s_mov_b32 s56, s98
  s_and_b32 s57, s99, 0xffff
  s_mov_b32 s58, 0x800
  s_mov_b32 s59, 0x20000
  s_bfe_u32 s62, s2, 0x30004
  s_and_b32 s63, s2, 15
  s_lshl4_add_u32 s63, s61, s63
  v_mov_b32 v34, 161024
  v_lshl_add_u32 v132, v3, 2, v34
  v_mov_b32 v133, 0
  ds_write_b32 v132, v133
  v_lshl_add_u32 v135, v3, 8, s66
  v_and_b32 v136, 7, v3
  v_lshlrev_b32 v136, 1, v136
  v_xor_b32 v136, v136, v2
  v_xor_b32 v12, 0, v136
  v_lshl_add_u32 v12, v12, 4, v135
  v_xor_b32 v13, 4, v136
  v_lshl_add_u32 v13, v13, 4, v135
  v_xor_b32 v14, 8, v136
  v_lshl_add_u32 v14, v14, 4, v135
  v_xor_b32 v15, 12, v136
  v_lshl_add_u32 v15, v15, 4, v135
  v_lshl_add_u32 v132, v2, 3, v5
  v_lshl_add_u32 v132, v132, 6, s67
  v_lshl_add_u32 v132, v4, 3, v132
  s_lshl_b32 s73, s60, 9
  s_add_u32 s73, s73, 147456
  v_and_b32 v133, 1, v1
  v_lshl_add_u32 v133, v133, 7, s73
  v_lshl_add_u32 v133, v2, 4, v133
  v_and_b32 v135, 31, v1
  v_lshlrev_b32 v135, 4, v135
  v_add_u32 v135, 147456, v135
  v_bfe_u32 v136, v1, 3, 1
  v_lshlrev_b32 v136, 14, v136
  v_and_b32 v137, 7, v1
  v_lshl_add_u32 v136, v137, 4, v136
  s_lshl_b32 s73, s61, 13
  s_add_u32 s73, s73, s80
  s_lshl_b32 s73, s73, 2
  s_add_u32 s73, s73, 4096
  s_movk_i32 s74, 0xff00
  s_xor_b32 s65, s64, 0x0
  s_add_u32 m0, s66, 0
  s_waitcnt vmcnt(11)
  buffer_load_dwordx4 v10, s[20:23], s65 offen offset:0 nt lds
  s_waitcnt vmcnt(11)
  buffer_load_dwordx4 v11, s[20:23], s65 offen offset:1024 nt lds
  s_waitcnt vmcnt(11)
  buffer_load_dwordx4 v10, s[20:23], s65 offen offset:2048 nt lds
  s_waitcnt vmcnt(11)
  buffer_load_dwordx4 v11, s[20:23], s65 offen offset:3072 nt lds
  s_xor_b32 s65, s64, 0x4000
  s_add_u32 m0, s66, 4096
  s_waitcnt vmcnt(11)
  buffer_load_dwordx4 v10, s[20:23], s65 offen offset:0 nt lds
  s_waitcnt vmcnt(11)
  buffer_load_dwordx4 v11, s[20:23], s65 offen offset:1024 nt lds
  s_waitcnt vmcnt(11)
  buffer_load_dwordx4 v10, s[20:23], s65 offen offset:2048 nt lds
  s_waitcnt vmcnt(11)
  buffer_load_dwordx4 v11, s[20:23], s65 offen offset:3072 nt lds
  s_xor_b32 s65, s64, 0x400000
  s_add_u32 m0, s66, 8192
  s_nop 0
  buffer_load_dwordx4 v10, s[20:23], s65 offen offset:0 nt lds
  buffer_load_dwordx4 v11, s[20:23], s65 offen offset:1024 nt lds
  s_waitcnt lgkmcnt(0)
  s_waitcnt vmcnt(10)
  ds_read_b64_tr_b16 a[32:33], v132 offset:0
  ds_read_b64_tr_b16 a[34:35], v132 offset:256
  ds_read_b64_tr_b16 a[36:37], v132 offset:32
  ds_read_b64_tr_b16 a[38:39], v132 offset:288
  ds_read_b64_tr_b16 a[40:41], v132 offset:2048
  ds_read_b64_tr_b16 a[42:43], v132 offset:2304
  ds_read_b64_tr_b16 a[44:45], v132 offset:2080
  ds_read_b64_tr_b16 a[46:47], v132 offset:2336
  ds_read_b64_tr_b16 a[48:49], v132 offset:4096
  ds_read_b64_tr_b16 a[50:51], v132 offset:4352
  ds_read_b64_tr_b16 a[52:53], v132 offset:4128
  ds_read_b64_tr_b16 a[54:55], v132 offset:4384
  ds_read_b64_tr_b16 a[56:57], v132 offset:6144
  ds_read_b64_tr_b16 a[58:59], v132 offset:6400
  ds_read_b64_tr_b16 a[60:61], v132 offset:6176
  ds_read_b64_tr_b16 a[62:63], v132 offset:6432
  s_mov_b32 s40, s16
  s_and_b32 s41, s17, 0xffff
  s_mov_b32 s42, 0x400000
  s_mov_b32 s43, 0x20000
  s_add_u32 s68, s68, 0x9e3779b1
  s_and_b32 s69, s68, 0xff
  s_and_b32 s70, s68, 0xfff
  s_and_b32 s81, s68, 0xffff
  v_mov_b32 v137, s69
  s_waitcnt lgkmcnt(12)
  v_mfma_f32_16x16x32_bf16 v[140:143], a[32:35], v[84:87], 0
  v_mfma_f32_16x16x32_bf16 v[144:147], a[36:39], v[84:87], 0
  s_waitcnt lgkmcnt(8)
  v_mfma_f32_16x16x32_bf16 v[140:143], a[40:43], v[88:91], v[140:143]
  v_mfma_f32_16x16x32_bf16 v[144:147], a[44:47], v[88:91], v[144:147]
  s_waitcnt lgkmcnt(4)
  v_mfma_f32_16x16x32_bf16 v[140:143], a[48:51], v[92:95], v[140:143]
  v_mfma_f32_16x16x32_bf16 v[144:147], a[52:55], v[92:95], v[144:147]
  s_waitcnt lgkmcnt(0)
  v_mfma_f32_16x16x32_bf16 v[140:143], a[56:59], v[96:99], v[140:143]
  v_mfma_f32_16x16x32_bf16 v[144:147], a[60:63], v[96:99], v[144:147]
  s_nop 6
  ds_write_b128 v133, v[140:143] offset:0
  ds_write_b128 v133, v[144:147] offset:64
  s_cmp_eq_u32 s60, 0
  s_waitcnt lgkmcnt(0)
  s_barrier
  s_cbranch_scc0 L_noqstore
  ds_read_b128 v[140:143], v135 offset:0
  ds_read_b128 v[144:147], v135 offset:512
  ds_read_b128 v[148:151], v135 offset:1024
  ds_read_b128 v[152:155], v135 offset:1536
  s_waitcnt lgkmcnt(0)
  v_add_f32 v140, v140, v144
  v_add_f32 v148, v148, v152
  v_add_f32 v141, v141, v145
  v_add_f32 v149, v149, v153
  v_add_f32 v142, v142, v146
  v_add_f32 v150, v150, v154
  v_add_f32 v143, v143, v147
  v_add_f32 v151, v151, v155
  v_add_f32 v140, v140, v148
  v_add_f32 v141, v141, v149
  v_add_f32 v142, v142, v150
  v_add_f32 v143, v143, v151
  v_cvt_pk_bf16_f32 v140, 0, v140
  v_cvt_pk_bf16_f32 v141, 0, v141
  v_cvt_pk_bf16_f32 v142, 0, v142
  v_cvt_pk_bf16_f32 v143, 0, v143
  v_or_b32 v140, s81, v140
  v_or_b32 v141, s81, v141
  v_or_b32 v142, s81, v142
  v_or_b32 v143, s81, v143
  s_mov_b64 exec, 0xffff
  buffer_store_dwordx4 v[140:143], v136, s[44:47], s73 offen sc1
  s_mov_b64 exec, -1
L_noqstore:
  s_waitcnt vmcnt(4)
  buffer_load_dwordx4 v10, s[20:23], s65 offen offset:2048 nt lds
  ds_read_b128 a[132:135], v12 offset:0
  ds_read_b128 a[136:139], v13 offset:0
  ds_read_b128 a[140:143], v14 offset:0
  ds_read_b128 a[144:147], v15 offset:0
  s_waitcnt vmcnt(4)
  buffer_load_dwordx4 v11, s[20:23], s65 offen offset:3072 nt lds
  s_waitcnt lgkmcnt(0)
  v_and_b32 v132, 31, v1
  v_lshlrev_b32 v132, 5, v132
  s_lshl_b32 s73, s61, 10
  buffer_load_dwordx4 v[68:71], v132, s[48:51], s73 offen offset:0
  buffer_load_dwordx4 v[72:75], v132, s[48:51], s73 offen offset:16
  buffer_load_dwordx4 v[76:79], v132, s[52:55], 0 offen offset:0
  buffer_load_dwordx4 v[80:83], v132, s[52:55], 0 offen offset:16
  s_xor_b32 s65, s64, 0x404000
  s_add_u32 m0, s66, 12288
  s_waitcnt vmcnt(8)
  buffer_load_dwordx4 v10, s[20:23], s65 offen offset:0 nt lds
  s_getpc_b64 s[82:83]
L_cp:
  s_lshr_b32 s18, s2, 3
  s_lshl2_add_u32 s18, s18, s60
  s_lshl_b32 s18, s18, 9
  v_lshl_add_u32 v181, v4, 7, s18
  v_min_u32 v181, L_end-L_cp, v181
  s_mov_b64 exec, 15
  global_load_dword v180, v181, s[82:83]
  s_mov_b64 exec, -1
  s_mov_b32 s71, 0x3fb8aa3b
  s_mov_b32 s72, 0x3db504f3
  s_mov_b32 s79, 2097152
  v_mov_b32 v56, 0x3f803f80
  v_mov_b32 v57, 0x3f803f80
  v_mov_b32 v58, 0x3f803f80
  v_mov_b32 v59, 0x3f803f80
  v_lshrrev_b32 v132, 5, v1
  v_and_b32 v133, 31, v1
  v_lshlrev_b32 v134, 4, v133
  v_lshl_add_u32 v30, v132, 15, v134
  s_lshr_b32 s73, s2, 4
  s_lshl2_add_u32 s73, s73, s60
  s_lshl_b32 s73, s73, 9
  s_add_u32 s3, s73, 4096
  s_lshl_b32 s73, s60, 8
  s_waitcnt vmcnt(9)
  buffer_load_dwordx4 v11, s[20:23], s65 offen offset:1024 nt lds
  s_add_u32 s73, s73, 149504
  v_lshl_add_u32 v31, v133, 3, s73
  v_lshl_add_u32 v31, v132, 10, v31
  v_lshlrev_b32 v32, 8, v4
  v_lshl_add_u32 v32, v2, 4, v32
  v_add_u32 v32, 149504, v32
  s_lshl_b32 s73, s60, 2
  v_add_u32 v33, s73, v34
  s_mov_b32 s14, 0
  s_and_b32 s17, s68, 0xffffff00
  v_mov_b32 v9, s17
  v_min_u32 v6, 1, v1
  v_lshlrev_b32 v6, 30, v6
  s_and_b32 s73, s2, 7
  s_mul_i32 s73, s73, 4352
  s_add_u32 s73, s73, 524288
  s_waitcnt vmcnt(9)
  buffer_load_dwordx4 v10, s[20:23], s65 offen offset:2048 nt lds
  v_lshl_add_u32 v7, v1, 2, s73
  s_add_u32 s39, s73, 128
  s_mov_b32 s36, 0
  s_mov_b32 s37, 0
  s_lshr_b32 s74, s2, 3
  s_lshl_b32 s75, s60, 5
  s_add_u32 s74, s74, s75
  s_xor_b32 s74, s74, 36
  s_min_u32 s74, s74, 1
  s_lshl_b32 s74, s74, 30
  s_add_u32 s74, s74, 589824
  v_lshrrev_b32 v135, 3, v1
  v_min_u32 v135, 1, v135
  v_lshlrev_b32 v135, 30, v135
  v_mul_u32_u24 v136, 4224, v1
  v_add3_u32 v182, v135, v136, s74
  s_waitcnt vmcnt(9)
  buffer_load_dwordx4 v11, s[20:23], s65 offen offset:3072 nt lds
  s_and_b32 s75, s2, 7
  s_mul_i32 s75, s75, 4224
  s_add_u32 s38, s74, s75
  s_lshr_b32 s74, s2, 3
  s_lshl2_add_u32 s16, s74, s73
  s_and_b32 s74, s74, 3
  s_lshl4_add_u32 s15, s60, s74
  s_xor_b32 s65, s64, 0x20000
  s_add_u32 m0, s66, 16384
  s_waitcnt vmcnt(9)
  buffer_load_dwordx4 v10, s[20:23], s65 offen offset:0 nt lds
  s_waitcnt vmcnt(5)
  buffer_load_dwordx4 v11, s[20:23], s65 offen offset:1024 nt lds
  ds_read_b128 a[148:151], v12 offset:4096
  ds_read_b128 a[152:155], v13 offset:4096
  ds_read_b128 a[156:159], v14 offset:4096
  ds_read_b128 a[160:163], v15 offset:4096
  s_waitcnt vmcnt(4)
  buffer_load_dwordx4 v10, s[20:23], s65 offen offset:2048 nt lds
  s_waitcnt lgkmcnt(0)
  ds_read_b128 a[164:167], v12 offset:8192
  ds_read_b128 a[168:171], v13 offset:8192
  ds_read_b128 a[172:175], v14 offset:8192
  ds_read_b128 a[176:179], v15 offset:8192
  s_waitcnt vmcnt(4)
  buffer_load_dwordx4 v11, s[20:23], s65 offen offset:3072 nt lds
  s_waitcnt lgkmcnt(0)
  v_lshlrev_b32 v132, 16, v68
  v_lshlrev_b32 v133, 16, v76
  v_and_b32 v68, 0xffff0000, v68
  v_and_b32 v76, 0xffff0000, v76
  v_mul_f32 v132, v132, v133
  v_mul_f32 v68, v68, v76
  v_cvt_pk_bf16_f32 v68, v132, v68
  v_lshlrev_b32 v132, 16, v69
  v_lshlrev_b32 v133, 16, v77
  v_and_b32 v69, 0xffff0000, v69
  v_and_b32 v77, 0xffff0000, v77
  v_mul_f32 v132, v132, v133
  v_mul_f32 v69, v69, v77
  v_cvt_pk_bf16_f32 v69, v132, v69
  v_lshlrev_b32 v132, 16, v70
  v_lshlrev_b32 v133, 16, v78
  s_xor_b32 s65, s64, 0x24000
  s_add_u32 m0, s66, 20480
  s_waitcnt vmcnt(4)
  buffer_load_dwordx4 v10, s[20:23], s65 offen offset:0 nt lds
  ds_read_b128 a[180:183], v12 offset:12288
  ds_read_b128 a[184:187], v13 offset:12288
  ds_read_b128 a[188:191], v14 offset:12288
  ds_read_b128 a[192:195], v15 offset:12288
  s_waitcnt vmcnt(4)
  buffer_load_dwordx4 v11, s[20:23], s65 offen offset:1024 nt lds
  s_waitcnt lgkmcnt(0)
  v_and_b32 v70, 0xffff0000, v70
  v_and_b32 v78, 0xffff0000, v78
  v_mul_f32 v132, v132, v133
  v_mul_f32 v70, v70, v78
  v_cvt_pk_bf16_f32 v70, v132, v70
  v_lshlrev_b32 v132, 16, v71
  v_lshlrev_b32 v133, 16, v79
  v_and_b32 v71, 0xffff0000, v71
  v_and_b32 v79, 0xffff0000, v79
  v_mul_f32 v132, v132, v133
  v_mul_f32 v71, v71, v79
  v_cvt_pk_bf16_f32 v71, v132, v71
  v_lshlrev_b32 v132, 16, v72
  v_lshlrev_b32 v133, 16, v80
  v_and_b32 v72, 0xffff0000, v72
  v_and_b32 v80, 0xffff0000, v80
  s_waitcnt vmcnt(4)
  buffer_load_dwordx4 v10, s[20:23], s65 offen offset:2048 nt lds
  v_mul_f32 v132, v132, v133
  v_mul_f32 v72, v72, v80
  v_cvt_pk_bf16_f32 v72, v132, v72
  v_lshlrev_b32 v132, 16, v73
  v_lshlrev_b32 v133, 16, v81
  v_and_b32 v73, 0xffff0000, v73
  v_and_b32 v81, 0xffff0000, v81
  v_mul_f32 v132, v132, v133
  v_mul_f32 v73, v73, v81
  v_cvt_pk_bf16_f32 v73, v132, v73
  v_lshlrev_b32 v132, 16, v74
  v_lshlrev_b32 v133, 16, v82
  v_and_b32 v74, 0xffff0000, v74
  v_and_b32 v82, 0xffff0000, v82
  v_mul_f32 v132, v132, v133
  v_mul_f32 v74, v74, v82
  s_waitcnt vmcnt(4)
  buffer_load_dwordx4 v11, s[20:23], s65 offen offset:3072 nt lds
  v_cvt_pk_bf16_f32 v74, v132, v74
  v_lshlrev_b32 v132, 16, v75
  v_lshlrev_b32 v133, 16, v83
  v_and_b32 v75, 0xffff0000, v75
  v_and_b32 v83, 0xffff0000, v83
  v_mul_f32 v132, v132, v133
  v_mul_f32 v75, v75, v83
  v_cvt_pk_bf16_f32 v75, v132, v75
  v_dot2_f32_bf16 v134, v68, v56, 0
  v_dot2_f32_bf16 v134, v69, v56, v134
  v_dot2_f32_bf16 v134, v70, v56, v134
  v_dot2_f32_bf16 v134, v71, v56, v134
  v_dot2_f32_bf16 v134, v72, v56, v134
  v_dot2_f32_bf16 v134, v73, v56, v134
  v_dot2_f32_bf16 v134, v74, v56, v134
  v_dot2_f32_bf16 v134, v75, v56, v134
  s_xor_b32 s65, s64, 0x420000
  s_add_u32 m0, s66, 24576
  s_waitcnt vmcnt(4)
  buffer_load_dwordx4 v10, s[20:23], s65 offen offset:0 nt lds
  ds_read_b128 a[196:199], v12 offset:16384
  ds_read_b128 a[200:203], v13 offset:16384
  ds_read_b128 a[204:207], v14 offset:16384
  ds_read_b128 a[208:211], v15 offset:16384
  s_waitcnt vmcnt(4)
  buffer_load_dwordx4 v11, s[20:23], s65 offen offset:1024 nt lds
  s_waitcnt lgkmcnt(0)
  s_nop 2
  v_add_f32_dpp v134, v134, v134 row_ror:1 row_mask:0xf bank_mask:0xf
  s_nop 1
  v_add_f32_dpp v134, v134, v134 row_ror:2 row_mask:0xf bank_mask:0xf
  s_nop 1
  v_add_f32_dpp v134, v134, v134 row_ror:4 row_mask:0xf bank_mask:0xf
  s_nop 1
  v_add_f32_dpp v134, v134, v134 row_ror:8 row_mask:0xf bank_mask:0xf
  s_nop 1
  v_mov_b32 v135, v134
  s_nop 1
  v_permlane16_swap_b32 v134, v135
  s_nop 0
  v_add_f32 v134, v134, v135
  v_cvt_pk_bf16_f32 v134, 0, v134
  v_mul_f32 v134, 0xbfb8aa3b, v134
  s_waitcnt vmcnt(4)
  buffer_load_dwordx4 v10, s[20:23], s65 offen offset:2048 nt lds
  v_exp_f32 v134, v134
  s_nop 0
  v_add_f32 v134, 1.0, v134
  v_rcp_f32 v134, v134
  v_bfe_i32 v136, v1, 2, 1
  v_cvt_pk_bf16_f32 v134, 0, v134
  v_sub_f32 v135, 1.0, v134
  v_cvt_pk_bf16_f32 v135, 0, v135
  v_bfi_b32 v27, v136, v135, v134
  s_waitcnt vmcnt(4)
  buffer_load_dwordx4 v11, s[20:23], s65 offen offset:3072 nt lds
  s_xor_b32 s65, s64, 0x424000
  s_add_u32 m0, s66, 0
  s_waitcnt vmcnt(4)
  buffer_load_dwordx4 v10, s[20:23], s65 offen offset:0 nt lds
  buffer_load_dwordx4 v[140:143], v30, s[44:47], s3 offen sc1
  s_waitcnt vmcnt(5)
  buffer_load_dwordx4 v11, s[20:23], s65 offen offset:1024 nt lds
  s_waitcnt vmcnt(5)
  buffer_load_dwordx4 v10, s[20:23], s65 offen offset:2048 nt lds
  s_waitcnt vmcnt(5)
  buffer_load_dwordx4 v11, s[20:23], s65 offen offset:3072 nt lds
  s_xor_b32 s65, s64, 0x40000
  s_add_u32 m0, s66, 4096
  s_waitcnt vmcnt(5)
  buffer_load_dwordx4 v10, s[20:23], s65 offen offset:0 nt lds
  s_waitcnt vmcnt(5)
  buffer_load_dwordx4 v11, s[20:23], s65 offen offset:1024 nt lds
  s_cmp_eq_u32 s15, 0
  s_cselect_b32 s18, s16, 0x400000
  v_or_b32 v8, 8, v9
  buffer_store_dword v8, v6, s[44:47], s18 offen
  s_waitcnt vmcnt(5)
  buffer_load_dwordx4 v10, s[20:23], s65 offen offset:2048 nt lds
L_qcheck:
  v_xor_b32 v132, s81, v140
  v_bitop3_b32 v132, v132, v141, s81 bitop3:0xf6
  v_bitop3_b32 v132, v132, v142, s81 bitop3:0xf6
  v_bitop3_b32 v132, v132, v143, s81 bitop3:0xf6
  v_and_b32 v132, 0xffff, v132
  v_cmp_ne_u32 vcc, 0, v132
  s_cbranch_vccnz L_qretry
  s_mov_b32 s73, 0x07060302
  v_perm_b32 v144, v141, v140, s73
  v_perm_b32 v145, v143, v142, s73
  ds_write_b64 v31, v[144:145]
  s_waitcnt lgkmcnt(0)
  ds_write_b32 v33, v56
  s_waitcnt vmcnt(5)
  buffer_load_dwordx4 v11, s[20:23], s65 offen offset:3072 nt lds
  s_xor_b32 s65, s64, 0x44000
  s_add_u32 m0, s66, 8192
  s_waitcnt vmcnt(5)
  buffer_load_dwordx4 v10, s[20:23], s65 offen offset:0 nt lds
  s_waitcnt vmcnt(5)
  buffer_load_dwordx4 v11, s[20:23], s65 offen offset:1024 nt lds
  s_cmp_eq_u32 s15, 1
  s_cselect_b32 s18, s16, 0x400000
  v_or_b32 v8, 9, v9
  buffer_store_dword v8, v6, s[44:47], s18 offen
L_qflag:
  ds_read_b128 v[140:143], v34 offset:0
  s_sub_u32 s79, s79, 1
  s_cbranch_scc1 L_end
  s_waitcnt lgkmcnt(0)
  v_and_b32 v140, v140, v141
  v_and_b32 v142, v142, v143
  v_and_b32 v140, v140, v142
  v_cmp_eq_u32 vcc, 0, v140
  s_cbranch_vccnz L_qflag
  ds_read_b128 a[0:3], v32 offset:0
  ds_read_b128 a[4:7], v32 offset:64
  ds_read_b128 a[8:11], v32 offset:128
  ds_read_b128 a[12:15], v32 offset:192
  s_mov_b32 s80, 0
  s_mov_b32 s3, 0
  ds_read_b128 a[16:19], v32 offset:1024
  ds_read_b128 a[20:23], v32 offset:1088
  ds_read_b128 a[24:27], v32 offset:1152
  ds_read_b128 a[28:31], v32 offset:1216
  s_waitcnt vmcnt(6)
  buffer_load_dwordx4 v10, s[20:23], s65 offen offset:2048 nt lds
  s_waitcnt lgkmcnt(0)
  v_mfma_f32_16x16x32_bf16 v[52:55], a[132:135], a[0:3], 0
  v_mfma_f32_16x16x32_bf16 v[52:55], a[136:139], a[4:7], v[52:55]
  v_mfma_f32_16x16x32_bf16 v[52:55], a[140:143], a[8:11], v[52:55]
  v_mfma_f32_16x16x32_bf16 v[52:55], a[144:147], a[12:15], v[52:55]
  s_nop 7
  v_cvt_pk_bf16_f32 v52, 0, v52
  v_cvt_pk_bf16_f32 v53, 0, v53
  v_cvt_pk_bf16_f32 v54, 0, v54
  v_cvt_pk_bf16_f32 v55, 0, v55
  v_mul_f32 v52, s72, v52
  v_mul_f32 v53, s72, v53
  v_mul_f32 v54, s72, v54
  v_mul_f32 v55, s72, v55
  v_max_f32 v24, v52, v53
  v_cvt_pk_bf16_f32 v68, v52, v53
  v_max3_f32 v24, v24, v54, v55
  v_cvt_pk_bf16_f32 v69, v54, v55
  s_waitcnt lgkmcnt(0)
  v_mfma_f32_16x16x32_bf16 v[52:55], a[148:151], a[0:3], 0
  v_mfma_f32_16x16x32_bf16 v[52:55], a[152:155], a[4:7], v[52:55]
  v_mfma_f32_16x16x32_bf16 v[52:55], a[156:159], a[8:11], v[52:55]
  v_mfma_f32_16x16x32_bf16 v[52:55], a[160:163], a[12:15], v[52:55]
  s_waitcnt vmcnt(5)
  buffer_load_dwordx4 v11, s[20:23], s65 offen offset:3072 nt lds
  s_nop 7
  v_cvt_pk_bf16_f32 v52, 0, v52
  v_cvt_pk_bf16_f32 v53, 0, v53
  v_cvt_pk_bf16_f32 v54, 0, v54
  v_cvt_pk_bf16_f32 v55, 0, v55
  v_mul_f32 v52, s72, v52
  v_mul_f32 v53, s72, v53
  v_mul_f32 v54, s72, v54
  v_mul_f32 v55, s72, v55
  v_max3_f32 v24, v24, v52, v53
  v_cvt_pk_bf16_f32 v70, v52, v53
  v_max3_f32 v24, v24, v54, v55
  v_cvt_pk_bf16_f32 v71, v54, v55
  s_waitcnt lgkmcnt(0)
  v_mfma_f32_16x16x32_bf16 v[52:55], a[164:167], a[0:3], 0
  v_mfma_f32_16x16x32_bf16 v[52:55], a[168:171], a[4:7], v[52:55]
  v_mfma_f32_16x16x32_bf16 v[52:55], a[172:175], a[8:11], v[52:55]
  v_mfma_f32_16x16x32_bf16 v[52:55], a[176:179], a[12:15], v[52:55]
  s_nop 7
  v_cvt_pk_bf16_f32 v52, 0, v52
  v_cvt_pk_bf16_f32 v53, 0, v53
  v_cvt_pk_bf16_f32 v54, 0, v54
  v_cvt_pk_bf16_f32 v55, 0, v55
  v_mul_f32 v52, s72, v52
  v_mul_f32 v53, s72, v53
  v_mul_f32 v54, s72, v54
  v_mul_f32 v55, s72, v55
  v_max3_f32 v24, v24, v52, v53
  v_cvt_pk_bf16_f32 v72, v52, v53
  v_max3_f32 v24, v24, v54, v55
  v_cvt_pk_bf16_f32 v73, v54, v55
  s_xor_b32 s65, s64, 0x440000
  s_add_u32 m0, s66, 12288
  s_waitcnt vmcnt(5)
  buffer_load_dwordx4 v10, s[20:23], s65 offen offset:0 nt lds
  s_waitcnt lgkmcnt(0)
  v_mfma_f32_16x16x32_bf16 v[52:55], a[180:183], a[0:3], 0
  v_mfma_f32_16x16x32_bf16 v[52:55], a[184:187], a[4:7], v[52:55]
  v_mfma_f32_16x16x32_bf16 v[52:55], a[188:191], a[8:11], v[52:55]
  v_mfma_f32_16x16x32_bf16 v[52:55], a[192:195], a[12:15], v[52:55]
  s_nop 7
  v_cvt_pk_bf16_f32 v52, 0, v52
  v_cvt_pk_bf16_f32 v53, 0, v53
  v_cvt_pk_bf16_f32 v54, 0, v54
  v_cvt_pk_bf16_f32 v55, 0, v55
  v_mul_f32 v52, s72, v52
  v_mul_f32 v53, s72, v53
  v_mul_f32 v54, s72, v54
  v_mul_f32 v55, s72, v55
  v_max3_f32 v24, v24, v52, v53
  v_cvt_pk_bf16_f32 v74, v52, v53
  v_max3_f32 v24, v24, v54, v55
  v_cvt_pk_bf16_f32 v75, v54, v55
  s_waitcnt lgkmcnt(0)
  v_mfma_f32_16x16x32_bf16 v[52:55], a[196:199], a[0:3], 0
  v_mfma_f32_16x16x32_bf16 v[52:55], a[200:203], a[4:7], v[52:55]
  v_mfma_f32_16x16x32_bf16 v[52:55], a[204:207], a[8:11], v[52:55]
  v_mfma_f32_16x16x32_bf16 v[52:55], a[208:211], a[12:15], v[52:55]
  s_waitcnt vmcnt(5)
  buffer_load_dwordx4 v11, s[20:23], s65 offen offset:1024 nt lds
  s_cmp_eq_u32 s15, 2
  s_cselect_b32 s18, s16, 0x400000
  v_or_b32 v8, 10, v9
  buffer_store_dword v8, v6, s[44:47], s18 offen
  s_nop 7
  v_cvt_pk_bf16_f32 v52, 0, v52
  v_cvt_pk_bf16_f32 v53, 0, v53
  v_cvt_pk_bf16_f32 v54, 0, v54
  v_cvt_pk_bf16_f32 v55, 0, v55
  v_mul_f32 v52, s72, v52
  v_mul_f32 v53, s72, v53
  v_mul_f32 v54, s72, v54
  v_mul_f32 v55, s72, v55
  v_max3_f32 v24, v24, v52, v53
  v_cvt_pk_bf16_f32 v76, v52, v53
  v_max3_f32 v24, v24, v54, v55
  v_cvt_pk_bf16_f32 v77, v54, v55
  ds_read_b128 a[132:135], v12 offset:20480
  ds_read_b128 a[136:139], v13 offset:20480
  ds_read_b128 a[140:143], v14 offset:20480
  ds_read_b128 a[144:147], v15 offset:20480
  s_waitcnt lgkmcnt(0)
  v_mfma_f32_16x16x32_bf16 v[52:55], a[132:135], a[0:3], 0
  v_mfma_f32_16x16x32_bf16 v[52:55], a[136:139], a[4:7], v[52:55]
  v_mfma_f32_16x16x32_bf16 v[52:55], a[140:143], a[8:11], v[52:55]
  v_mfma_f32_16x16x32_bf16 v[52:55], a[144:147], a[12:15], v[52:55]
  s_waitcnt vmcnt(6)
  buffer_load_dwordx4 v10, s[20:23], s65 offen offset:2048 nt lds
  s_nop 7
  v_cvt_pk_bf16_f32 v52, 0, v52
  v_cvt_pk_bf16_f32 v53, 0, v53
  v_cvt_pk_bf16_f32 v54, 0, v54
  v_cvt_pk_bf16_f32 v55, 0, v55
  v_mul_f32 v52, s72, v52
  v_mul_f32 v53, s72, v53
  v_mul_f32 v54, s72, v54
  v_mul_f32 v55, s72, v55
  v_max3_f32 v24, v24, v52, v53
  v_cvt_pk_bf16_f32 v78, v52, v53
  v_max3_f32 v24, v24, v54, v55
  v_cvt_pk_bf16_f32 v79, v54, v55
  ds_read_b128 a[148:151], v12 offset:24576
  ds_read_b128 a[152:155], v13 offset:24576
  ds_read_b128 a[156:159], v14 offset:24576
  ds_read_b128 a[160:163], v15 offset:24576
  s_waitcnt lgkmcnt(0)
  v_mfma_f32_16x16x32_bf16 v[52:55], a[148:151], a[0:3], 0
  v_mfma_f32_16x16x32_bf16 v[52:55], a[152:155], a[4:7], v[52:55]
  v_mfma_f32_16x16x32_bf16 v[52:55], a[156:159], a[8:11], v[52:55]
  v_mfma_f32_16x16x32_bf16 v[52:55], a[160:163], a[12:15], v[52:55]
  s_waitcnt vmcnt(5)
  buffer_load_dwordx4 v11, s[20:23], s65 offen offset:3072 nt lds
  s_nop 7
  v_cvt_pk_bf16_f32 v52, 0, v52
  v_cvt_pk_bf16_f32 v53, 0, v53
  v_cvt_pk_bf16_f32 v54, 0, v54
  v_cvt_pk_bf16_f32 v55, 0, v55
  v_mul_f32 v52, s72, v52
  v_mul_f32 v53, s72, v53
  v_mul_f32 v54, s72, v54
  v_mul_f32 v55, s72, v55
  v_max3_f32 v24, v24, v52, v53
  v_cvt_pk_bf16_f32 v80, v52, v53
  v_max3_f32 v24, v24, v54, v55
  v_cvt_pk_bf16_f32 v81, v54, v55
  ds_read_b128 a[164:167], v12 offset:0
  ds_read_b128 a[168:171], v13 offset:0
  ds_read_b128 a[172:175], v14 offset:0
  ds_read_b128 a[176:179], v15 offset:0
  s_waitcnt lgkmcnt(0)
  v_mfma_f32_16x16x32_bf16 v[52:55], a[164:167], a[0:3], 0
  v_mfma_f32_16x16x32_bf16 v[52:55], a[168:171], a[4:7], v[52:55]
  v_mfma_f32_16x16x32_bf16 v[52:55], a[172:175], a[8:11], v[52:55]
  v_mfma_f32_16x16x32_bf16 v[52:55], a[176:179], a[12:15], v[52:55]
  s_xor_b32 s65, s64, 0x444000
  s_add_u32 m0, s66, 16384
  s_waitcnt vmcnt(5)
  buffer_load_dwordx4 v10, s[20:23], s65 offen offset:0 nt lds
  s_nop 7
  v_cvt_pk_bf16_f32 v52, 0, v52
  v_cvt_pk_bf16_f32 v53, 0, v53
  v_cvt_pk_bf16_f32 v54, 0, v54
  v_cvt_pk_bf16_f32 v55, 0, v55
  v_mul_f32 v52, s72, v52
  v_mul_f32 v53, s72, v53
  v_mul_f32 v54, s72, v54
  v_mul_f32 v55, s72, v55
  v_max3_f32 v24, v24, v52, v53
  v_cvt_pk_bf16_f32 v82, v52, v53
  v_max3_f32 v24, v24, v54, v55
  v_cvt_pk_bf16_f32 v83, v54, v55
  s_waitcnt vmcnt(5)
  buffer_load_dwordx4 v11, s[20:23], s65 offen offset:1024 nt lds
  s_cmp_eq_u32 s15, 3
  s_cselect_b32 s18, s16, 0x400000
  v_or_b32 v8, 11, v9
  buffer_store_dword v8, v6, s[44:47], s18 offen
  ds_read_b128 a[180:183], v12 offset:4096
  ds_read_b128 a[184:187], v13 offset:4096
  ds_read_b128 a[188:191], v14 offset:4096
  ds_read_b128 a[192:195], v15 offset:4096
  s_waitcnt lgkmcnt(0)
  v_mfma_f32_16x16x32_bf16 v[52:55], a[180:183], a[0:3], 0
  v_mfma_f32_16x16x32_bf16 v[52:55], a[184:187], a[4:7], v[52:55]
  v_mfma_f32_16x16x32_bf16 v[52:55], a[188:191], a[8:11], v[52:55]
  v_mfma_f32_16x16x32_bf16 v[52:55], a[192:195], a[12:15], v[52:55]
  s_nop 7
  v_cvt_pk_bf16_f32 v52, 0, v52
  v_cvt_pk_bf16_f32 v53, 0, v53
  v_cvt_pk_bf16_f32 v54, 0, v54
  v_cvt_pk_bf16_f32 v55, 0, v55
  v_mul_f32 v52, s72, v52
  v_mul_f32 v53, s72, v53
  v_mul_f32 v54, s72, v54
  v_mul_f32 v55, s72, v55
  v_max3_f32 v24, v24, v52, v53
  v_cvt_pk_bf16_f32 v84, v52, v53
  v_max3_f32 v24, v24, v54, v55
  v_cvt_pk_bf16_f32 v85, v54, v55
  s_waitcnt vmcnt(6)
  buffer_load_dwordx4 v10, s[20:23], s65 offen offset:2048 nt lds
  ds_read_b128 a[196:199], v12 offset:8192
  ds_read_b128 a[200:203], v13 offset:8192
  ds_read_b128 a[204:207], v14 offset:8192
  ds_read_b128 a[208:211], v15 offset:8192
  s_waitcnt vmcnt(5)
  buffer_load_dwordx4 v11, s[20:23], s65 offen offset:3072 nt lds
  s_waitcnt lgkmcnt(0)
  v_mfma_f32_16x16x32_bf16 v[52:55], a[196:199], a[0:3], 0
  v_mfma_f32_16x16x32_bf16 v[52:55], a[200:203], a[4:7], v[52:55]
  v_mfma_f32_16x16x32_bf16 v[52:55], a[204:207], a[8:11], v[52:55]
  v_mfma_f32_16x16x32_bf16 v[52:55], a[208:211], a[12:15], v[52:55]
  s_xor_b32 s65, s64, 0x60000
  s_add_u32 m0, s66, 20480
  s_waitcnt vmcnt(5)
  buffer_load_dwordx4 v10, s[20:23], s65 offen offset:0 nt lds
  s_nop 7
  v_cvt_pk_bf16_f32 v52, 0, v52
  v_cvt_pk_bf16_f32 v53, 0, v53
  v_cvt_pk_bf16_f32 v54, 0, v54
  v_cvt_pk_bf16_f32 v55, 0, v55
  v_mul_f32 v52, s72, v52
  v_mul_f32 v53, s72, v53
  v_mul_f32 v54, s72, v54
  v_mul_f32 v55, s72, v55
  v_max3_f32 v24, v24, v52, v53
  v_cvt_pk_bf16_f32 v86, v52, v53
  v_max3_f32 v24, v24, v54, v55
  v_cvt_pk_bf16_f32 v87, v54, v55
  s_waitcnt vmcnt(5)
  buffer_load_dwordx4 v11, s[20:23], s65 offen offset:1024 nt lds
  s_cmp_eq_u32 s15, 0
  s_cselect_b32 s18, s16, 0x400000
  v_or_b32 v8, 12, v9
  buffer_store_dword v8, v6, s[44:47], s18 offen
  ds_read_b128 a[132:135], v12 offset:12288
  ds_read_b128 a[136:139], v13 offset:12288
  ds_read_b128 a[140:143], v14 offset:12288
  ds_read_b128 a[144:147], v15 offset:12288
  s_waitcnt vmcnt(6)
  buffer_load_dwordx4 v10, s[20:23], s65 offen offset:2048 nt lds
  s_waitcnt lgkmcnt(0)
  v_mfma_f32_16x16x32_bf16 v[52:55], a[132:135], a[0:3], 0
  v_mfma_f32_16x16x32_bf16 v[52:55], a[136:139], a[4:7], v[52:55]
  v_mfma_f32_16x16x32_bf16 v[52:55], a[140:143], a[8:11], v[52:55]
  v_mfma_f32_16x16x32_bf16 v[52:55], a[144:147], a[12:15], v[52:55]
  s_waitcnt vmcnt(5)
  buffer_load_dwordx4 v11, s[20:23], s65 offen offset:3072 nt lds
  s_nop 7
  v_cvt_pk_bf16_f32 v52, 0, v52
  v_cvt_pk_bf16_f32 v53, 0, v53
  v_cvt_pk_bf16_f32 v54, 0, v54
  v_cvt_pk_bf16_f32 v55, 0, v55
  v_mul_f32 v52, s72, v52
  v_mul_f32 v53, s72, v53
  v_mul_f32 v54, s72, v54
  v_mul_f32 v55, s72, v55
  v_max3_f32 v24, v24, v52, v53
  v_cvt_pk_bf16_f32 v88, v52, v53
  v_max3_f32 v24, v24, v54, v55
  v_cvt_pk_bf16_f32 v89, v54, v55
  s_xor_b32 s65, s64, 0x64000
  s_add_u32 m0, s66, 24576
  s_waitcnt vmcnt(5)
  buffer_load_dwordx4 v10, s[20:23], s65 offen offset:0 nt lds
  s_mov_b32 s4, 0x07060302
  s_mov_b32 s81, 0xfffff000
  s_mov_b32 s11, 0xfffefffe
  v_lshl_add_u32 v135, v2, 2, v5
  v_and_b32 v137, 1, v4
  v_lshlrev_b32 v137, 3, v137
  v_lshrrev_b32 v138, 1, v4
  v_lshl_add_u32 v136, v135, 8, v137
  v_add_u32 v136, s66, v136
  v_and_b32 v139, 7, v135
  v_lshl_or_b32 v139, v139, 1, v138
  v_xor_b32 v16, 0, v139
  v_lshl_add_u32 v16, v16, 4, v136
  v_xor_b32 v17, 2, v139
  v_lshl_add_u32 v17, v17, 4, v136
  v_xor_b32 v18, 4, v139
  s_waitcnt vmcnt(5)
  buffer_load_dwordx4 v11, s[20:23], s65 offen offset:1024 nt lds
  s_cmp_eq_u32 s15, 1
  s_cselect_b32 s18, s16, 0x400000
  v_or_b32 v8, 13, v9
  buffer_store_dword v8, v6, s[44:47], s18 offen
  ds_read_b128 a[148:151], v12 offset:16384
  ds_read_b128 a[152:155], v13 offset:16384
  ds_read_b128 a[156:159], v14 offset:16384
  ds_read_b128 a[160:163], v15 offset:16384
  s_waitcnt vmcnt(6)
  buffer_load_dwordx4 v10, s[20:23], s65 offen offset:2048 nt lds
  s_waitcnt lgkmcnt(0)
  v_mfma_f32_16x16x32_bf16 v[52:55], a[148:151], a[0:3], 0
  v_mfma_f32_16x16x32_bf16 v[52:55], a[152:155], a[4:7], v[52:55]
  v_mfma_f32_16x16x32_bf16 v[52:55], a[156:159], a[8:11], v[52:55]
  v_mfma_f32_16x16x32_bf16 v[52:55], a[160:163], a[12:15], v[52:55]
  s_waitcnt vmcnt(5)
  buffer_load_dwordx4 v11, s[20:23], s65 offen offset:3072 nt lds
  s_nop 7
  v_cvt_pk_bf16_f32 v52, 0, v52
  v_cvt_pk_bf16_f32 v53, 0, v53
  v_cvt_pk_bf16_f32 v54, 0, v54
  v_cvt_pk_bf16_f32 v55, 0, v55
  v_mul_f32 v52, s72, v52
  v_mul_f32 v53, s72, v53
  v_mul_f32 v54, s72, v54
  v_mul_f32 v55, s72, v55
  v_max3_f32 v24, v24, v52, v53
  v_cvt_pk_bf16_f32 v90, v52, v53
  v_max3_f32 v24, v24, v54, v55
  v_cvt_pk_bf16_f32 v91, v54, v55
  s_xor_b32 s65, s64, 0x460000
  s_add_u32 m0, s66, 0
  s_waitcnt vmcnt(5)
  buffer_load_dwordx4 v10, s[20:23], s65 offen offset:0 nt lds
  v_lshl_add_u32 v18, v18, 4, v136
  v_xor_b32 v19, 6, v139
  v_lshl_add_u32 v19, v19, 4, v136
  v_xor_b32 v20, 8, v139
  v_lshl_add_u32 v20, v20, 4, v136
  v_xor_b32 v21, 10, v139
  v_lshl_add_u32 v21, v21, 4, v136
  v_xor_b32 v22, 12, v139
  v_lshl_add_u32 v22, v22, 4, v136
  v_xor_b32 v23, 14, v139
  v_lshl_add_u32 v23, v23, 4, v136
  v_lshl_add_u32 v136, v135, 7, v137
  v_add_u32 v136, 114688, v136
  v_and_b32 v139, 6, v135
  v_or_b32 v139, v139, v138
  s_lshl_b32 s73, s60, 1
  s_waitcnt vmcnt(5)
  buffer_load_dwordx4 v11, s[20:23], s65 offen offset:1024 nt lds
  s_cmp_eq_u32 s15, 2
  s_cselect_b32 s18, s16, 0x400000
  v_or_b32 v8, 14, v9
  buffer_store_dword v8, v6, s[44:47], s18 offen
  ds_read_b128 a[164:167], v12 offset:20480
  ds_read_b128 a[168:171], v13 offset:20480
  ds_read_b128 a[172:175], v14 offset:20480
  ds_read_b128 a[176:179], v15 offset:20480
  s_waitcnt vmcnt(6)
  buffer_load_dwordx4 v10, s[20:23], s65 offen offset:2048 nt lds
  buffer_load_dword v50, v7, s[44:47], 0 offen sc1
  s_waitcnt lgkmcnt(0)
  v_mfma_f32_16x16x32_bf16 v[52:55], a[164:167], a[0:3], 0
  v_mfma_f32_16x16x32_bf16 v[52:55], a[168:171], a[4:7], v[52:55]
  v_mfma_f32_16x16x32_bf16 v[52:55], a[172:175], a[8:11], v[52:55]
  v_mfma_f32_16x16x32_bf16 v[52:55], a[176:179], a[12:15], v[52:55]
  s_waitcnt vmcnt(6)
  buffer_load_dwordx4 v11, s[20:23], s65 offen offset:3072 nt lds
  s_nop 7
  v_cvt_pk_bf16_f32 v52, 0, v52
  v_cvt_pk_bf16_f32 v53, 0, v53
  v_cvt_pk_bf16_f32 v54, 0, v54
  v_cvt_pk_bf16_f32 v55, 0, v55
  v_mul_f32 v52, s72, v52
  v_mul_f32 v53, s72, v53
  v_mul_f32 v54, s72, v54
  v_mul_f32 v55, s72, v55
  v_max3_f32 v24, v24, v52, v53
  v_cvt_pk_bf16_f32 v92, v52, v53
  v_max3_f32 v24, v24, v54, v55
  v_cvt_pk_bf16_f32 v93, v54, v55
  s_xor_b32 s65, s64, 0x464000
  s_add_u32 m0, s66, 4096
  s_waitcnt vmcnt(6)
  buffer_load_dwordx4 v10, s[20:23], s65 offen offset:0 nt lds
  v_xor_b32 v139, s73, v139
  v_lshl_add_u32 v49, v139, 4, v136
  v_lshrrev_b32 v135, 3, v1
  v_and_b32 v136, 6, v135
  v_and_b32 v137, 7, v1
  v_xor_b32 v136, v136, v137
  v_lshlrev_b32 v136, 4, v136
  v_lshl_add_u32 v29, v135, 10, v136
  s_lshr_b32 s73, s63, 3
  s_lshl2_add_u32 s76, s62, s73
  s_and_b32 s73, s60, 1
  s_lshl1_add_u32 s73, s76, s73
  s_lshl_b32 s73, s73, 16
  s_and_b32 s75, s2, 7
  s_lshl_b32 s74, s75, 7
  s_add_u32 s78, s73, s74
  s_waitcnt vmcnt(6)
  buffer_load_dwordx4 v11, s[20:23], s65 offen offset:1024 nt lds
  s_cmp_eq_u32 s15, 3
  s_cselect_b32 s18, s16, 0x400000
  v_or_b32 v8, 15, v9
  buffer_store_dword v8, v6, s[44:47], s18 offen
  s_lshl2_add_u32 s73, s75, s60
  s_lshl_b32 s73, s73, 12
  s_lshl_b32 s74, s76, 7
  s_add_u32 s73, s73, s74
  s_add_u32 s7, s73, 262144
  v_and_b32 v135, 1, v1
  v_lshlrev_b32 v46, 6, v135
  v_lshl_add_u32 v46, v2, 4, v46
  v_lshlrev_b32 v45, 8, v135
  v_lshl_add_u32 v45, v2, 4, v45
  v_add_u32 v45, 160000, v45
  s_lshl2_add_u32 s12, s75, s60
  s_lshl_b32 s74, s12, 12
  s_add_u32 s8, s74, 262144
  s_lshr_b32 s73, s2, 3
  s_xor_b32 s73, s73, s60
  s_waitcnt vmcnt(7)
  buffer_load_dwordx4 v10, s[20:23], s65 offen offset:2048 nt lds
  s_lshl_b32 s73, s73, 5
  s_or_b32 s12, s12, s73
  v_lshlrev_b32 v42, 4, v1
  v_bfe_u32 v135, v1, 2, 1
  v_lshlrev_b32 v48, 10, v135
  v_lshl_add_u32 v48, v4, 3, v48
  v_bfe_u32 v136, v1, 4, 1
  v_lshl_add_u32 v48, v136, 2, v48
  v_lshrrev_b32 v137, 5, v1
  v_lshl_add_u32 v48, v137, 1, v48
  v_lshlrev_b32 v137, 4, v3
  v_lshl_add_u32 v43, v2, 11, v137
  s_and_b32 s73, s60, 1
  s_lshl1_add_u32 s74, s76, s73
  s_lshl_b32 s74, s74, 13
  s_lshr_b32 s75, s60, 1
  s_waitcnt vmcnt(6)
  buffer_load_dwordx4 v11, s[20:23], s65 offen offset:3072 nt lds
  ds_read_b128 a[180:183], v12 offset:24576
  ds_read_b128 a[184:187], v13 offset:24576
  ds_read_b128 a[188:191], v14 offset:24576
  ds_read_b128 a[192:195], v15 offset:24576
  s_xor_b32 s65, s64, 0x80000
  s_add_u32 m0, s66, 8192
  s_sub_i32 s77, s36, 17
  s_cmp_gt_i32 s14, 16
  s_cselect_b64 vcc, -1, 0
  buffer_load_dwordx4 v10, s[20:23], s65 offen offset:0 nt lds
  s_waitcnt lgkmcnt(0)
  v_mfma_f32_16x16x32_bf16 v[52:55], a[180:183], a[0:3], 0
  v_mfma_f32_16x16x32_bf16 v[52:55], a[184:187], a[4:7], v[52:55]
  v_mfma_f32_16x16x32_bf16 v[52:55], a[188:191], a[8:11], v[52:55]
  v_mfma_f32_16x16x32_bf16 v[52:55], a[192:195], a[12:15], v[52:55]
  s_cbranch_vccnz L_b73
  s_waitcnt vmcnt(6)
  s_bitcmp0_b32 s77, 31
  s_cbranch_scc1 L_b73
  s_waitcnt vmcnt(5)
L_b73:
  buffer_load_dwordx4 v11, s[20:23], s65 offen offset:1024 nt lds
  s_cmp_eq_u32 s15, 0
  s_cselect_b32 s18, s16, 0x400000
  v_or_b32 v8, 16, v9
  buffer_store_dword v8, v6, s[44:47], s18 offen
  s_nop 7
  v_cvt_pk_bf16_f32 v52, 0, v52
  v_cvt_pk_bf16_f32 v53, 0, v53
  v_cvt_pk_bf16_f32 v54, 0, v54
  v_cvt_pk_bf16_f32 v55, 0, v55
  v_mul_f32 v52, s72, v52
  v_mul_f32 v53, s72, v53
  v_mul_f32 v54, s72, v54
  v_mul_f32 v55, s72, v55
  v_max3_f32 v24, v24, v52, v53
  v_cvt_pk_bf16_f32 v94, v52, v53
  v_max3_f32 v24, v24, v54, v55
  v_cvt_pk_bf16_f32 v95, v54, v55
  s_waitcnt vmcnt(8)
  s_cbranch_vccnz L_b74
  s_waitcnt vmcnt(7)
  s_bitcmp0_b32 s77, 31
  s_cbranch_scc1 L_b74
  s_waitcnt vmcnt(6)
L_b74:
  buffer_load_dwordx4 v10, s[20:23], s65 offen offset:2048 nt lds
  v_xor_b32 v50, s17, v50
  v_lshrrev_b32 v51, 8, v50
  v_cmp_eq_u32 s[82:83], 0, v51
  v_mov_b32 v51, 12
  s_nop 0
  v_cndmask_b32 v50, v51, v50, s[82:83]
  s_nop 1
  v_add_u32_dpp v50, v50, v50 row_ror:1 row_mask:0xf bank_mask:0xf
  s_nop 1
  v_add_u32_dpp v50, v50, v50 row_ror:2 row_mask:0xf bank_mask:0xf
  s_nop 1
  v_add_u32_dpp v50, v50, v50 row_ror:4 row_mask:0xf bank_mask:0xf
  s_nop 1
  v_add_u32_dpp v50, v50, v50 row_ror:8 row_mask:0xf bank_mask:0xf
  s_nop 0
  v_readlane_b32 s100, v50, 0
  v_readlane_b32 s101, v50, 16
  s_add_u32 s100, s100, s101
  s_sub_i32 s100, s100, 387
  s_ashr_i32 s37, s100, 1
  s_add_i32 s101, s100, 32
  s_mul_i32 s101, s101, -20
  s_ashr_i32 s101, s101, 8
  s_min_i32 s101, s101, 4
  s_add_i32 s80, s101, 17
  s_max_i32 s80, s80, s3
  s_mul_i32 s100, s100, 24
  s_ashr_i32 s100, s100, 8
  s_min_i32 s100, s100, 8
  s_add_i32 s14, s100, 17
  s_lshl_b32 s76, s75, 8
  s_add_u32 s74, s74, s76
  s_add_u32 s6, s74, 1048576
  s_lshl1_add_u32 s73, s73, s75
  s_lshl_b32 s73, s73, 7
  s_add_u32 s73, s73, 160000
  v_lshl_add_u32 v44, v4, 4, s73
  v_lshl_add_u32 v44, v135, 3, v44
  v_bfe_u32 v137, v1, 3, 1
  v_lshl_add_u32 v44, v137, 6, v44
  v_xor_b32 v136, 1, v136
  v_lshl_add_u32 v44, v136, 9, v44
  s_lshl2_add_u32 s73, s62, s60
  s_lshl_b32 s73, s73, 5
  s_add_u32 s73, s73, s63
  s_lshl_b32 s73, s73, 9
  s_waitcnt vmcnt(8)
  s_cbranch_vccnz L_b75
  s_waitcnt vmcnt(7)
  s_bitcmp0_b32 s77, 31
  s_cbranch_scc1 L_b75
  s_cmp_gt_i32 s80, 16
  s_cbranch_scc0 L_n75
  s_waitcnt vmcnt(4)
L_n75:
  s_waitcnt vmcnt(5)
L_b75:
  buffer_load_dwordx4 v11, s[20:23], s65 offen offset:3072 nt lds
  s_add_u32 s5, s73, 1048576
  v_lshlrev_b32 v135, 9, v4
  v_lshl_add_u32 v135, v2, 4, v135
  s_lshl_b32 s73, s60, 11
  s_add_u32 s73, s73, 151552
  v_add_u32 v35, s73, v135
  v_add_u32 v36, s66, v135
  v_lshl_add_u32 v36, v4, 4, v36
  s_lshl_b32 s73, s60, 2
  s_add_u32 s73, s73, 159744
  v_lshl_add_u32 v37, v4, 4, s73
  v_and_b32 v135, 7, v1
  v_lshlrev_b32 v135, 4, v135
  v_add_u32 v41, 159744, v135
  v_and_b32 v135, 31, v1
  s_lshl_b32 s73, s60, 9
  s_xor_b32 s65, s64, 0x84000
  s_add_u32 m0, s66, 12288
  s_sub_i32 s77, s36, 18
  s_cmp_gt_i32 s14, 17
  s_cselect_b64 vcc, -1, 0
  s_waitcnt vmcnt(8)
  s_cbranch_vccnz L_b76
  s_waitcnt vmcnt(6)
  s_bitcmp0_b32 s77, 31
  s_cbranch_scc1 L_b76
  s_cmp_gt_i32 s80, 17
  s_cbranch_scc0 L_n76
  s_waitcnt vmcnt(4)
L_n76:
  s_waitcnt vmcnt(5)
L_b76:
  buffer_load_dwordx4 v10, s[20:23], s65 offen offset:0 nt lds
  ds_read_b128 a[196:199], v12 offset:0
  ds_read_b128 a[200:203], v13 offset:0
  ds_read_b128 a[204:207], v14 offset:0
  ds_read_b128 a[208:211], v15 offset:0
  s_waitcnt vmcnt(7)
  s_cbranch_vccnz L_b77
  s_waitcnt vmcnt(6)
  s_bitcmp0_b32 s77, 31
  s_cbranch_scc1 L_b77
  s_cmp_gt_i32 s80, 17
  s_cbranch_scc0 L_n77
  s_waitcnt vmcnt(4)
L_n77:
  s_waitcnt vmcnt(5)
L_b77:
  buffer_load_dwordx4 v11, s[20:23], s65 offen offset:1024 nt lds
  s_cmp_eq_u32 s15, 1
  s_cselect_b32 s18, s16, 0x400000
  v_or_b32 v8, 17, v9
  buffer_store_dword v8, v6, s[44:47], s18 offen
  s_waitcnt lgkmcnt(0)
  v_mfma_f32_16x16x32_bf16 v[52:55], a[196:199], a[0:3], 0
  v_mfma_f32_16x16x32_bf16 v[52:55], a[200:203], a[4:7], v[52:55]
  v_mfma_f32_16x16x32_bf16 v[52:55], a[204:207], a[8:11], v[52:55]
  v_mfma_f32_16x16x32_bf16 v[52:55], a[208:211], a[12:15], v[52:55]
  s_waitcnt vmcnt(8)
  s_cbranch_vccnz L_b78
  s_waitcnt vmcnt(7)
  s_bitcmp0_b32 s77, 31
  s_cbranch_scc1 L_b78
  s_cmp_gt_i32 s80, 17
  s_cbranch_scc0 L_n78
  s_waitcnt vmcnt(4)
L_n78:
  s_waitcnt vmcnt(6)
L_b78:
  buffer_load_dwordx4 v10, s[20:23], s65 offen offset:2048 nt lds
  s_nop 7
  v_cvt_pk_bf16_f32 v52, 0, v52
  v_cvt_pk_bf16_f32 v53, 0, v53
  v_cvt_pk_bf16_f32 v54, 0, v54
  v_cvt_pk_bf16_f32 v55, 0, v55
  v_mul_f32 v52, s72, v52
  v_mul_f32 v53, s72, v53
  v_mul_f32 v54, s72, v54
  v_mul_f32 v55, s72, v55
  v_max3_f32 v24, v24, v52, v53
  v_cvt_pk_bf16_f32 v96, v52, v53
  v_max3_f32 v24, v24, v54, v55
  v_cvt_pk_bf16_f32 v97, v54, v55
  s_waitcnt vmcnt(8)
  s_cbranch_vccnz L_b79
  s_waitcnt vmcnt(7)
  s_bitcmp0_b32 s77, 31
  s_cbranch_scc1 L_b79
  s_cmp_gt_i32 s80, 17
  s_cbranch_scc0 L_n79
  s_waitcnt vmcnt(4)
L_n79:
  s_waitcnt vmcnt(5)
L_b79:
  buffer_load_dwordx4 v11, s[20:23], s65 offen offset:3072 nt lds
  v_lshl_add_u32 v39, v135, 4, s73
  v_add_u32 v38, 151552, v39
  s_lshl_b32 s73, s60, 4
  v_add_u32 v39, s73, v39
  v_add_u32 v40, 57344, v39
  s_lshl_b32 s73, s2, 7
  s_add_u32 s9, s73, 196608
  s_andn2_b32 s73, s73, 0x7ff
  s_lshl3_add_u32 s73, s60, s73
  s_add_u32 s10, s73, 196608
  v_bfe_u32 v135, v1, 4, 1
  v_lshlrev_b32 v135, 5, v135
  v_lshl_add_u32 v47, v3, 7, v135
  s_and_b32 s73, s69, 1
  s_bfe_u32 s74, s69, 0x10001
  s_pack_ll_b32_b16 s73, s73, s74
  s_xor_b32 s65, s64, 0x480000
  s_add_u32 m0, s66, 16384
  s_sub_i32 s77, s36, 19
  s_cmp_gt_i32 s14, 18
  s_cselect_b64 vcc, -1, 0
  s_waitcnt vmcnt(8)
  s_cbranch_vccnz L_b80
  s_waitcnt vmcnt(6)
  s_bitcmp0_b32 s77, 31
  s_cbranch_scc1 L_b80
  s_cmp_gt_i32 s80, 18
  s_cbranch_scc0 L_n80
  s_waitcnt vmcnt(4)
L_n80:
  s_waitcnt vmcnt(5)
L_b80:
  buffer_load_dwordx4 v10, s[20:23], s65 offen offset:0 nt lds
  ds_read_b128 a[132:135], v12 offset:4096
  ds_read_b128 a[136:139], v13 offset:4096
  ds_read_b128 a[140:143], v14 offset:4096
  ds_read_b128 a[144:147], v15 offset:4096
  s_waitcnt vmcnt(7)
  s_cbranch_vccnz L_b81
  s_waitcnt vmcnt(6)
  s_bitcmp0_b32 s77, 31
  s_cbranch_scc1 L_b81
  s_cmp_gt_i32 s80, 18
  s_cbranch_scc0 L_n81
  s_waitcnt vmcnt(4)
L_n81:
  s_waitcnt vmcnt(5)
L_b81:
  buffer_load_dwordx4 v11, s[20:23], s65 offen offset:1024 nt lds
  s_cmp_eq_u32 s15, 2
  s_cselect_b32 s18, s16, 0x400000
  v_or_b32 v8, 18, v9
  buffer_store_dword v8, v6, s[44:47], s18 offen
  s_waitcnt lgkmcnt(0)
  v_mfma_f32_16x16x32_bf16 v[52:55], a[132:135], a[0:3], 0
  v_mfma_f32_16x16x32_bf16 v[52:55], a[136:139], a[4:7], v[52:55]
  v_mfma_f32_16x16x32_bf16 v[52:55], a[140:143], a[8:11], v[52:55]
  v_mfma_f32_16x16x32_bf16 v[52:55], a[144:147], a[12:15], v[52:55]
  s_waitcnt vmcnt(8)
  s_cbranch_vccnz L_b82
  s_waitcnt vmcnt(7)
  s_bitcmp0_b32 s77, 31
  s_cbranch_scc1 L_b82
  s_cmp_gt_i32 s80, 18
  s_cbranch_scc0 L_n82
  s_waitcnt vmcnt(4)
L_n82:
  s_waitcnt vmcnt(6)
L_b82:
  buffer_load_dwordx4 v10, s[20:23], s65 offen offset:2048 nt lds
  buffer_load_dword v50, v7, s[44:47], 0 offen sc1
  s_nop 7
  v_cvt_pk_bf16_f32 v52, 0, v52
  v_cvt_pk_bf16_f32 v53, 0, v53
  v_cvt_pk_bf16_f32 v54, 0, v54
  v_cvt_pk_bf16_f32 v55, 0, v55
  v_mul_f32 v52, s72, v52
  v_mul_f32 v53, s72, v53
  v_mul_f32 v54, s72, v54
  v_mul_f32 v55, s72, v55
  v_max3_f32 v24, v24, v52, v53
  v_cvt_pk_bf16_f32 v98, v52, v53
  v_max3_f32 v24, v24, v54, v55
  v_cvt_pk_bf16_f32 v99, v54, v55
  s_waitcnt vmcnt(9)
  s_cbranch_vccnz L_b83
  s_waitcnt vmcnt(8)
  s_bitcmp0_b32 s77, 31
  s_cbranch_scc1 L_b83
  s_cmp_gt_i32 s80, 18
  s_cbranch_scc0 L_n83
  s_waitcnt vmcnt(5)
L_n83:
  s_waitcnt vmcnt(6)
L_b83:
  buffer_load_dwordx4 v11, s[20:23], s65 offen offset:3072 nt lds
  v_mov_b32 v168, s73
  s_and_b32 s73, s69, 1
  s_bfe_u32 s74, s69, 0x10002
  s_pack_ll_b32_b16 s73, s73, s74
  v_mov_b32 v169, s73
  s_and_b32 s73, s69, 1
  s_bfe_u32 s74, s69, 0x10003
  s_pack_ll_b32_b16 s73, s73, s74
  v_mov_b32 v170, s73
  s_and_b32 s73, s69, 1
  s_bfe_u32 s74, s69, 0x10004
  s_pack_ll_b32_b16 s73, s73, s74
  v_mov_b32 v171, s73
  v_and_b32 v135, 1, v1
  v_lshlrev_b32 v135, 4, v135
  v_mov_b32 v136, 0x3f80
  s_xor_b32 s65, s64, 0x484000
  s_add_u32 m0, s66, 20480
  s_sub_i32 s77, s36, 20
  s_cmp_gt_i32 s14, 19
  s_cselect_b64 vcc, -1, 0
  s_waitcnt vmcnt(9)
  s_cbranch_vccnz L_b84
  s_waitcnt vmcnt(7)
  s_bitcmp0_b32 s77, 31
  s_cbranch_scc1 L_b84
  s_cmp_gt_i32 s80, 19
  s_cbranch_scc0 L_n84
  s_waitcnt vmcnt(5)
L_n84:
  s_waitcnt vmcnt(6)
L_b84:
  buffer_load_dwordx4 v10, s[20:23], s65 offen offset:0 nt lds
  v_lshlrev_b32 v135, v135, v136
  v_lshrrev_b32 v136, 1, v3
  v_xor_b32 v137, 0, v136
  v_min_u32 v137, 1, v137
  v_add_u32 v137, -1, v137
  v_and_b32 v172, v137, v135
  v_xor_b32 v137, 1, v136
  v_min_u32 v137, 1, v137
  v_add_u32 v137, -1, v137
  v_and_b32 v173, v137, v135
  v_xor_b32 v137, 2, v136
  v_min_u32 v137, 1, v137
  v_add_u32 v137, -1, v137
  v_and_b32 v174, v137, v135
  v_xor_b32 v137, 3, v136
  v_min_u32 v137, 1, v137
  s_waitcnt vmcnt(8)
  s_cbranch_vccnz L_b85
  s_waitcnt vmcnt(7)
  s_bitcmp0_b32 s77, 31
  s_cbranch_scc1 L_b85
  s_cmp_gt_i32 s80, 19
  s_cbranch_scc0 L_n85
  s_waitcnt vmcnt(5)
L_n85:
  s_waitcnt vmcnt(6)
L_b85:
  buffer_load_dwordx4 v11, s[20:23], s65 offen offset:1024 nt lds
  s_cmp_eq_u32 s15, 3
  s_cselect_b32 s18, s16, 0x400000
  v_or_b32 v8, 19, v9
  buffer_store_dword v8, v6, s[44:47], s18 offen
  ds_read_b128 a[148:151], v12 offset:8192
  ds_read_b128 a[152:155], v13 offset:8192
  ds_read_b128 a[156:159], v14 offset:8192
  ds_read_b128 a[160:163], v15 offset:8192
  s_waitcnt vmcnt(9)
  s_cbranch_vccnz L_b86
  s_waitcnt vmcnt(8)
  s_bitcmp0_b32 s77, 31
  s_cbranch_scc1 L_b86
  s_cmp_gt_i32 s80, 19
  s_cbranch_scc0 L_n86
  s_waitcnt vmcnt(5)
L_n86:
  s_waitcnt vmcnt(7)
L_b86:
  buffer_load_dwordx4 v10, s[20:23], s65 offen offset:2048 nt lds
  s_waitcnt lgkmcnt(0)
  v_mfma_f32_16x16x32_bf16 v[52:55], a[148:151], a[0:3], 0
  v_mfma_f32_16x16x32_bf16 v[52:55], a[152:155], a[4:7], v[52:55]
  v_mfma_f32_16x16x32_bf16 v[52:55], a[156:159], a[8:11], v[52:55]
  v_mfma_f32_16x16x32_bf16 v[52:55], a[160:163], a[12:15], v[52:55]
  s_waitcnt vmcnt(9)
  s_cbranch_vccnz L_b87
  s_waitcnt vmcnt(8)
  s_bitcmp0_b32 s77, 31
  s_cbranch_scc1 L_b87
  s_cmp_gt_i32 s80, 19
  s_cbranch_scc0 L_n87
  s_waitcnt vmcnt(4)
L_n87:
  s_waitcnt vmcnt(6)
L_b87:
  buffer_load_dwordx4 v11, s[20:23], s65 offen offset:3072 nt lds
  s_mov_b32 s18, 0
  buffer_load_dword v184, v182, s[44:47], s18 offen sc1
  s_nop 7
  v_cvt_pk_bf16_f32 v52, 0, v52
  v_cvt_pk_bf16_f32 v53, 0, v53
  v_cvt_pk_bf16_f32 v54, 0, v54
  v_cvt_pk_bf16_f32 v55, 0, v55
  v_mul_f32 v52, s72, v52
  v_mul_f32 v53, s72, v53
  v_mul_f32 v54, s72, v54
  v_mul_f32 v55, s72, v55
  v_max3_f32 v24, v24, v52, v53
  v_cvt_pk_bf16_f32 v100, v52, v53
  v_max3_f32 v24, v24, v54, v55
  v_cvt_pk_bf16_f32 v101, v54, v55
  s_xor_b32 s65, s64, 0xa0000
  s_add_u32 m0, s66, 24576
  s_sub_i32 s77, s36, 21
  s_cmp_gt_i32 s14, 20
  s_cselect_b64 vcc, -1, 0
  s_waitcnt vmcnt(10)
  s_cbranch_vccnz L_b88
  s_waitcnt vmcnt(8)
  s_bitcmp0_b32 s77, 31
  s_cbranch_scc1 L_b88
  s_cmp_gt_i32 s80, 20
  s_cbranch_scc0 L_n88
  s_waitcnt vmcnt(5)
L_n88:
  s_waitcnt vmcnt(6)
L_b88:
  buffer_load_dwordx4 v10, s[20:23], s65 offen offset:0 nt lds
  v_add_u32 v137, -1, v137
  v_and_b32 v175, v137, v135
  s_waitcnt vmcnt(9)
  s_cbranch_vccnz L_b89
  s_waitcnt vmcnt(7)
  s_bitcmp0_b32 s77, 31
  s_cbranch_scc1 L_b89
  s_cmp_gt_i32 s80, 20
  s_cbranch_scc0 L_n89
  s_waitcnt vmcnt(5)
L_n89:
  s_waitcnt vmcnt(6)
L_b89:
  buffer_load_dwordx4 v11, s[20:23], s65 offen offset:1024 nt lds
  s_cmp_eq_u32 s15, 0
  s_cselect_b32 s18, s16, 0x400000
  v_or_b32 v8, 20, v9
  buffer_store_dword v8, v6, s[44:47], s18 offen
  ds_read_b128 a[164:167], v12 offset:12288
  ds_read_b128 a[168:171], v13 offset:12288
  ds_read_b128 a[172:175], v14 offset:12288
  ds_read_b128 a[176:179], v15 offset:12288
  s_waitcnt vmcnt(9)
  s_cbranch_vccnz L_b90
  s_waitcnt vmcnt(8)
  s_bitcmp0_b32 s77, 31
  s_cbranch_scc1 L_b90
  s_cmp_gt_i32 s80, 20
  s_cbranch_scc0 L_n90
  s_waitcnt vmcnt(5)
L_n90:
  s_waitcnt vmcnt(7)
L_b90:
  buffer_load_dwordx4 v10, s[20:23], s65 offen offset:2048 nt lds
  v_xor_b32 v50, s17, v50
  v_lshrrev_b32 v51, 8, v50
  v_cmp_eq_u32 s[82:83], 0, v51
  v_mov_b32 v51, 16
  s_nop 0
  v_cndmask_b32 v50, v51, v50, s[82:83]
  s_nop 1
  v_add_u32_dpp v50, v50, v50 row_ror:1 row_mask:0xf bank_mask:0xf
  s_nop 1
  v_add_u32_dpp v50, v50, v50 row_ror:2 row_mask:0xf bank_mask:0xf
  s_nop 1
  v_add_u32_dpp v50, v50, v50 row_ror:4 row_mask:0xf bank_mask:0xf
  s_nop 1
  v_add_u32_dpp v50, v50, v50 row_ror:8 row_mask:0xf bank_mask:0xf
  s_nop 0
  v_readlane_b32 s100, v50, 0
  v_readlane_b32 s101, v50, 16
  s_add_u32 s100, s100, s101
  s_sub_i32 s100, s100, 515
  s_ashr_i32 s37, s100, 1
  s_add_i32 s101, s100, 32
  s_mul_i32 s101, s101, -20
  s_ashr_i32 s101, s101, 8
  s_min_i32 s101, s101, 4
  s_add_i32 s80, s101, 21
  s_max_i32 s80, s80, s3
  s_mul_i32 s100, s100, 24
  s_ashr_i32 s100, s100, 8
  s_min_i32 s100, s100, 8
  s_add_i32 s14, s100, 21
  s_waitcnt lgkmcnt(0)
  v_mfma_f32_16x16x32_bf16 v[52:55], a[164:167], a[0:3], 0
  v_mfma_f32_16x16x32_bf16 v[52:55], a[168:171], a[4:7], v[52:55]
  v_mfma_f32_16x16x32_bf16 v[52:55], a[172:175], a[8:11], v[52:55]
  v_mfma_f32_16x16x32_bf16 v[52:55], a[176:179], a[12:15], v[52:55]
  s_waitcnt vmcnt(9)
  s_cbranch_vccnz L_b91
  s_waitcnt vmcnt(8)
  s_bitcmp0_b32 s77, 31
  s_cbranch_scc1 L_b91
  s_cmp_gt_i32 s80, 20
  s_cbranch_scc0 L_n91
  s_waitcnt vmcnt(5)
L_n91:
  s_waitcnt vmcnt(6)
L_b91:
  buffer_load_dwordx4 v11, s[20:23], s65 offen offset:3072 nt lds
  s_mov_b32 s18, 0
  buffer_load_dword v185, v182, s[44:47], s18 offen sc1
  s_nop 7
  v_cvt_pk_bf16_f32 v52, 0, v52
  v_cvt_pk_bf16_f32 v53, 0, v53
  v_cvt_pk_bf16_f32 v54, 0, v54
  v_cvt_pk_bf16_f32 v55, 0, v55
  v_mul_f32 v52, s72, v52
  v_mul_f32 v53, s72, v53
  v_mul_f32 v54, s72, v54
  v_mul_f32 v55, s72, v55
  v_max3_f32 v24, v24, v52, v53
  v_cvt_pk_bf16_f32 v102, v52, v53
  v_max3_f32 v24, v24, v54, v55
  v_cvt_pk_bf16_f32 v103, v54, v55
  s_xor_b32 s65, s64, 0xa4000
  s_add_u32 m0, s66, 0
  s_sub_i32 s77, s36, 22
  s_cmp_gt_i32 s14, 21
  s_cselect_b64 vcc, -1, 0
  s_waitcnt vmcnt(10)
  s_cbranch_vccnz L_b92
  s_waitcnt vmcnt(8)
  s_bitcmp0_b32 s77, 31
  s_cbranch_scc1 L_b92
  s_cmp_gt_i32 s80, 21
  s_cbranch_scc0 L_n92
  s_waitcnt vmcnt(5)
L_n92:
  s_waitcnt vmcnt(7)
L_b92:
  buffer_load_dwordx4 v10, s[20:23], s65 offen offset:0 nt lds
  s_waitcnt vmcnt(9)
  s_cbranch_vccnz L_b93
  s_waitcnt vmcnt(8)
  s_bitcmp0_b32 s77, 31
  s_cbranch_scc1 L_b93
  s_cmp_gt_i32 s80, 21
  s_cbranch_scc0 L_n93
  s_waitcnt vmcnt(5)
L_n93:
  s_waitcnt vmcnt(6)
L_b93:
  buffer_load_dwordx4 v11, s[20:23], s65 offen offset:1024 nt lds
  s_cmp_eq_u32 s15, 1
  s_cselect_b32 s18, s16, 0x400000
  v_or_b32 v8, 21, v9
  buffer_store_dword v8, v6, s[44:47], s18 offen
  ds_read_b128 a[180:183], v12 offset:16384
  ds_read_b128 a[184:187], v13 offset:16384
  ds_read_b128 a[188:191], v14 offset:16384
  ds_read_b128 a[192:195], v15 offset:16384
  s_waitcnt vmcnt(10)
  s_cbranch_vccnz L_b94
  s_waitcnt vmcnt(8)
  s_bitcmp0_b32 s77, 31
  s_cbranch_scc1 L_b94
  s_cmp_gt_i32 s80, 21
  s_cbranch_scc0 L_n94
  s_waitcnt vmcnt(5)
L_n94:
  s_waitcnt vmcnt(7)
L_b94:
  buffer_load_dwordx4 v10, s[20:23], s65 offen offset:2048 nt lds
  s_waitcnt lgkmcnt(0)
  v_mfma_f32_16x16x32_bf16 v[52:55], a[180:183], a[0:3], 0
  v_mfma_f32_16x16x32_bf16 v[52:55], a[184:187], a[4:7], v[52:55]
  v_mfma_f32_16x16x32_bf16 v[52:55], a[188:191], a[8:11], v[52:55]
  v_mfma_f32_16x16x32_bf16 v[52:55], a[192:195], a[12:15], v[52:55]
  s_waitcnt vmcnt(9)
  s_cbranch_vccnz L_b95
  s_waitcnt vmcnt(8)
  s_bitcmp0_b32 s77, 31
  s_cbranch_scc1 L_b95
  s_cmp_gt_i32 s80, 21
  s_cbranch_scc0 L_n95
  s_waitcnt vmcnt(5)
L_n95:
  s_waitcnt vmcnt(6)
L_b95:
  buffer_load_dwordx4 v11, s[20:23], s65 offen offset:3072 nt lds
  s_mov_b32 s18, 0
  buffer_load_dword v186, v182, s[44:47], s18 offen sc1
  s_nop 7
  v_cvt_pk_bf16_f32 v52, 0, v52
  v_cvt_pk_bf16_f32 v53, 0, v53
  v_cvt_pk_bf16_f32 v54, 0, v54
  v_cvt_pk_bf16_f32 v55, 0, v55
  v_mul_f32 v52, s72, v52
  v_mul_f32 v53, s72, v53
  v_mul_f32 v54, s72, v54
  v_mul_f32 v55, s72, v55
  v_max3_f32 v24, v24, v52, v53
  v_cvt_pk_bf16_f32 v104, v52, v53
  v_max3_f32 v24, v24, v54, v55
  v_cvt_pk_bf16_f32 v105, v54, v55
  s_xor_b32 s65, s64, 0x4a0000
  s_add_u32 m0, s66, 4096
  s_sub_i32 s77, s36, 23
  s_cmp_gt_i32 s14, 22
  s_cselect_b64 vcc, -1, 0
  s_waitcnt vmcnt(10)
  s_cbranch_vccnz L_b96
  s_waitcnt vmcnt(8)
  s_bitcmp0_b32 s77, 31
  s_cbranch_scc1 L_b96
  s_cmp_gt_i32 s80, 22
  s_cbranch_scc0 L_n96
  s_waitcnt vmcnt(5)
L_n96:
  s_waitcnt vmcnt(7)
L_b96:
  buffer_load_dwordx4 v10, s[20:23], s65 offen offset:0 nt lds
  s_waitcnt vmcnt(9)
  s_cbranch_vccnz L_b97
  s_waitcnt vmcnt(8)
  s_bitcmp0_b32 s77, 31
  s_cbranch_scc1 L_b97
  s_cmp_gt_i32 s80, 22
  s_cbranch_scc0 L_n97
  s_waitcnt vmcnt(5)
L_n97:
  s_waitcnt vmcnt(6)
L_b97:
  buffer_load_dwordx4 v11, s[20:23], s65 offen offset:1024 nt lds
  s_cmp_eq_u32 s15, 2
  s_cselect_b32 s18, s16, 0x400000
  v_or_b32 v8, 22, v9
  buffer_store_dword v8, v6, s[44:47], s18 offen
  ds_read_b128 a[196:199], v12 offset:20480
  ds_read_b128 a[200:203], v13 offset:20480
  ds_read_b128 a[204:207], v14 offset:20480
  ds_read_b128 a[208:211], v15 offset:20480
  s_waitcnt vmcnt(10)
  s_cbranch_vccnz L_b98
  s_waitcnt vmcnt(8)
  s_bitcmp0_b32 s77, 31
  s_cbranch_scc1 L_b98
  s_cmp_gt_i32 s80, 22
  s_cbranch_scc0 L_n98
  s_waitcnt vmcnt(5)
L_n98:
  s_waitcnt vmcnt(7)
L_b98:
  buffer_load_dwordx4 v10, s[20:23], s65 offen offset:2048 nt lds
  buffer_load_dword v50, v7, s[44:47], 0 offen sc1
  s_bitcmp1_b32 s38, 30
  s_cbranch_scc1 L_gp0
  s_add_i32 s100, s37, 128
  s_max_i32 s100, s100, 0
  s_min_i32 s100, s100, 255
  s_mov_b32 s62, s100
  v_or_b32 v180, s100, v9
  s_add_u32 s18, s38, 0
  buffer_store_dword v180, v6, s[44:47], s18 offen sc1
L_gp0:
  s_waitcnt lgkmcnt(0)
  v_mfma_f32_16x16x32_bf16 v[52:55], a[196:199], a[0:3], 0
  v_mfma_f32_16x16x32_bf16 v[52:55], a[200:203], a[4:7], v[52:55]
  v_mfma_f32_16x16x32_bf16 v[52:55], a[204:207], a[8:11], v[52:55]
  v_mfma_f32_16x16x32_bf16 v[52:55], a[208:211], a[12:15], v[52:55]
  s_waitcnt vmcnt(10)
  s_cbranch_vccnz L_b99
  s_waitcnt vmcnt(9)
  s_bitcmp0_b32 s77, 31
  s_cbranch_scc1 L_b99
  s_cmp_gt_i32 s80, 22
  s_cbranch_scc0 L_n99
  s_waitcnt vmcnt(6)
L_n99:
  s_waitcnt vmcnt(7)
L_b99:
  buffer_load_dwordx4 v11, s[20:23], s65 offen offset:3072 nt lds
  s_mov_b32 s18, 0
  buffer_load_dword v187, v182, s[44:47], s18 offen sc1
  s_nop 7
  v_cvt_pk_bf16_f32 v52, 0, v52
  v_cvt_pk_bf16_f32 v53, 0, v53
  v_cvt_pk_bf16_f32 v54, 0, v54
  v_cvt_pk_bf16_f32 v55, 0, v55
  v_mul_f32 v52, s72, v52
  v_mul_f32 v53, s72, v53
  v_mul_f32 v54, s72, v54
  v_mul_f32 v55, s72, v55
  v_max3_f32 v24, v24, v52, v53
  v_cvt_pk_bf16_f32 v106, v52, v53
  v_max3_f32 v24, v24, v54, v55
  v_cvt_pk_bf16_f32 v107, v54, v55
  s_xor_b32 s65, s64, 0x4a4000
  s_add_u32 m0, s66, 8192
  s_sub_i32 s77, s36, 24
  s_cmp_gt_i32 s14, 23
  s_cselect_b64 vcc, -1, 0
  s_waitcnt vmcnt(11)
  s_cbranch_vccnz L_b100
  s_waitcnt vmcnt(9)
  s_bitcmp0_b32 s77, 31
  s_cbranch_scc1 L_b100
  s_cmp_gt_i32 s80, 23
  s_cbranch_scc0 L_n100
  s_waitcnt vmcnt(6)
L_n100:
  s_waitcnt vmcnt(8)
L_b100:
  buffer_load_dwordx4 v10, s[20:23], s65 offen offset:0 nt lds
  s_waitcnt vmcnt(10)
  s_cbranch_vccnz L_b101
  s_waitcnt vmcnt(9)
  s_bitcmp0_b32 s77, 31
  s_cbranch_scc1 L_b101
  s_cmp_gt_i32 s80, 23
  s_cbranch_scc0 L_n101
  s_waitcnt vmcnt(6)
L_n101:
  s_waitcnt vmcnt(7)
L_b101:
  buffer_load_dwordx4 v11, s[20:23], s65 offen offset:1024 nt lds
  s_cmp_eq_u32 s15, 3
  s_cselect_b32 s18, s16, 0x400000
  v_or_b32 v8, 23, v9
  buffer_store_dword v8, v6, s[44:47], s18 offen
  s_waitcnt vmcnt(11)
  s_cbranch_vccnz L_b102
  s_waitcnt vmcnt(9)
  s_bitcmp0_b32 s77, 31
  s_cbranch_scc1 L_b102
  s_cmp_gt_i32 s80, 23
  s_cbranch_scc0 L_n102
  s_waitcnt vmcnt(6)
L_n102:
  s_waitcnt vmcnt(8)
L_b102:
  buffer_load_dwordx4 v10, s[20:23], s65 offen offset:2048 nt lds
  s_waitcnt vmcnt(10)
  s_cbranch_vccnz L_b103
  s_waitcnt vmcnt(9)
  s_bitcmp0_b32 s77, 31
  s_cbranch_scc1 L_b103
  s_cmp_gt_i32 s80, 23
  s_cbranch_scc0 L_n103
  s_waitcnt vmcnt(5)
L_n103:
  s_waitcnt vmcnt(7)
L_b103:
  buffer_load_dwordx4 v11, s[20:23], s65 offen offset:3072 nt lds
  s_mov_b32 s18, 0
  buffer_load_dword v188, v182, s[44:47], s18 offen sc1
  ds_read_b128 a[132:135], v12 offset:24576
  ds_read_b128 a[136:139], v13 offset:24576
  ds_read_b128 a[140:143], v14 offset:24576
  ds_read_b128 a[144:147], v15 offset:24576
  s_xor_b32 s65, s64, 0xc0000
  s_add_u32 m0, s66, 12288
  s_sub_i32 s77, s36, 25
  s_cmp_gt_i32 s14, 24
  s_cselect_b64 vcc, -1, 0
  s_waitcnt vmcnt(11)
  s_cbranch_vccnz L_b104
  s_waitcnt vmcnt(9)
  s_bitcmp0_b32 s77, 31
  s_cbranch_scc1 L_b104
  s_cmp_gt_i32 s80, 24
  s_cbranch_scc0 L_n104
  s_waitcnt vmcnt(5)
L_n104:
  s_waitcnt vmcnt(7)
L_b104:
  buffer_load_dwordx4 v10, s[20:23], s65 offen offset:0 nt lds
  s_waitcnt lgkmcnt(0)
  v_mfma_f32_16x16x32_bf16 v[52:55], a[132:135], a[0:3], 0
  v_mfma_f32_16x16x32_bf16 v[52:55], a[136:139], a[4:7], v[52:55]
  v_mfma_f32_16x16x32_bf16 v[52:55], a[140:143], a[8:11], v[52:55]
  v_mfma_f32_16x16x32_bf16 v[52:55], a[144:147], a[12:15], v[52:55]
  s_waitcnt vmcnt(10)
  s_cbranch_vccnz L_b105
  s_waitcnt vmcnt(8)
  s_bitcmp0_b32 s77, 31
  s_cbranch_scc1 L_b105
  s_cmp_gt_i32 s80, 24
  s_cbranch_scc0 L_n105
  s_waitcnt vmcnt(5)
L_n105:
  s_waitcnt vmcnt(6)
L_b105:
  buffer_load_dwordx4 v11, s[20:23], s65 offen offset:1024 nt lds
  s_cmp_eq_u32 s15, 0
  s_cselect_b32 s18, s16, 0x400000
  v_or_b32 v8, 24, v9
  buffer_store_dword v8, v6, s[44:47], s18 offen
  s_nop 7
  v_cvt_pk_bf16_f32 v52, 0, v52
  v_cvt_pk_bf16_f32 v53, 0, v53
  v_cvt_pk_bf16_f32 v54, 0, v54
  v_cvt_pk_bf16_f32 v55, 0, v55
  v_mul_f32 v52, s72, v52
  v_mul_f32 v53, s72, v53
  v_mul_f32 v54, s72, v54
  v_mul_f32 v55, s72, v55
  v_max3_f32 v24, v24, v52, v53
  v_cvt_pk_bf16_f32 v108, v52, v53
  v_max3_f32 v24, v24, v54, v55
  v_cvt_pk_bf16_f32 v109, v54, v55
  s_waitcnt vmcnt(10)
  s_cbranch_vccnz L_b106
  s_waitcnt vmcnt(8)
  s_bitcmp0_b32 s77, 31
  s_cbranch_scc1 L_b106
  s_cmp_gt_i32 s80, 24
  s_cbranch_scc0 L_n106
  s_waitcnt vmcnt(5)
L_n106:
  s_waitcnt vmcnt(7)
L_b106:
  buffer_load_dwordx4 v10, s[20:23], s65 offen offset:2048 nt lds
  v_xor_b32 v50, s17, v50
  v_lshrrev_b32 v51, 8, v50
  v_cmp_eq_u32 s[82:83], 0, v51
  v_mov_b32 v51, 20
  s_nop 0
  v_cndmask_b32 v50, v51, v50, s[82:83]
  s_nop 1
  v_add_u32_dpp v50, v50, v50 row_ror:1 row_mask:0xf bank_mask:0xf
  s_nop 1
  v_add_u32_dpp v50, v50, v50 row_ror:2 row_mask:0xf bank_mask:0xf
  s_nop 1
  v_add_u32_dpp v50, v50, v50 row_ror:4 row_mask:0xf bank_mask:0xf
  s_nop 1
  v_add_u32_dpp v50, v50, v50 row_ror:8 row_mask:0xf bank_mask:0xf
  s_nop 0
  v_readlane_b32 s100, v50, 0
  v_readlane_b32 s101, v50, 16
  s_add_u32 s100, s100, s101
  s_sub_i32 s100, s100, 643
  s_ashr_i32 s37, s100, 1
  s_add_i32 s62, s37, 128
  s_add_i32 s101, s100, 32
  s_mul_i32 s101, s101, -20
  s_ashr_i32 s101, s101, 8
  s_min_i32 s101, s101, 4
  s_add_i32 s80, s101, 25
  s_max_i32 s80, s80, s3
  s_mul_i32 s100, s100, 24
  s_ashr_i32 s100, s100, 8
  s_min_i32 s100, s100, 8
  s_add_i32 s14, s100, 25
  ds_read_b128 a[148:151], v12 offset:0
  ds_read_b128 a[152:155], v13 offset:0
  ds_read_b128 a[156:159], v14 offset:0
  ds_read_b128 a[160:163], v15 offset:0
  s_waitcnt vmcnt(9)
  s_cbranch_vccnz L_b107
  s_waitcnt vmcnt(8)
  s_bitcmp0_b32 s77, 31
  s_cbranch_scc1 L_b107
  s_cmp_gt_i32 s80, 24
  s_cbranch_scc0 L_n107
  s_waitcnt vmcnt(5)
L_n107:
  s_waitcnt vmcnt(6)
L_b107:
  buffer_load_dwordx4 v11, s[20:23], s65 offen offset:3072 nt lds
  s_mov_b32 s18, 0
  buffer_load_dword v189, v182, s[44:47], s18 offen sc1
  s_waitcnt lgkmcnt(0)
  v_mfma_f32_16x16x32_bf16 v[52:55], a[148:151], a[0:3], 0
  v_mfma_f32_16x16x32_bf16 v[52:55], a[152:155], a[4:7], v[52:55]
  v_mfma_f32_16x16x32_bf16 v[52:55], a[156:159], a[8:11], v[52:55]
  v_mfma_f32_16x16x32_bf16 v[52:55], a[160:163], a[12:15], v[52:55]
  s_xor_b32 s65, s64, 0xc4000
  s_add_u32 m0, s66, 16384
  s_sub_i32 s77, s36, 26
  s_cmp_gt_i32 s14, 25
  s_cselect_b64 vcc, -1, 0
  s_waitcnt vmcnt(10)
  s_cbranch_vccnz L_b108
  s_waitcnt vmcnt(8)
  s_bitcmp0_b32 s77, 31
  s_cbranch_scc1 L_b108
  s_cmp_gt_i32 s80, 25
  s_cbranch_scc0 L_n108
  s_waitcnt vmcnt(5)
L_n108:
  s_waitcnt vmcnt(7)
L_b108:
  buffer_load_dwordx4 v10, s[20:23], s65 offen offset:0 nt lds
  s_nop 7
  v_cvt_pk_bf16_f32 v52, 0, v52
  v_cvt_pk_bf16_f32 v53, 0, v53
  v_cvt_pk_bf16_f32 v54, 0, v54
  v_cvt_pk_bf16_f32 v55, 0, v55
  v_mul_f32 v52, s72, v52
  v_mul_f32 v53, s72, v53
  v_mul_f32 v54, s72, v54
  v_mul_f32 v55, s72, v55
  v_max3_f32 v24, v24, v52, v53
  v_cvt_pk_bf16_f32 v110, v52, v53
  v_max3_f32 v24, v24, v54, v55
  v_cvt_pk_bf16_f32 v111, v54, v55
  s_waitcnt vmcnt(9)
  s_cbranch_vccnz L_b109
  s_waitcnt vmcnt(8)
  s_bitcmp0_b32 s77, 31
  s_cbranch_scc1 L_b109
  s_cmp_gt_i32 s80, 25
  s_cbranch_scc0 L_n109
  s_waitcnt vmcnt(5)
L_n109:
  s_waitcnt vmcnt(6)
L_b109:
  buffer_load_dwordx4 v11, s[20:23], s65 offen offset:1024 nt lds
  s_cmp_eq_u32 s15, 1
  s_cselect_b32 s18, s16, 0x400000
  v_or_b32 v8, 25, v9
  buffer_store_dword v8, v6, s[44:47], s18 offen
  ds_read_b128 a[164:167], v12 offset:4096
  ds_read_b128 a[168:171], v13 offset:4096
  ds_read_b128 a[172:175], v14 offset:4096
  ds_read_b128 a[176:179], v15 offset:4096
  s_waitcnt vmcnt(10)
  s_cbranch_vccnz L_b110
  s_waitcnt vmcnt(8)
  s_bitcmp0_b32 s77, 31
  s_cbranch_scc1 L_b110
  s_cmp_gt_i32 s80, 25
  s_cbranch_scc0 L_n110
  s_waitcnt vmcnt(5)
L_n110:
  s_waitcnt vmcnt(7)
L_b110:
  buffer_load_dwordx4 v10, s[20:23], s65 offen offset:2048 nt lds
  s_waitcnt lgkmcnt(0)
  v_mfma_f32_16x16x32_bf16 v[52:55], a[164:167], a[0:3], 0
  v_mfma_f32_16x16x32_bf16 v[52:55], a[168:171], a[4:7], v[52:55]
  v_mfma_f32_16x16x32_bf16 v[52:55], a[172:175], a[8:11], v[52:55]
  v_mfma_f32_16x16x32_bf16 v[52:55], a[176:179], a[12:15], v[52:55]
  s_waitcnt vmcnt(9)
  s_cbranch_vccnz L_b111
  s_waitcnt vmcnt(8)
  s_bitcmp0_b32 s77, 31
  s_cbranch_scc1 L_b111
  s_cmp_gt_i32 s80, 25
  s_cbranch_scc0 L_n111
  s_waitcnt vmcnt(5)
L_n111:
  s_waitcnt vmcnt(6)
L_b111:
  buffer_load_dwordx4 v11, s[20:23], s65 offen offset:3072 nt lds
  s_mov_b32 s18, 0
  buffer_load_dword v190, v182, s[44:47], s18 offen sc1
  s_nop 7
  v_cvt_pk_bf16_f32 v52, 0, v52
  v_cvt_pk_bf16_f32 v53, 0, v53
  v_cvt_pk_bf16_f32 v54, 0, v54
  v_cvt_pk_bf16_f32 v55, 0, v55
  v_mul_f32 v52, s72, v52
  v_mul_f32 v53, s72, v53
  v_mul_f32 v54, s72, v54
  v_mul_f32 v55, s72, v55
  v_max3_f32 v24, v24, v52, v53
  v_cvt_pk_bf16_f32 v112, v52, v53
  v_max3_f32 v24, v24, v54, v55
  v_cvt_pk_bf16_f32 v113, v54, v55
  s_xor_b32 s65, s64, 0x4c0000
  s_add_u32 m0, s66, 20480
  s_sub_i32 s77, s36, 27
  s_cmp_gt_i32 s14, 26
  s_cselect_b64 vcc, -1, 0
  s_waitcnt vmcnt(10)
  s_cbranch_vccnz L_b112
  s_waitcnt vmcnt(8)
  s_bitcmp0_b32 s77, 31
  s_cbranch_scc1 L_b112
  s_cmp_gt_i32 s80, 26
  s_cbranch_scc0 L_n112
  s_waitcnt vmcnt(5)
L_n112:
  s_waitcnt vmcnt(7)
L_b112:
  buffer_load_dwordx4 v10, s[20:23], s65 offen offset:0 nt lds
  s_waitcnt vmcnt(9)
  s_cbranch_vccnz L_b113
  s_waitcnt vmcnt(8)
  s_bitcmp0_b32 s77, 31
  s_cbranch_scc1 L_b113
  s_cmp_gt_i32 s80, 26
  s_cbranch_scc0 L_n113
  s_waitcnt vmcnt(5)
L_n113:
  s_waitcnt vmcnt(6)
L_b113:
  buffer_load_dwordx4 v11, s[20:23], s65 offen offset:1024 nt lds
  s_cmp_eq_u32 s15, 2
  s_cselect_b32 s18, s16, 0x400000
  v_or_b32 v8, 26, v9
  buffer_store_dword v8, v6, s[44:47], s18 offen
  ds_read_b128 a[180:183], v12 offset:8192
  ds_read_b128 a[184:187], v13 offset:8192
  ds_read_b128 a[188:191], v14 offset:8192
  ds_read_b128 a[192:195], v15 offset:8192
  s_waitcnt vmcnt(10)
  s_cbranch_vccnz L_b114
  s_waitcnt vmcnt(8)
  s_bitcmp0_b32 s77, 31
  s_cbranch_scc1 L_b114
  s_cmp_gt_i32 s80, 26
  s_cbranch_scc0 L_n114
  s_waitcnt vmcnt(5)
L_n114:
  s_waitcnt vmcnt(7)
L_b114:
  buffer_load_dwordx4 v10, s[20:23], s65 offen offset:2048 nt lds
  buffer_load_dword v50, v7, s[44:47], 0 offen sc1
  s_waitcnt lgkmcnt(0)
  v_mfma_f32_16x16x32_bf16 v[52:55], a[180:183], a[0:3], 0
  v_mfma_f32_16x16x32_bf16 v[52:55], a[184:187], a[4:7], v[52:55]
  v_mfma_f32_16x16x32_bf16 v[52:55], a[188:191], a[8:11], v[52:55]
  v_mfma_f32_16x16x32_bf16 v[52:55], a[192:195], a[12:15], v[52:55]
  s_waitcnt vmcnt(10)
  s_cbranch_vccnz L_b115
  s_waitcnt vmcnt(9)
  s_bitcmp0_b32 s77, 31
  s_cbranch_scc1 L_b115
  s_cmp_gt_i32 s80, 26
  s_cbranch_scc0 L_n115
  s_waitcnt vmcnt(6)
L_n115:
  s_waitcnt vmcnt(7)
L_b115:
  buffer_load_dwordx4 v11, s[20:23], s65 offen offset:3072 nt lds
  s_mov_b32 s18, 0
  buffer_load_dword v191, v182, s[44:47], s18 offen sc1
  s_nop 7
  v_cvt_pk_bf16_f32 v52, 0, v52
  v_cvt_pk_bf16_f32 v53, 0, v53
  v_cvt_pk_bf16_f32 v54, 0, v54
  v_cvt_pk_bf16_f32 v55, 0, v55
  v_mul_f32 v52, s72, v52
  v_mul_f32 v53, s72, v53
  v_mul_f32 v54, s72, v54
  v_mul_f32 v55, s72, v55
  v_max3_f32 v24, v24, v52, v53
  v_cvt_pk_bf16_f32 v114, v52, v53
  v_max3_f32 v24, v24, v54, v55
  v_cvt_pk_bf16_f32 v115, v54, v55
  s_xor_b32 s65, s64, 0x4c4000
  s_add_u32 m0, s66, 24576
  s_sub_i32 s77, s36, 28
  s_cmp_gt_i32 s14, 27
  s_cselect_b64 vcc, -1, 0
  s_waitcnt vmcnt(11)
  s_cbranch_vccnz L_b116
  s_waitcnt vmcnt(9)
  s_bitcmp0_b32 s77, 31
  s_cbranch_scc1 L_b116
  s_cmp_gt_i32 s80, 27
  s_cbranch_scc0 L_n116
  s_waitcnt vmcnt(6)
L_n116:
  s_waitcnt vmcnt(8)
L_b116:
  buffer_load_dwordx4 v10, s[20:23], s65 offen offset:0 nt lds
  s_waitcnt vmcnt(10)
  s_cbranch_vccnz L_b117
  s_waitcnt vmcnt(9)
  s_bitcmp0_b32 s77, 31
  s_cbranch_scc1 L_b117
  s_cmp_gt_i32 s80, 27
  s_cbranch_scc0 L_n117
  s_waitcnt vmcnt(6)
L_n117:
  s_waitcnt vmcnt(7)
L_b117:
  buffer_load_dwordx4 v11, s[20:23], s65 offen offset:1024 nt lds
  s_cmp_eq_u32 s15, 3
  s_cselect_b32 s18, s16, 0x400000
  v_or_b32 v8, 27, v9
  buffer_store_dword v8, v6, s[44:47], s18 offen
  s_waitcnt vmcnt(11)
  s_cbranch_vccnz L_b118
  s_waitcnt vmcnt(9)
  s_bitcmp0_b32 s77, 31
  s_cbranch_scc1 L_b118
  s_cmp_gt_i32 s80, 27
  s_cbranch_scc0 L_n118
  s_waitcnt vmcnt(6)
L_n118:
  s_waitcnt vmcnt(8)
L_b118:
  buffer_load_dwordx4 v10, s[20:23], s65 offen offset:2048 nt lds
  s_waitcnt vmcnt(10)
  s_cbranch_vccnz L_b119
  s_waitcnt vmcnt(9)
  s_bitcmp0_b32 s77, 31
  s_cbranch_scc1 L_b119
  s_cmp_gt_i32 s80, 27
  s_cbranch_scc0 L_n119
  s_waitcnt vmcnt(5)
L_n119:
  s_waitcnt vmcnt(7)
L_b119:
  buffer_load_dwordx4 v11, s[20:23], s65 offen offset:3072 nt lds
  ds_read_b128 a[196:199], v12 offset:12288
  ds_read_b128 a[200:203], v13 offset:12288
  ds_read_b128 a[204:207], v14 offset:12288
  ds_read_b128 a[208:211], v15 offset:12288
  s_xor_b32 s65, s64, 0xe0000
  s_add_u32 m0, s66, 0
  s_sub_i32 s77, s36, 29
  s_cmp_gt_i32 s14, 28
  s_cselect_b64 vcc, -1, 0
  s_waitcnt vmcnt(10)
  s_cbranch_vccnz L_b120
  s_waitcnt vmcnt(8)
  s_bitcmp0_b32 s77, 31
  s_cbranch_scc1 L_b120
  s_cmp_gt_i32 s80, 28
  s_cbranch_scc0 L_n120
  s_waitcnt vmcnt(4)
L_n120:
  s_waitcnt vmcnt(6)
L_b120:
  buffer_load_dwordx4 v10, s[20:23], s65 offen offset:0 nt lds
  s_waitcnt lgkmcnt(0)
  v_mfma_f32_16x16x32_bf16 v[52:55], a[196:199], a[0:3], 0
  v_mfma_f32_16x16x32_bf16 v[52:55], a[200:203], a[4:7], v[52:55]
  v_mfma_f32_16x16x32_bf16 v[52:55], a[204:207], a[8:11], v[52:55]
  v_mfma_f32_16x16x32_bf16 v[52:55], a[208:211], a[12:15], v[52:55]
  s_waitcnt vmcnt(9)
  s_cbranch_vccnz L_b121
  s_waitcnt vmcnt(7)
  s_bitcmp0_b32 s77, 31
  s_cbranch_scc1 L_b121
  s_cmp_gt_i32 s80, 28
  s_cbranch_scc0 L_n121
  s_waitcnt vmcnt(4)
L_n121:
  s_waitcnt vmcnt(5)
L_b121:
  buffer_load_dwordx4 v11, s[20:23], s65 offen offset:1024 nt lds
  s_cmp_eq_u32 s15, 0
  s_cselect_b32 s18, s16, 0x400000
  v_or_b32 v8, 28, v9
  buffer_store_dword v8, v6, s[44:47], s18 offen
  s_nop 7
  v_cvt_pk_bf16_f32 v52, 0, v52
  v_cvt_pk_bf16_f32 v53, 0, v53
  v_cvt_pk_bf16_f32 v54, 0, v54
  v_cvt_pk_bf16_f32 v55, 0, v55
  v_mul_f32 v52, s72, v52
  v_mul_f32 v53, s72, v53
  v_mul_f32 v54, s72, v54
  v_mul_f32 v55, s72, v55
  v_max3_f32 v24, v24, v52, v53
  v_cvt_pk_bf16_f32 v116, v52, v53
  v_max3_f32 v24, v24, v54, v55
  v_cvt_pk_bf16_f32 v117, v54, v55
  s_waitcnt vmcnt(9)
  s_cbranch_vccnz L_b122
  s_waitcnt vmcnt(7)
  s_bitcmp0_b32 s77, 31
  s_cbranch_scc1 L_b122
  s_cmp_gt_i32 s80, 28
  s_cbranch_scc0 L_n122
  s_waitcnt vmcnt(4)
L_n122:
  s_waitcnt vmcnt(6)
L_b122:
  buffer_load_dwordx4 v10, s[20:23], s65 offen offset:2048 nt lds
  v_xor_b32 v50, s17, v50
  v_lshrrev_b32 v51, 8, v50
  v_cmp_eq_u32 s[82:83], 0, v51
  v_mov_b32 v51, 24
  s_nop 0
  v_cndmask_b32 v50, v51, v50, s[82:83]
  s_nop 1
  v_add_u32_dpp v50, v50, v50 row_ror:1 row_mask:0xf bank_mask:0xf
  s_nop 1
  v_add_u32_dpp v50, v50, v50 row_ror:2 row_mask:0xf bank_mask:0xf
  s_nop 1
  v_add_u32_dpp v50, v50, v50 row_ror:4 row_mask:0xf bank_mask:0xf
  s_nop 1
  v_add_u32_dpp v50, v50, v50 row_ror:8 row_mask:0xf bank_mask:0xf
  s_nop 0
  v_readlane_b32 s100, v50, 0
  v_readlane_b32 s101, v50, 16
  s_add_u32 s100, s100, s101
  s_sub_i32 s100, s100, 771
  s_ashr_i32 s37, s100, 1
  s_add_i32 s101, s100, 32
  s_mul_i32 s101, s101, -20
  s_ashr_i32 s101, s101, 8
  s_min_i32 s101, s101, 4
  s_add_i32 s80, s101, 29
  s_max_i32 s80, s80, s3
  s_mul_i32 s100, s100, 24
  s_ashr_i32 s100, s100, 8
  s_min_i32 s100, s100, 8
  s_add_i32 s14, s100, 29
  ds_read_b128 a[132:135], v12 offset:16384
  ds_read_b128 a[136:139], v13 offset:16384
  ds_read_b128 a[140:143], v14 offset:16384
  ds_read_b128 a[144:147], v15 offset:16384
  s_waitcnt vmcnt(8)
  s_cbranch_vccnz L_b123
  s_waitcnt vmcnt(7)
  s_bitcmp0_b32 s77, 31
  s_cbranch_scc1 L_b123
  s_cmp_gt_i32 s80, 28
  s_cbranch_scc0 L_n123
  s_waitcnt vmcnt(4)
L_n123:
  s_waitcnt vmcnt(5)
L_b123:
  buffer_load_dwordx4 v11, s[20:23], s65 offen offset:3072 nt lds
  s_bitcmp1_b32 s38, 30
  s_cbranch_scc1 L_ge0
  v_xor_b32 v184, s17, v184
  v_xor_b32 v185, s17, v185
  v_xor_b32 v186, s17, v186
  v_xor_b32 v187, s17, v187
  v_xor_b32 v188, s17, v188
  v_xor_b32 v189, s17, v189
  v_xor_b32 v190, s17, v190
  v_xor_b32 v191, s17, v191
  v_min_u32 v180, 0x100, v191
  v_lshrrev_b32 v181, 1, v180
  v_and_b32 v181, 0x80, v181
  v_and_b32 v180, 0xff, v180
  v_add_u32 v180, v180, v181
  v_lshrrev_b32 v184, 8, v184
  v_min_u32 v184, 1, v184
  v_lshlrev_b32 v184, 4, v184
  v_sub_u32 v180, v180, v184
  v_lshrrev_b32 v185, 8, v185
  v_min_u32 v185, 1, v185
  v_lshlrev_b32 v185, 4, v185
  v_sub_u32 v180, v180, v185
  v_lshrrev_b32 v186, 8, v186
  v_min_u32 v186, 1, v186
  v_lshlrev_b32 v186, 4, v186
  v_sub_u32 v180, v180, v186
  v_lshrrev_b32 v187, 8, v187
  v_min_u32 v187, 1, v187
  v_lshlrev_b32 v187, 4, v187
  v_sub_u32 v180, v180, v187
  v_lshrrev_b32 v188, 8, v188
  v_min_u32 v188, 1, v188
  v_lshlrev_b32 v188, 4, v188
  v_sub_u32 v180, v180, v188
  v_lshrrev_b32 v189, 8, v189
  v_min_u32 v189, 1, v189
  v_lshlrev_b32 v189, 4, v189
  v_sub_u32 v180, v180, v189
  v_lshrrev_b32 v190, 8, v190
  v_min_u32 v190, 1, v190
  v_lshlrev_b32 v190, 4, v190
  v_sub_u32 v180, v180, v190
  v_lshrrev_b32 v191, 8, v191
  v_min_u32 v191, 1, v191
  v_lshlrev_b32 v191, 4, v191
  v_sub_u32 v180, v180, v191
  s_and_b32 s101, s2, 7
  s_sub_i32 s100, s62, 64
  s_mov_b32 m0, s101
  v_writelane_b32 v180, s100, m0
  s_add_u32 m0, s66, 0
  s_nop 1
  v_add_u32_dpp v180, v180, v180 quad_perm:[1,0,3,2] row_mask:0xf bank_mask:0xf
  s_nop 1
  v_add_u32_dpp v180, v180, v180 quad_perm:[2,3,0,1] row_mask:0xf bank_mask:0xf
  s_nop 1
  v_add_u32_dpp v180, v180, v180 row_half_mirror row_mask:0xf bank_mask:0xf
  s_nop 0
  v_readlane_b32 s101, v180, 0
  s_lshl_b32 s100, s100, 3
  s_sub_i32 s100, s101, s100
  s_add_i32 s100, s100, -32
  s_mul_i32 s100, s100, 96
  s_add_i32 s100, s100, 512
  s_ashr_i32 s100, s100, 10
  s_max_i32 s100, s100, -16
  s_min_i32 s100, s100, 16
  s_add_i32 s100, s100, 128
  v_or_b32 v180, s100, v9
  buffer_store_dword v180, v6, s[44:47], s39 offen offset:0
L_ge0:
  s_waitcnt lgkmcnt(0)
  v_mfma_f32_16x16x32_bf16 v[52:55], a[132:135], a[0:3], 0
  v_mfma_f32_16x16x32_bf16 v[52:55], a[136:139], a[4:7], v[52:55]
  v_mfma_f32_16x16x32_bf16 v[52:55], a[140:143], a[8:11], v[52:55]
  v_mfma_f32_16x16x32_bf16 v[52:55], a[144:147], a[12:15], v[52:55]
  s_xor_b32 s65, s64, 0xe4000
  s_add_u32 m0, s66, 4096
  s_sub_i32 s77, s36, 30
  s_cmp_gt_i32 s14, 29
  s_cselect_b64 vcc, -1, 0
  s_waitcnt vmcnt(8)
  s_cbranch_vccnz L_b124
  s_waitcnt vmcnt(6)
  s_bitcmp0_b32 s77, 31
  s_cbranch_scc1 L_b124
  s_cmp_gt_i32 s80, 29
  s_cbranch_scc0 L_n124
  s_waitcnt vmcnt(4)
L_n124:
  s_waitcnt vmcnt(5)
L_b124:
  buffer_load_dwordx4 v10, s[20:23], s65 offen offset:0 nt lds
  s_nop 7
  v_cvt_pk_bf16_f32 v52, 0, v52
  v_cvt_pk_bf16_f32 v53, 0, v53
  v_cvt_pk_bf16_f32 v54, 0, v54
  v_cvt_pk_bf16_f32 v55, 0, v55
  v_mul_f32 v52, s72, v52
  v_mul_f32 v53, s72, v53
  v_mul_f32 v54, s72, v54
  v_mul_f32 v55, s72, v55
  v_max3_f32 v24, v24, v52, v53
  v_cvt_pk_bf16_f32 v118, v52, v53
  v_max3_f32 v24, v24, v54, v55
  v_cvt_pk_bf16_f32 v119, v54, v55
  s_waitcnt vmcnt(7)
  s_cbranch_vccnz L_b125
  s_waitcnt vmcnt(6)
  s_bitcmp0_b32 s77, 31
  s_cbranch_scc1 L_b125
  s_cmp_gt_i32 s80, 29
  s_cbranch_scc0 L_n125
  s_waitcnt vmcnt(4)
L_n125:
  s_waitcnt vmcnt(5)
L_b125:
  buffer_load_dwordx4 v11, s[20:23], s65 offen offset:1024 nt lds
  s_cmp_eq_u32 s15, 1
  s_cselect_b32 s18, s16, 0x400000
  v_or_b32 v8, 29, v9
  buffer_store_dword v8, v6, s[44:47], s18 offen
  ds_read_b128 a[148:151], v12 offset:20480
  ds_read_b128 a[152:155], v13 offset:20480
  ds_read_b128 a[156:159], v14 offset:20480
  ds_read_b128 a[160:163], v15 offset:20480
  s_waitcnt vmcnt(8)
  s_cbranch_vccnz L_b126
  s_waitcnt vmcnt(7)
  s_bitcmp0_b32 s77, 31
  s_cbranch_scc1 L_b126
  s_cmp_gt_i32 s80, 29
  s_cbranch_scc0 L_n126
  s_waitcnt vmcnt(4)
L_n126:
  s_waitcnt vmcnt(6)
L_b126:
  buffer_load_dwordx4 v10, s[20:23], s65 offen offset:2048 nt lds
  s_waitcnt lgkmcnt(0)
  v_mfma_f32_16x16x32_bf16 v[52:55], a[148:151], a[0:3], 0
  v_mfma_f32_16x16x32_bf16 v[52:55], a[152:155], a[4:7], v[52:55]
  v_mfma_f32_16x16x32_bf16 v[52:55], a[156:159], a[8:11], v[52:55]
  v_mfma_f32_16x16x32_bf16 v[52:55], a[160:163], a[12:15], v[52:55]
  s_waitcnt vmcnt(8)
  s_cbranch_vccnz L_b127
  s_waitcnt vmcnt(7)
  s_bitcmp0_b32 s77, 31
  s_cbranch_scc1 L_b127
  s_cmp_gt_i32 s80, 29
  s_cbranch_scc0 L_n127
  s_waitcnt vmcnt(4)
L_n127:
  s_waitcnt vmcnt(5)
L_b127:
  buffer_load_dwordx4 v11, s[20:23], s65 offen offset:3072 nt lds
  s_nop 7
  v_cvt_pk_bf16_f32 v52, 0, v52
  v_cvt_pk_bf16_f32 v53, 0, v53
  v_cvt_pk_bf16_f32 v54, 0, v54
  v_cvt_pk_bf16_f32 v55, 0, v55
  v_mul_f32 v52, s72, v52
  v_mul_f32 v53, s72, v53
  v_mul_f32 v54, s72, v54
  v_mul_f32 v55, s72, v55
  v_max3_f32 v24, v24, v52, v53
  v_cvt_pk_bf16_f32 v120, v52, v53
  v_max3_f32 v24, v24, v54, v55
  v_cvt_pk_bf16_f32 v121, v54, v55
  s_xor_b32 s65, s64, 0x4e0000
  s_add_u32 m0, s66, 8192
  s_sub_i32 s77, s36, 31
  s_cmp_gt_i32 s14, 30
  s_cselect_b64 vcc, -1, 0
  s_waitcnt vmcnt(8)
  s_cbranch_vccnz L_b128
  s_waitcnt vmcnt(6)
  s_bitcmp0_b32 s77, 31
  s_cbranch_scc1 L_b128
  s_cmp_gt_i32 s80, 30
  s_cbranch_scc0 L_n128
  s_waitcnt vmcnt(4)
L_n128:
  s_waitcnt vmcnt(5)
L_b128:
  buffer_load_dwordx4 v10, s[20:23], s65 offen offset:0 nt lds
  ds_read_b128 a[164:167], v12 offset:24576
  ds_read_b128 a[168:171], v13 offset:24576
  ds_read_b128 a[172:175], v14 offset:24576
  ds_read_b128 a[176:179], v15 offset:24576
  s_waitcnt vmcnt(7)
  s_cbranch_vccnz L_b129
  s_waitcnt vmcnt(6)
  s_bitcmp0_b32 s77, 31
  s_cbranch_scc1 L_b129
  s_cmp_gt_i32 s80, 30
  s_cbranch_scc0 L_n129
  s_waitcnt vmcnt(4)
L_n129:
  s_waitcnt vmcnt(5)
L_b129:
  buffer_load_dwordx4 v11, s[20:23], s65 offen offset:1024 nt lds
  s_cmp_eq_u32 s15, 2
  s_cselect_b32 s18, s16, 0x400000
  v_or_b32 v8, 30, v9
  buffer_store_dword v8, v6, s[44:47], s18 offen
  s_waitcnt lgkmcnt(0)
  v_mfma_f32_16x16x32_bf16 v[52:55], a[164:167], a[0:3], 0
  v_mfma_f32_16x16x32_bf16 v[52:55], a[168:171], a[4:7], v[52:55]
  v_mfma_f32_16x16x32_bf16 v[52:55], a[172:175], a[8:11], v[52:55]
  v_mfma_f32_16x16x32_bf16 v[52:55], a[176:179], a[12:15], v[52:55]
  s_waitcnt vmcnt(8)
  s_cbranch_vccnz L_b130
  s_waitcnt vmcnt(7)
  s_bitcmp0_b32 s77, 31
  s_cbranch_scc1 L_b130
  s_cmp_gt_i32 s80, 30
  s_cbranch_scc0 L_n130
  s_waitcnt vmcnt(4)
L_n130:
  s_waitcnt vmcnt(6)
L_b130:
  buffer_load_dwordx4 v10, s[20:23], s65 offen offset:2048 nt lds
  buffer_load_dword v50, v7, s[44:47], 0 offen sc1
  s_nop 7
  v_cvt_pk_bf16_f32 v52, 0, v52
  v_cvt_pk_bf16_f32 v53, 0, v53
  v_cvt_pk_bf16_f32 v54, 0, v54
  v_cvt_pk_bf16_f32 v55, 0, v55
  v_mul_f32 v52, s72, v52
  v_mul_f32 v53, s72, v53
  v_mul_f32 v54, s72, v54
  v_mul_f32 v55, s72, v55
  v_max3_f32 v24, v24, v52, v53
  v_cvt_pk_bf16_f32 v122, v52, v53
  v_max3_f32 v24, v24, v54, v55
  v_cvt_pk_bf16_f32 v123, v54, v55
  s_waitcnt vmcnt(9)
  s_cbranch_vccnz L_b131
  s_waitcnt vmcnt(8)
  s_bitcmp0_b32 s77, 31
  s_cbranch_scc1 L_b131
  s_cmp_gt_i32 s80, 30
  s_cbranch_scc0 L_n131
  s_waitcnt vmcnt(5)
L_n131:
  s_waitcnt vmcnt(6)
L_b131:
  buffer_load_dwordx4 v11, s[20:23], s65 offen offset:3072 nt lds
  s_xor_b32 s65, s64, 0x4e4000
  s_add_u32 m0, s66, 12288
  s_sub_i32 s77, s36, 32
  s_cmp_gt_i32 s14, 31
  s_cselect_b64 vcc, -1, 0
  s_waitcnt vmcnt(9)
  s_cbranch_vccnz L_b132
  s_waitcnt vmcnt(7)
  s_bitcmp0_b32 s77, 31
  s_cbranch_scc1 L_b132
  s_cmp_gt_i32 s80, 31
  s_cbranch_scc0 L_n132
  s_waitcnt vmcnt(5)
L_n132:
  s_waitcnt vmcnt(6)
L_b132:
  buffer_load_dwordx4 v10, s[20:23], s65 offen offset:0 nt lds
  s_waitcnt vmcnt(8)
  s_cbranch_vccnz L_b133
  s_waitcnt vmcnt(7)
  s_bitcmp0_b32 s77, 31
  s_cbranch_scc1 L_b133
  s_cmp_gt_i32 s80, 31
  s_cbranch_scc0 L_n133
  s_waitcnt vmcnt(5)
L_n133:
  s_waitcnt vmcnt(6)
L_b133:
  buffer_load_dwordx4 v11, s[20:23], s65 offen offset:1024 nt lds
  s_cmp_eq_u32 s15, 3
  s_cselect_b32 s18, s16, 0x400000
  v_or_b32 v8, 31, v9
  buffer_store_dword v8, v6, s[44:47], s18 offen
  ds_read_b128 a[180:183], v12 offset:0
  ds_read_b128 a[184:187], v13 offset:0
  ds_read_b128 a[188:191], v14 offset:0
  ds_read_b128 a[192:195], v15 offset:0
  s_waitcnt vmcnt(9)
  s_cbranch_vccnz L_b134
  s_waitcnt vmcnt(8)
  s_bitcmp0_b32 s77, 31
  s_cbranch_scc1 L_b134
  s_cmp_gt_i32 s80, 31
  s_cbranch_scc0 L_n134
  s_waitcnt vmcnt(5)
L_n134:
  s_waitcnt vmcnt(7)
L_b134:
  buffer_load_dwordx4 v10, s[20:23], s65 offen offset:2048 nt lds
  s_waitcnt lgkmcnt(0)
  v_mfma_f32_16x16x32_bf16 v[52:55], a[180:183], a[0:3], 0
  v_mfma_f32_16x16x32_bf16 v[52:55], a[184:187], a[4:7], v[52:55]
  v_mfma_f32_16x16x32_bf16 v[52:55], a[188:191], a[8:11], v[52:55]
  v_mfma_f32_16x16x32_bf16 v[52:55], a[192:195], a[12:15], v[52:55]
  s_waitcnt vmcnt(9)
  s_cbranch_vccnz L_b135
  s_waitcnt vmcnt(8)
  s_bitcmp0_b32 s77, 31
  s_cbranch_scc1 L_b135
  s_cmp_gt_i32 s80, 31
  s_cbranch_scc0 L_n135
  s_waitcnt vmcnt(4)
L_n135:
  s_waitcnt vmcnt(6)
L_b135:
  buffer_load_dwordx4 v11, s[20:23], s65 offen offset:3072 nt lds
  s_nop 7
  v_cvt_pk_bf16_f32 v52, 0, v52
  v_cvt_pk_bf16_f32 v53, 0, v53
  v_cvt_pk_bf16_f32 v54, 0, v54
  v_cvt_pk_bf16_f32 v55, 0, v55
  v_mul_f32 v52, s72, v52
  v_mul_f32 v53, s72, v53
  v_mul_f32 v54, s72, v54
  v_mul_f32 v55, s72, v55
  v_max3_f32 v24, v24, v52, v53
  v_cvt_pk_bf16_f32 v124, v52, v53
  v_max3_f32 v24, v24, v54, v55
  v_cvt_pk_bf16_f32 v125, v54, v55
  s_xor_b32 s65, s64, 0x0
  s_add_u32 m0, s66, 16384
  s_sub_i32 s77, s36, 33
  s_cmp_gt_i32 s14, 32
  s_cselect_b64 vcc, -1, 0
  s_waitcnt vmcnt(9)
  s_cbranch_vccnz L_b136
  s_waitcnt vmcnt(7)
  s_bitcmp0_b32 s77, 31
  s_cbranch_scc1 L_b136
  s_cmp_gt_i32 s80, 32
  s_cbranch_scc0 L_n136
  s_waitcnt vmcnt(4)
L_n136:
  s_waitcnt vmcnt(5)
L_b136:
  buffer_load_dwordx4 v10, s[24:27], s65 offen offset:0 nt lds
  s_waitcnt vmcnt(8)
  s_cbranch_vccnz L_b137
  s_waitcnt vmcnt(6)
  s_bitcmp0_b32 s77, 31
  s_cbranch_scc1 L_b137
  s_cmp_gt_i32 s80, 32
  s_cbranch_scc0 L_n137
  s_waitcnt vmcnt(4)
L_n137:
  s_waitcnt vmcnt(5)
L_b137:
  buffer_load_dwordx4 v11, s[24:27], s65 offen offset:1024 nt lds
  s_cmp_eq_u32 s15, 0
  s_cselect_b32 s18, s16, 0x400000
  v_or_b32 v8, 32, v9
  buffer_store_dword v8, v6, s[44:47], s18 offen
  ds_read_b128 a[196:199], v12 offset:4096
  ds_read_b128 a[200:203], v13 offset:4096
  ds_read_b128 a[204:207], v14 offset:4096
  ds_read_b128 a[208:211], v15 offset:4096
  s_waitcnt vmcnt(8)
  s_cbranch_vccnz L_b138
  s_waitcnt vmcnt(7)
  s_bitcmp0_b32 s77, 31
  s_cbranch_scc1 L_b138
  s_cmp_gt_i32 s80, 32
  s_cbranch_scc0 L_n138
  s_waitcnt vmcnt(4)
L_n138:
  s_waitcnt vmcnt(6)
L_b138:
  buffer_load_dwordx4 v10, s[24:27], s65 offen offset:2048 nt lds
  v_xor_b32 v50, s17, v50
  v_lshrrev_b32 v51, 8, v50
  v_readlane_b32 s100, v50, 32
  s_cmp_lt_u32 s100, 256
  s_cselect_b32 s100, s100, 128
  s_add_i32 s36, s100, -95
  s_sub_i32 s3, 122, s100
  s_ashr_i32 s3, s3, 2
  s_add_i32 s3, s3, 33
  v_cmp_eq_u32 s[82:83], 0, v51
  v_mov_b32 v51, 28
  s_nop 0
  v_cndmask_b32 v50, v51, v50, s[82:83]
  s_nop 1
  v_add_u32_dpp v50, v50, v50 row_ror:1 row_mask:0xf bank_mask:0xf
  s_nop 1
  v_add_u32_dpp v50, v50, v50 row_ror:2 row_mask:0xf bank_mask:0xf
  s_nop 1
  v_add_u32_dpp v50, v50, v50 row_ror:4 row_mask:0xf bank_mask:0xf
  s_nop 1
  v_add_u32_dpp v50, v50, v50 row_ror:8 row_mask:0xf bank_mask:0xf
  s_nop 0
  v_readlane_b32 s100, v50, 0
  v_readlane_b32 s101, v50, 16
  s_add_u32 s100, s100, s101
  s_sub_i32 s100, s100, 899
  s_ashr_i32 s37, s100, 1
  s_add_i32 s101, s100, 32
  s_mul_i32 s101, s101, -20
  s_ashr_i32 s101, s101, 8
  s_min_i32 s101, s101, 4
  s_add_i32 s80, s101, 33
  s_max_i32 s80, s80, s3
  s_mul_i32 s100, s100, 24
  s_ashr_i32 s100, s100, 8
  s_min_i32 s100, s100, 8
  s_add_i32 s14, s100, 33
  s_waitcnt lgkmcnt(0)
  v_mfma_f32_16x16x32_bf16 v[52:55], a[196:199], a[0:3], 0
  v_mfma_f32_16x16x32_bf16 v[52:55], a[200:203], a[4:7], v[52:55]
  v_mfma_f32_16x16x32_bf16 v[52:55], a[204:207], a[8:11], v[52:55]
  v_mfma_f32_16x16x32_bf16 v[52:55], a[208:211], a[12:15], v[52:55]
  s_waitcnt vmcnt(8)
  s_cbranch_vccnz L_b139
  s_waitcnt vmcnt(7)
  s_bitcmp0_b32 s77, 31
  s_cbranch_scc1 L_b139
  s_cmp_gt_i32 s80, 32
  s_cbranch_scc0 L_n139
  s_waitcnt vmcnt(4)
L_n139:
  s_waitcnt vmcnt(5)
L_b139:
  buffer_load_dwordx4 v11, s[24:27], s65 offen offset:3072 nt lds
  s_nop 7
  v_cvt_pk_bf16_f32 v52, 0, v52
  v_cvt_pk_bf16_f32 v53, 0, v53
  v_cvt_pk_bf16_f32 v54, 0, v54
  v_cvt_pk_bf16_f32 v55, 0, v55
  v_mul_f32 v52, s72, v52
  v_mul_f32 v53, s72, v53
  v_mul_f32 v54, s72, v54
  v_mul_f32 v55, s72, v55
  v_max3_f32 v24, v24, v52, v53
  v_cvt_pk_bf16_f32 v126, v52, v53
  v_max3_f32 v24, v24, v54, v55
  v_cvt_pk_bf16_f32 v127, v54, v55
  s_xor_b32 s65, s64, 0x4000
  s_add_u32 m0, s66, 20480
  s_sub_i32 s77, s36, 34
  s_cmp_gt_i32 s14, 33
  s_cselect_b64 vcc, -1, 0
  s_waitcnt vmcnt(8)
  s_cbranch_vccnz L_b140
  s_waitcnt vmcnt(6)
  s_bitcmp0_b32 s77, 31
  s_cbranch_scc1 L_b140
  s_cmp_gt_i32 s80, 33
  s_cbranch_scc0 L_n140
  s_waitcnt vmcnt(4)
L_n140:
  s_waitcnt vmcnt(5)
L_b140:
  buffer_load_dwordx4 v10, s[24:27], s65 offen offset:0 nt lds
  ds_read_b128 a[132:135], v12 offset:8192
  ds_read_b128 a[136:139], v13 offset:8192
  ds_read_b128 a[140:143], v14 offset:8192
  ds_read_b128 a[144:147], v15 offset:8192
  s_waitcnt vmcnt(7)
  s_cbranch_vccnz L_b141
  s_waitcnt vmcnt(6)
  s_bitcmp0_b32 s77, 31
  s_cbranch_scc1 L_b141
  s_cmp_gt_i32 s80, 33
  s_cbranch_scc0 L_n141
  s_waitcnt vmcnt(4)
L_n141:
  s_waitcnt vmcnt(5)
L_b141:
  buffer_load_dwordx4 v11, s[24:27], s65 offen offset:1024 nt lds
  s_cmp_eq_u32 s15, 1
  s_cselect_b32 s18, s16, 0x400000
  v_or_b32 v8, 33, v9
  buffer_store_dword v8, v6, s[44:47], s18 offen
  s_waitcnt lgkmcnt(0)
  v_mfma_f32_16x16x32_bf16 v[52:55], a[132:135], a[0:3], 0
  v_mfma_f32_16x16x32_bf16 v[52:55], a[136:139], a[4:7], v[52:55]
  v_mfma_f32_16x16x32_bf16 v[52:55], a[140:143], a[8:11], v[52:55]
  v_mfma_f32_16x16x32_bf16 v[52:55], a[144:147], a[12:15], v[52:55]
  s_waitcnt vmcnt(8)
  s_cbranch_vccnz L_b142
  s_waitcnt vmcnt(7)
  s_bitcmp0_b32 s77, 31
  s_cbranch_scc1 L_b142
  s_cmp_gt_i32 s80, 33
  s_cbranch_scc0 L_n142
  s_waitcnt vmcnt(4)
L_n142:
  s_waitcnt vmcnt(6)
L_b142:
  buffer_load_dwordx4 v10, s[24:27], s65 offen offset:2048 nt lds
  s_nop 7
  v_cvt_pk_bf16_f32 v52, 0, v52
  v_cvt_pk_bf16_f32 v53, 0, v53
  v_cvt_pk_bf16_f32 v54, 0, v54
  v_cvt_pk_bf16_f32 v55, 0, v55
  v_mul_f32 v52, s72, v52
  v_mul_f32 v53, s72, v53
  v_mul_f32 v54, s72, v54
  v_mul_f32 v55, s72, v55
  v_max3_f32 v24, v24, v52, v53
  v_cvt_pk_bf16_f32 v128, v52, v53
  v_max3_f32 v24, v24, v54, v55
  v_cvt_pk_bf16_f32 v129, v54, v55
  s_waitcnt vmcnt(8)
  s_cbranch_vccnz L_b143
  s_waitcnt vmcnt(7)
  s_bitcmp0_b32 s77, 31
  s_cbranch_scc1 L_b143
  s_cmp_gt_i32 s80, 33
  s_cbranch_scc0 L_n143
  s_waitcnt vmcnt(4)
L_n143:
  s_waitcnt vmcnt(5)
L_b143:
  buffer_load_dwordx4 v11, s[24:27], s65 offen offset:3072 nt lds
  s_xor_b32 s65, s64, 0x400000
  s_add_u32 m0, s66, 24576
  s_sub_i32 s77, s36, 35
  s_cmp_gt_i32 s14, 34
  s_cselect_b64 vcc, -1, 0
  s_waitcnt vmcnt(8)
  s_cbranch_vccnz L_b144
  s_waitcnt vmcnt(6)
  s_bitcmp0_b32 s77, 31
  s_cbranch_scc1 L_b144
  s_cmp_gt_i32 s80, 34
  s_cbranch_scc0 L_n144
  s_waitcnt vmcnt(4)
L_n144:
  s_waitcnt vmcnt(5)
L_b144:
  buffer_load_dwordx4 v10, s[24:27], s65 offen offset:0 nt lds
  ds_read_b128 a[148:151], v12 offset:12288
  ds_read_b128 a[152:155], v13 offset:12288
  ds_read_b128 a[156:159], v14 offset:12288
  ds_read_b128 a[160:163], v15 offset:12288
  s_waitcnt vmcnt(7)
  s_cbranch_vccnz L_b145
  s_waitcnt vmcnt(6)
  s_bitcmp0_b32 s77, 31
  s_cbranch_scc1 L_b145
  s_cmp_gt_i32 s80, 34
  s_cbranch_scc0 L_n145
  s_waitcnt vmcnt(4)
L_n145:
  s_waitcnt vmcnt(5)
L_b145:
  buffer_load_dwordx4 v11, s[24:27], s65 offen offset:1024 nt lds
  s_cmp_eq_u32 s15, 2
  s_cselect_b32 s18, s16, 0x400000
  v_or_b32 v8, 34, v9
  buffer_store_dword v8, v6, s[44:47], s18 offen
  s_waitcnt lgkmcnt(0)
  v_mfma_f32_16x16x32_bf16 v[52:55], a[148:151], a[0:3], 0
  v_mfma_f32_16x16x32_bf16 v[52:55], a[152:155], a[4:7], v[52:55]
  v_mfma_f32_16x16x32_bf16 v[52:55], a[156:159], a[8:11], v[52:55]
  v_mfma_f32_16x16x32_bf16 v[52:55], a[160:163], a[12:15], v[52:55]
  s_waitcnt vmcnt(8)
  s_cbranch_vccnz L_b146
  s_waitcnt vmcnt(7)
  s_bitcmp0_b32 s77, 31
  s_cbranch_scc1 L_b146
  s_cmp_gt_i32 s80, 34
  s_cbranch_scc0 L_n146
  s_waitcnt vmcnt(4)
L_n146:
  s_waitcnt vmcnt(6)
L_b146:
  buffer_load_dwordx4 v10, s[24:27], s65 offen offset:2048 nt lds
  buffer_load_dword v50, v7, s[44:47], 0 offen sc1
  s_nop 7
  v_cvt_pk_bf16_f32 v52, 0, v52
  v_cvt_pk_bf16_f32 v53, 0, v53
  v_cvt_pk_bf16_f32 v54, 0, v54
  v_cvt_pk_bf16_f32 v55, 0, v55
  v_mul_f32 v52, s72, v52
  v_mul_f32 v53, s72, v53
  v_mul_f32 v54, s72, v54
  v_mul_f32 v55, s72, v55
  v_max3_f32 v24, v24, v52, v53
  v_cvt_pk_bf16_f32 v130, v52, v53
  v_max3_f32 v24, v24, v54, v55
  v_cvt_pk_bf16_f32 v131, v54, v55
  s_waitcnt vmcnt(9)
  s_cbranch_vccnz L_b147
  s_waitcnt vmcnt(8)
  s_bitcmp0_b32 s77, 31
  s_cbranch_scc1 L_b147
  s_cmp_gt_i32 s80, 34
  s_cbranch_scc0 L_n147
  s_waitcnt vmcnt(5)
L_n147:
  s_waitcnt vmcnt(6)
L_b147:
  buffer_load_dwordx4 v11, s[24:27], s65 offen offset:3072 nt lds
  v_mov_b32 v28, v24
  s_nop 1
  v_permlane32_swap_b32 v24, v28
  v_max_f32 v24, v24, v28
  v_mov_b32 v28, v24
  s_nop 1
  v_permlane16_swap_b32 v24, v28
  v_max_f32 v24, v24, v28
  v_cvt_pk_bf16_f32 v25, 0, v24
  v_mul_f32 v26, 0xbfb8aa3b, v25
  s_xor_b32 s65, s64, 0x404000
  s_add_u32 m0, s66, 0
  s_sub_i32 s77, s36, 36
  s_cmp_gt_i32 s14, 35
  s_cselect_b64 vcc, -1, 0
  s_waitcnt vmcnt(9)
  s_cbranch_vccnz L_b148
  s_waitcnt vmcnt(7)
  s_bitcmp0_b32 s77, 31
  s_cbranch_scc1 L_b148
  s_cmp_gt_i32 s80, 35
  s_cbranch_scc0 L_n148
  s_waitcnt vmcnt(5)
L_n148:
  s_waitcnt vmcnt(6)
L_b148:
  buffer_load_dwordx4 v10, s[24:27], s65 offen offset:0 nt lds
  v_lshlrev_b32 v52, 16, v68
  v_and_b32 v53, 0xffff0000, v68
  v_lshlrev_b32 v54, 16, v69
  v_and_b32 v55, 0xffff0000, v69
  v_fma_f32 v52, v52, s71, v26
  v_fma_f32 v53, v53, s71, v26
  v_fma_f32 v54, v54, s71, v26
  v_fma_f32 v55, v55, s71, v26
  v_exp_f32 v52, v52
  v_exp_f32 v53, v53
  v_exp_f32 v54, v54
  v_exp_f32 v55, v55
  v_cvt_pk_bf16_f32 v68, v52, v53
  v_cvt_pk_bf16_f32 v69, v54, v55
  s_waitcnt vmcnt(8)
  s_cbranch_vccnz L_b149
  s_waitcnt vmcnt(7)
  s_bitcmp0_b32 s77, 31
  s_cbranch_scc1 L_b149
  s_cmp_gt_i32 s80, 35
  s_cbranch_scc0 L_n149
  s_waitcnt vmcnt(5)
L_n149:
  s_waitcnt vmcnt(6)
L_b149:
  buffer_load_dwordx4 v11, s[24:27], s65 offen offset:1024 nt lds
  s_cmp_eq_u32 s15, 3
  s_cselect_b32 s18, s16, 0x400000
  v_or_b32 v8, 35, v9
  buffer_store_dword v8, v6, s[44:47], s18 offen
  v_lshlrev_b32 v52, 16, v70
  v_and_b32 v53, 0xffff0000, v70
  v_lshlrev_b32 v54, 16, v71
  v_and_b32 v55, 0xffff0000, v71
  v_fma_f32 v52, v52, s71, v26
  v_fma_f32 v53, v53, s71, v26
  v_fma_f32 v54, v54, s71, v26
  v_fma_f32 v55, v55, s71, v26
  v_exp_f32 v52, v52
  v_exp_f32 v53, v53
  v_exp_f32 v54, v54
  v_exp_f32 v55, v55
  v_cvt_pk_bf16_f32 v70, v52, v53
  v_cvt_pk_bf16_f32 v71, v54, v55
  s_nop 1
  v_mfma_f32_16x16x32_bf16 a[128:131], v[56:59], v[68:71], 0
  ds_read_b64_tr_b16 a[32:33], v16 offset:16384
  ds_read_b64_tr_b16 a[36:37], v17 offset:16384
  ds_read_b64_tr_b16 a[40:41], v18 offset:16384
  ds_read_b64_tr_b16 a[44:45], v19 offset:16384
  ds_read_b64_tr_b16 a[48:49], v20 offset:16384
  ds_read_b64_tr_b16 a[52:53], v21 offset:16384
  ds_read_b64_tr_b16 a[56:57], v22 offset:16384
  ds_read_b64_tr_b16 a[60:61], v23 offset:16384
  s_waitcnt vmcnt(9)
  s_cbranch_vccnz L_b150
  s_waitcnt vmcnt(8)
  s_bitcmp0_b32 s77, 31
  s_cbranch_scc1 L_b150
  s_cmp_gt_i32 s80, 35
  s_cbranch_scc0 L_n150
  s_waitcnt vmcnt(5)
L_n150:
  s_waitcnt vmcnt(7)
L_b150:
  buffer_load_dwordx4 v10, s[24:27], s65 offen offset:2048 nt lds
  v_lshlrev_b32 v52, 16, v72
  v_and_b32 v53, 0xffff0000, v72
  v_lshlrev_b32 v54, 16, v73
  v_and_b32 v55, 0xffff0000, v73
  v_fma_f32 v52, v52, s71, v26
  v_fma_f32 v53, v53, s71, v26
  v_fma_f32 v54, v54, s71, v26
  v_fma_f32 v55, v55, s71, v26
  v_exp_f32 v52, v52
  v_exp_f32 v53, v53
  v_exp_f32 v54, v54
  v_exp_f32 v55, v55
  v_cvt_pk_bf16_f32 v72, v52, v53
  v_cvt_pk_bf16_f32 v73, v54, v55
  s_waitcnt vmcnt(9)
  s_cbranch_vccnz L_b151
  s_waitcnt vmcnt(8)
  s_bitcmp0_b32 s77, 31
  s_cbranch_scc1 L_b151
  s_cmp_gt_i32 s80, 35
  s_cbranch_scc0 L_n151
  s_waitcnt vmcnt(4)
L_n151:
  s_waitcnt vmcnt(6)
L_b151:
  buffer_load_dwordx4 v11, s[24:27], s65 offen offset:3072 nt lds
  s_mov_b32 s18, 33792
  buffer_load_dword v184, v182, s[44:47], s18 offen sc1
  v_lshlrev_b32 v52, 16, v74
  v_and_b32 v53, 0xffff0000, v74
  v_lshlrev_b32 v54, 16, v75
  v_and_b32 v55, 0xffff0000, v75
  v_fma_f32 v52, v52, s71, v26
  v_fma_f32 v53, v53, s71, v26
  v_fma_f32 v54, v54, s71, v26
  v_fma_f32 v55, v55, s71, v26
  v_exp_f32 v52, v52
  v_exp_f32 v53, v53
  v_exp_f32 v54, v54
  v_exp_f32 v55, v55
  v_cvt_pk_bf16_f32 v74, v52, v53
  v_cvt_pk_bf16_f32 v75, v54, v55
  s_nop 1
  v_mfma_f32_16x16x32_bf16 a[128:131], v[56:59], v[72:75], a[128:131]
  s_xor_b32 s65, s64, 0x20000
  s_add_u32 m0, s66, 4096
  s_sub_i32 s77, s36, 37
  s_cmp_gt_i32 s14, 36
  s_cselect_b64 vcc, -1, 0
  s_waitcnt vmcnt(10)
  s_cbranch_vccnz L_b152
  s_waitcnt vmcnt(8)
  s_bitcmp0_b32 s77, 31
  s_cbranch_scc1 L_b152
  s_cmp_gt_i32 s80, 36
  s_cbranch_scc0 L_n152
  s_waitcnt vmcnt(5)
L_n152:
  s_waitcnt vmcnt(6)
L_b152:
  buffer_load_dwordx4 v10, s[24:27], s65 offen offset:0 nt lds
  v_lshlrev_b32 v52, 16, v76
  v_and_b32 v53, 0xffff0000, v76
  v_lshlrev_b32 v54, 16, v77
  v_and_b32 v55, 0xffff0000, v77
  v_fma_f32 v52, v52, s71, v26
  v_fma_f32 v53, v53, s71, v26
  v_fma_f32 v54, v54, s71, v26
  v_fma_f32 v55, v55, s71, v26
  v_exp_f32 v52, v52
  v_exp_f32 v53, v53
  v_exp_f32 v54, v54
  v_exp_f32 v55, v55
  v_cvt_pk_bf16_f32 v76, v52, v53
  v_cvt_pk_bf16_f32 v77, v54, v55
  s_waitcnt vmcnt(9)
  s_cbranch_vccnz L_b153
  s_waitcnt vmcnt(7)
  s_bitcmp0_b32 s77, 31
  s_cbranch_scc1 L_b153
  s_cmp_gt_i32 s80, 36
  s_cbranch_scc0 L_n153
  s_waitcnt vmcnt(5)
L_n153:
  s_waitcnt vmcnt(6)
L_b153:
  buffer_load_dwordx4 v11, s[24:27], s65 offen offset:1024 nt lds
  s_cmp_eq_u32 s15, 0
  s_cselect_b32 s18, s16, 0x400000
  v_or_b32 v8, 36, v9
  buffer_store_dword v8, v6, s[44:47], s18 offen
  v_lshlrev_b32 v52, 16, v78
  v_and_b32 v53, 0xffff0000, v78
  v_lshlrev_b32 v54, 16, v79
  v_and_b32 v55, 0xffff0000, v79
  v_fma_f32 v52, v52, s71, v26
  v_fma_f32 v53, v53, s71, v26
  v_fma_f32 v54, v54, s71, v26
  v_fma_f32 v55, v55, s71, v26
  v_exp_f32 v52, v52
  v_exp_f32 v53, v53
  v_exp_f32 v54, v54
  v_exp_f32 v55, v55
  v_cvt_pk_bf16_f32 v78, v52, v53
  v_cvt_pk_bf16_f32 v79, v54, v55
  s_nop 1
  v_mfma_f32_16x16x32_bf16 a[128:131], v[56:59], v[76:79], a[128:131]
  ds_read_b64_tr_b16 a[34:35], v16 offset:20480
  ds_read_b64_tr_b16 a[38:39], v17 offset:20480
  ds_read_b64_tr_b16 a[42:43], v18 offset:20480
  ds_read_b64_tr_b16 a[46:47], v19 offset:20480
  ds_read_b64_tr_b16 a[50:51], v20 offset:20480
  ds_read_b64_tr_b16 a[54:55], v21 offset:20480
  ds_read_b64_tr_b16 a[58:59], v22 offset:20480
  ds_read_b64_tr_b16 a[62:63], v23 offset:20480
  s_waitcnt vmcnt(9)
  s_cbranch_vccnz L_b154
  s_waitcnt vmcnt(8)
  s_bitcmp0_b32 s77, 31
  s_cbranch_scc1 L_b154
  s_cmp_gt_i32 s80, 36
  s_cbranch_scc0 L_n154
  s_waitcnt vmcnt(5)
L_n154:
  s_waitcnt vmcnt(7)
L_b154:
  buffer_load_dwordx4 v10, s[24:27], s65 offen offset:2048 nt lds
  v_xor_b32 v50, s17, v50
  v_lshrrev_b32 v51, 8, v50
  v_cmp_eq_u32 s[82:83], 0, v51
  v_mov_b32 v51, 32
  s_nop 0
  v_cndmask_b32 v50, v51, v50, s[82:83]
  s_nop 1
  v_add_u32_dpp v50, v50, v50 row_ror:1 row_mask:0xf bank_mask:0xf
  s_nop 1
  v_add_u32_dpp v50, v50, v50 row_ror:2 row_mask:0xf bank_mask:0xf
  s_nop 1
  v_add_u32_dpp v50, v50, v50 row_ror:4 row_mask:0xf bank_mask:0xf
  s_nop 1
  v_add_u32_dpp v50, v50, v50 row_ror:8 row_mask:0xf bank_mask:0xf
  s_nop 0
  v_readlane_b32 s100, v50, 0
  v_readlane_b32 s101, v50, 16
  s_add_u32 s100, s100, s101
  s_sub_i32 s100, s100, 1027
  s_ashr_i32 s37, s100, 1
  s_add_i32 s101, s100, 32
  s_mul_i32 s101, s101, -20
  s_ashr_i32 s101, s101, 8
  s_min_i32 s101, s101, 4
  s_add_i32 s80, s101, 37
  s_max_i32 s80, s80, s3
  s_mul_i32 s100, s100, 24
  s_ashr_i32 s100, s100, 8
  s_min_i32 s100, s100, 8
  s_add_i32 s14, s100, 37
  v_lshlrev_b32 v52, 16, v80
  v_and_b32 v53, 0xffff0000, v80
  v_lshlrev_b32 v54, 16, v81
  v_and_b32 v55, 0xffff0000, v81
  v_fma_f32 v52, v52, s71, v26
  v_fma_f32 v53, v53, s71, v26
  v_fma_f32 v54, v54, s71, v26
  v_fma_f32 v55, v55, s71, v26
  v_exp_f32 v52, v52
  v_exp_f32 v53, v53
  v_exp_f32 v54, v54
  v_exp_f32 v55, v55
  v_cvt_pk_bf16_f32 v80, v52, v53
  v_cvt_pk_bf16_f32 v81, v54, v55
  s_waitcnt lgkmcnt(0)
  v_mfma_f32_16x16x32_bf16 a[96:99], a[32:35], v[68:71], 0
  v_mfma_f32_16x16x32_bf16 a[100:103], a[36:39], v[68:71], 0
  v_mfma_f32_16x16x32_bf16 a[104:107], a[40:43], v[68:71], 0
  v_mfma_f32_16x16x32_bf16 a[108:111], a[44:47], v[68:71], 0
  s_waitcnt vmcnt(9)
  s_cbranch_vccnz L_b155
  s_waitcnt vmcnt(8)
  s_bitcmp0_b32 s77, 31
  s_cbranch_scc1 L_b155
  s_cmp_gt_i32 s80, 36
  s_cbranch_scc0 L_n155
  s_waitcnt vmcnt(5)
L_n155:
  s_waitcnt vmcnt(6)
L_b155:
  buffer_load_dwordx4 v11, s[24:27], s65 offen offset:3072 nt lds
  s_mov_b32 s18, 33792
  buffer_load_dword v185, v182, s[44:47], s18 offen sc1
  v_lshlrev_b32 v52, 16, v82
  v_and_b32 v53, 0xffff0000, v82
  v_lshlrev_b32 v54, 16, v83
  v_and_b32 v55, 0xffff0000, v83
  v_fma_f32 v52, v52, s71, v26
  v_fma_f32 v53, v53, s71, v26
  v_fma_f32 v54, v54, s71, v26
  v_fma_f32 v55, v55, s71, v26
  v_exp_f32 v52, v52
  v_exp_f32 v53, v53
  v_exp_f32 v54, v54
  v_exp_f32 v55, v55
  v_cvt_pk_bf16_f32 v82, v52, v53
  v_cvt_pk_bf16_f32 v83, v54, v55
  s_nop 1
  v_mfma_f32_16x16x32_bf16 a[128:131], v[56:59], v[80:83], a[128:131]
  v_mfma_f32_16x16x32_bf16 a[112:115], a[48:51], v[68:71], 0
  v_mfma_f32_16x16x32_bf16 a[116:119], a[52:55], v[68:71], 0
  v_mfma_f32_16x16x32_bf16 a[120:123], a[56:59], v[68:71], 0
  v_mfma_f32_16x16x32_bf16 a[124:127], a[60:63], v[68:71], 0
  s_xor_b32 s65, s64, 0x24000
  s_add_u32 m0, s66, 8192
  s_sub_i32 s77, s36, 38
  s_cmp_gt_i32 s14, 37
  s_cselect_b64 vcc, -1, 0
  s_waitcnt vmcnt(10)
  s_cbranch_vccnz L_b156
  s_waitcnt vmcnt(8)
  s_bitcmp0_b32 s77, 31
  s_cbranch_scc1 L_b156
  s_cmp_gt_i32 s80, 37
  s_cbranch_scc0 L_n156
  s_waitcnt vmcnt(5)
L_n156:
  s_waitcnt vmcnt(7)
L_b156:
  buffer_load_dwordx4 v10, s[24:27], s65 offen offset:0 nt lds
  v_lshlrev_b32 v52, 16, v84
  v_and_b32 v53, 0xffff0000, v84
  v_lshlrev_b32 v54, 16, v85
  v_and_b32 v55, 0xffff0000, v85
  v_fma_f32 v52, v52, s71, v26
  v_fma_f32 v53, v53, s71, v26
  v_fma_f32 v54, v54, s71, v26
  v_fma_f32 v55, v55, s71, v26
  v_exp_f32 v52, v52
  v_exp_f32 v53, v53
  v_exp_f32 v54, v54
  v_exp_f32 v55, v55
  v_cvt_pk_bf16_f32 v84, v52, v53
  v_cvt_pk_bf16_f32 v85, v54, v55
  s_waitcnt vmcnt(9)
  s_cbranch_vccnz L_b157
  s_waitcnt vmcnt(8)
  s_bitcmp0_b32 s77, 31
  s_cbranch_scc1 L_b157
  s_cmp_gt_i32 s80, 37
  s_cbranch_scc0 L_n157
  s_waitcnt vmcnt(5)
L_n157:
  s_waitcnt vmcnt(6)
L_b157:
  buffer_load_dwordx4 v11, s[24:27], s65 offen offset:1024 nt lds
  s_cmp_eq_u32 s15, 1
  s_cselect_b32 s18, s16, 0x400000
  v_or_b32 v8, 37, v9
  buffer_store_dword v8, v6, s[44:47], s18 offen
  v_lshlrev_b32 v52, 16, v86
  v_and_b32 v53, 0xffff0000, v86
  v_lshlrev_b32 v54, 16, v87
  v_and_b32 v55, 0xffff0000, v87
  v_fma_f32 v52, v52, s71, v26
  v_fma_f32 v53, v53, s71, v26
  v_fma_f32 v54, v54, s71, v26
  v_fma_f32 v55, v55, s71, v26
  v_exp_f32 v52, v52
  v_exp_f32 v53, v53
  v_exp_f32 v54, v54
  v_exp_f32 v55, v55
  v_cvt_pk_bf16_f32 v86, v52, v53
  v_cvt_pk_bf16_f32 v87, v54, v55
  s_nop 1
  v_mfma_f32_16x16x32_bf16 a[128:131], v[56:59], v[84:87], a[128:131]
  ds_read_b64_tr_b16 a[32:33], v16 offset:24576
  ds_read_b64_tr_b16 a[36:37], v17 offset:24576
  ds_read_b64_tr_b16 a[40:41], v18 offset:24576
  ds_read_b64_tr_b16 a[44:45], v19 offset:24576
  ds_read_b64_tr_b16 a[48:49], v20 offset:24576
  ds_read_b64_tr_b16 a[52:53], v21 offset:24576
  ds_read_b64_tr_b16 a[56:57], v22 offset:24576
  ds_read_b64_tr_b16 a[60:61], v23 offset:24576
  s_waitcnt vmcnt(10)
  s_cbranch_vccnz L_b158
  s_waitcnt vmcnt(8)
  s_bitcmp0_b32 s77, 31
  s_cbranch_scc1 L_b158
  s_cmp_gt_i32 s80, 37
  s_cbranch_scc0 L_n158
  s_waitcnt vmcnt(5)
L_n158:
  s_waitcnt vmcnt(7)
L_b158:
  buffer_load_dwordx4 v10, s[24:27], s65 offen offset:2048 nt lds
  v_lshlrev_b32 v52, 16, v88
  v_and_b32 v53, 0xffff0000, v88
  v_lshlrev_b32 v54, 16, v89
  v_and_b32 v55, 0xffff0000, v89
  v_fma_f32 v52, v52, s71, v26
  v_fma_f32 v53, v53, s71, v26
  v_fma_f32 v54, v54, s71, v26
  v_fma_f32 v55, v55, s71, v26
  v_exp_f32 v52, v52
  v_exp_f32 v53, v53
  v_exp_f32 v54, v54
  v_exp_f32 v55, v55
  v_cvt_pk_bf16_f32 v88, v52, v53
  v_cvt_pk_bf16_f32 v89, v54, v55
  s_waitcnt vmcnt(9)
  s_cbranch_vccnz L_b159
  s_waitcnt vmcnt(8)
  s_bitcmp0_b32 s77, 31
  s_cbranch_scc1 L_b159
  s_cmp_gt_i32 s80, 37
  s_cbranch_scc0 L_n159
  s_waitcnt vmcnt(5)
L_n159:
  s_waitcnt vmcnt(6)
L_b159:
  buffer_load_dwordx4 v11, s[24:27], s65 offen offset:3072 nt lds
  s_mov_b32 s18, 33792
  buffer_load_dword v186, v182, s[44:47], s18 offen sc1
  v_lshlrev_b32 v52, 16, v90
  v_and_b32 v53, 0xffff0000, v90
  v_lshlrev_b32 v54, 16, v91
  v_and_b32 v55, 0xffff0000, v91
  v_fma_f32 v52, v52, s71, v26
  v_fma_f32 v53, v53, s71, v26
  v_fma_f32 v54, v54, s71, v26
  v_fma_f32 v55, v55, s71, v26
  v_exp_f32 v52, v52
  v_exp_f32 v53, v53
  v_exp_f32 v54, v54
  v_exp_f32 v55, v55
  v_cvt_pk_bf16_f32 v90, v52, v53
  v_cvt_pk_bf16_f32 v91, v54, v55
  s_nop 1
  v_mfma_f32_16x16x32_bf16 a[128:131], v[56:59], v[88:91], a[128:131]
  s_xor_b32 s65, s64, 0x420000
  s_add_u32 m0, s66, 12288
  s_sub_i32 s77, s36, 39
  s_cmp_gt_i32 s14, 38
  s_cselect_b64 vcc, -1, 0
  s_waitcnt vmcnt(10)
  s_cbranch_vccnz L_b160
  s_waitcnt vmcnt(8)
  s_bitcmp0_b32 s77, 31
  s_cbranch_scc1 L_b160
  s_cmp_gt_i32 s80, 38
  s_cbranch_scc0 L_n160
  s_waitcnt vmcnt(5)
L_n160:
  s_waitcnt vmcnt(7)
L_b160:
  buffer_load_dwordx4 v10, s[24:27], s65 offen offset:0 nt lds
  v_lshlrev_b32 v52, 16, v92
  v_and_b32 v53, 0xffff0000, v92
  v_lshlrev_b32 v54, 16, v93
  v_and_b32 v55, 0xffff0000, v93
  v_fma_f32 v52, v52, s71, v26
  v_fma_f32 v53, v53, s71, v26
  v_fma_f32 v54, v54, s71, v26
  v_fma_f32 v55, v55, s71, v26
  v_exp_f32 v52, v52
  v_exp_f32 v53, v53
  v_exp_f32 v54, v54
  v_exp_f32 v55, v55
  v_cvt_pk_bf16_f32 v92, v52, v53
  v_cvt_pk_bf16_f32 v93, v54, v55
  s_waitcnt vmcnt(9)
  s_cbranch_vccnz L_b161
  s_waitcnt vmcnt(8)
  s_bitcmp0_b32 s77, 31
  s_cbranch_scc1 L_b161
  s_cmp_gt_i32 s80, 38
  s_cbranch_scc0 L_n161
  s_waitcnt vmcnt(5)
L_n161:
  s_waitcnt vmcnt(6)
L_b161:
  buffer_load_dwordx4 v11, s[24:27], s65 offen offset:1024 nt lds
  s_cmp_eq_u32 s15, 2
  s_cselect_b32 s18, s16, 0x400000
  v_or_b32 v8, 38, v9
  buffer_store_dword v8, v6, s[44:47], s18 offen
  v_lshlrev_b32 v52, 16, v94
  v_and_b32 v53, 0xffff0000, v94
  v_lshlrev_b32 v54, 16, v95
  v_and_b32 v55, 0xffff0000, v95
  v_fma_f32 v52, v52, s71, v26
  v_fma_f32 v53, v53, s71, v26
  v_fma_f32 v54, v54, s71, v26
  v_fma_f32 v55, v55, s71, v26
  v_exp_f32 v52, v52
  v_exp_f32 v53, v53
  v_exp_f32 v54, v54
  v_exp_f32 v55, v55
  v_cvt_pk_bf16_f32 v94, v52, v53
  v_cvt_pk_bf16_f32 v95, v54, v55
  s_nop 1
  v_mfma_f32_16x16x32_bf16 a[128:131], v[56:59], v[92:95], a[128:131]
  ds_read_b64_tr_b16 a[34:35], v16 offset:0
  ds_read_b64_tr_b16 a[38:39], v17 offset:0
  ds_read_b64_tr_b16 a[42:43], v18 offset:0
  ds_read_b64_tr_b16 a[46:47], v19 offset:0
  ds_read_b64_tr_b16 a[50:51], v20 offset:0
  ds_read_b64_tr_b16 a[54:55], v21 offset:0
  ds_read_b64_tr_b16 a[58:59], v22 offset:0
  ds_read_b64_tr_b16 a[62:63], v23 offset:0
  s_waitcnt vmcnt(10)
  s_cbranch_vccnz L_b162
  s_waitcnt vmcnt(8)
  s_bitcmp0_b32 s77, 31
  s_cbranch_scc1 L_b162
  s_cmp_gt_i32 s80, 38
  s_cbranch_scc0 L_n162
  s_waitcnt vmcnt(5)
L_n162:
  s_waitcnt vmcnt(7)
L_b162:
  buffer_load_dwordx4 v10, s[24:27], s65 offen offset:2048 nt lds
  buffer_load_dword v50, v7, s[44:47], 0 offen sc1
  s_bitcmp1_b32 s38, 30
  s_cbranch_scc1 L_gp1
  s_add_i32 s100, s37, 128
  s_max_i32 s100, s100, 0
  s_min_i32 s100, s100, 255
  s_mov_b32 s62, s100
  v_or_b32 v180, s100, v9
  s_add_u32 s18, s38, 33792
  buffer_store_dword v180, v6, s[44:47], s18 offen sc1
L_gp1:
  v_lshlrev_b32 v52, 16, v96
  v_and_b32 v53, 0xffff0000, v96
  v_lshlrev_b32 v54, 16, v97
  v_and_b32 v55, 0xffff0000, v97
  v_fma_f32 v52, v52, s71, v26
  v_fma_f32 v53, v53, s71, v26
  v_fma_f32 v54, v54, s71, v26
  v_fma_f32 v55, v55, s71, v26
  v_exp_f32 v52, v52
  v_exp_f32 v53, v53
  v_exp_f32 v54, v54
  v_exp_f32 v55, v55
  v_cvt_pk_bf16_f32 v96, v52, v53
  v_cvt_pk_bf16_f32 v97, v54, v55
  s_waitcnt lgkmcnt(0)
  v_mfma_f32_16x16x32_bf16 a[96:99], a[32:35], v[72:75], a[96:99]
  v_mfma_f32_16x16x32_bf16 a[100:103], a[36:39], v[72:75], a[100:103]
  v_mfma_f32_16x16x32_bf16 a[104:107], a[40:43], v[72:75], a[104:107]
  v_mfma_f32_16x16x32_bf16 a[108:111], a[44:47], v[72:75], a[108:111]
  s_waitcnt vmcnt(10)
  s_cbranch_vccnz L_b163
  s_waitcnt vmcnt(9)
  s_bitcmp0_b32 s77, 31
  s_cbranch_scc1 L_b163
  s_cmp_gt_i32 s80, 38
  s_cbranch_scc0 L_n163
  s_waitcnt vmcnt(6)
L_n163:
  s_waitcnt vmcnt(7)
L_b163:
  buffer_load_dwordx4 v11, s[24:27], s65 offen offset:3072 nt lds
  s_mov_b32 s18, 33792
  buffer_load_dword v187, v182, s[44:47], s18 offen sc1
  v_lshlrev_b32 v52, 16, v98
  v_and_b32 v53, 0xffff0000, v98
  v_lshlrev_b32 v54, 16, v99
  v_and_b32 v55, 0xffff0000, v99
  v_fma_f32 v52, v52, s71, v26
  v_fma_f32 v53, v53, s71, v26
  v_fma_f32 v54, v54, s71, v26
  v_fma_f32 v55, v55, s71, v26
  v_exp_f32 v52, v52
  v_exp_f32 v53, v53
  v_exp_f32 v54, v54
  v_exp_f32 v55, v55
  v_cvt_pk_bf16_f32 v98, v52, v53
  v_cvt_pk_bf16_f32 v99, v54, v55
  s_nop 1
  v_mfma_f32_16x16x32_bf16 a[128:131], v[56:59], v[96:99], a[128:131]
  v_mfma_f32_16x16x32_bf16 a[112:115], a[48:51], v[72:75], a[112:115]
  v_mfma_f32_16x16x32_bf16 a[116:119], a[52:55], v[72:75], a[116:119]
  v_mfma_f32_16x16x32_bf16 a[120:123], a[56:59], v[72:75], a[120:123]
  v_mfma_f32_16x16x32_bf16 a[124:127], a[60:63], v[72:75], a[124:127]
  s_xor_b32 s65, s64, 0x424000
  s_add_u32 m0, s66, 16384
  s_sub_i32 s77, s36, 40
  s_cmp_gt_i32 s14, 39
  s_cselect_b64 vcc, -1, 0
  s_waitcnt vmcnt(11)
  s_cbranch_vccnz L_b164
  s_waitcnt vmcnt(9)
  s_bitcmp0_b32 s77, 31
  s_cbranch_scc1 L_b164
  s_cmp_gt_i32 s80, 39
  s_cbranch_scc0 L_n164
  s_waitcnt vmcnt(6)
L_n164:
  s_waitcnt vmcnt(8)
L_b164:
  buffer_load_dwordx4 v10, s[24:27], s65 offen offset:0 nt lds
  v_lshlrev_b32 v52, 16, v100
  v_and_b32 v53, 0xffff0000, v100
  v_lshlrev_b32 v54, 16, v101
  v_and_b32 v55, 0xffff0000, v101
  v_fma_f32 v52, v52, s71, v26
  v_fma_f32 v53, v53, s71, v26
  v_fma_f32 v54, v54, s71, v26
  v_fma_f32 v55, v55, s71, v26
  v_exp_f32 v52, v52
  v_exp_f32 v53, v53
  v_exp_f32 v54, v54
  v_exp_f32 v55, v55
  v_cvt_pk_bf16_f32 v100, v52, v53
  v_cvt_pk_bf16_f32 v101, v54, v55
  s_waitcnt vmcnt(10)
  s_cbranch_vccnz L_b165
  s_waitcnt vmcnt(9)
  s_bitcmp0_b32 s77, 31
  s_cbranch_scc1 L_b165
  s_cmp_gt_i32 s80, 39
  s_cbranch_scc0 L_n165
  s_waitcnt vmcnt(6)
L_n165:
  s_waitcnt vmcnt(7)
L_b165:
  buffer_load_dwordx4 v11, s[24:27], s65 offen offset:1024 nt lds
  s_cmp_eq_u32 s15, 3
  s_cselect_b32 s18, s16, 0x400000
  v_or_b32 v8, 39, v9
  buffer_store_dword v8, v6, s[44:47], s18 offen
  v_lshlrev_b32 v52, 16, v102
  v_and_b32 v53, 0xffff0000, v102
  v_lshlrev_b32 v54, 16, v103
  v_and_b32 v55, 0xffff0000, v103
  v_fma_f32 v52, v52, s71, v26
  v_fma_f32 v53, v53, s71, v26
  v_fma_f32 v54, v54, s71, v26
  v_fma_f32 v55, v55, s71, v26
  v_exp_f32 v52, v52
  v_exp_f32 v53, v53
  v_exp_f32 v54, v54
  v_exp_f32 v55, v55
  v_cvt_pk_bf16_f32 v102, v52, v53
  v_cvt_pk_bf16_f32 v103, v54, v55
  s_nop 1
  v_mfma_f32_16x16x32_bf16 a[128:131], v[56:59], v[100:103], a[128:131]
  s_waitcnt vmcnt(11)
  s_cbranch_vccnz L_b166
  s_waitcnt vmcnt(9)
  s_bitcmp0_b32 s77, 31
  s_cbranch_scc1 L_b166
  s_cmp_gt_i32 s80, 39
  s_cbranch_scc0 L_n166
  s_waitcnt vmcnt(6)
L_n166:
  s_waitcnt vmcnt(8)
L_b166:
  buffer_load_dwordx4 v10, s[24:27], s65 offen offset:2048 nt lds
  v_lshlrev_b32 v52, 16, v104
  v_and_b32 v53, 0xffff0000, v104
  v_lshlrev_b32 v54, 16, v105
  v_and_b32 v55, 0xffff0000, v105
  v_fma_f32 v52, v52, s71, v26
  v_fma_f32 v53, v53, s71, v26
  v_fma_f32 v54, v54, s71, v26
  v_fma_f32 v55, v55, s71, v26
  v_exp_f32 v52, v52
  v_exp_f32 v53, v53
  v_exp_f32 v54, v54
  v_exp_f32 v55, v55
  v_cvt_pk_bf16_f32 v104, v52, v53
  v_cvt_pk_bf16_f32 v105, v54, v55
  s_waitcnt vmcnt(10)
  s_cbranch_vccnz L_b167
  s_waitcnt vmcnt(9)
  s_bitcmp0_b32 s77, 31
  s_cbranch_scc1 L_b167
  s_cmp_gt_i32 s80, 39
  s_cbranch_scc0 L_n167
  s_waitcnt vmcnt(5)
L_n167:
  s_waitcnt vmcnt(7)
L_b167:
  buffer_load_dwordx4 v11, s[24:27], s65 offen offset:3072 nt lds
  s_mov_b32 s18, 33792
  buffer_load_dword v188, v182, s[44:47], s18 offen sc1
  v_lshlrev_b32 v52, 16, v106
  v_and_b32 v53, 0xffff0000, v106
  v_lshlrev_b32 v54, 16, v107
  v_and_b32 v55, 0xffff0000, v107
  v_fma_f32 v52, v52, s71, v26
  v_fma_f32 v53, v53, s71, v26
  v_fma_f32 v54, v54, s71, v26
  v_fma_f32 v55, v55, s71, v26
  v_exp_f32 v52, v52
  v_exp_f32 v53, v53
  v_exp_f32 v54, v54
  v_exp_f32 v55, v55
  v_cvt_pk_bf16_f32 v106, v52, v53
  v_cvt_pk_bf16_f32 v107, v54, v55
  s_nop 1
  v_mfma_f32_16x16x32_bf16 a[128:131], v[56:59], v[104:107], a[128:131]
  ds_read_b64_tr_b16 a[32:33], v16 offset:4096
  ds_read_b64_tr_b16 a[36:37], v17 offset:4096
  ds_read_b64_tr_b16 a[40:41], v18 offset:4096
  ds_read_b64_tr_b16 a[44:45], v19 offset:4096
  ds_read_b64_tr_b16 a[48:49], v20 offset:4096
  ds_read_b64_tr_b16 a[52:53], v21 offset:4096
  ds_read_b64_tr_b16 a[56:57], v22 offset:4096
  ds_read_b64_tr_b16 a[60:61], v23 offset:4096
  s_xor_b32 s65, s64, 0x40000
  s_add_u32 m0, s66, 20480
  s_sub_i32 s77, s36, 41
  s_cmp_gt_i32 s14, 40
  s_cselect_b64 vcc, -1, 0
  s_waitcnt vmcnt(11)
  s_cbranch_vccnz L_b168
  s_waitcnt vmcnt(9)
  s_bitcmp0_b32 s77, 31
  s_cbranch_scc1 L_b168
  s_cmp_gt_i32 s80, 40
  s_cbranch_scc0 L_n168
  s_waitcnt vmcnt(5)
L_n168:
  s_waitcnt vmcnt(7)
L_b168:
  buffer_load_dwordx4 v10, s[24:27], s65 offen offset:0 nt lds
  v_lshlrev_b32 v52, 16, v108
  v_and_b32 v53, 0xffff0000, v108
  v_lshlrev_b32 v54, 16, v109
  v_and_b32 v55, 0xffff0000, v109
  v_fma_f32 v52, v52, s71, v26
  v_fma_f32 v53, v53, s71, v26
  v_fma_f32 v54, v54, s71, v26
  v_fma_f32 v55, v55, s71, v26
  v_exp_f32 v52, v52
  v_exp_f32 v53, v53
  v_exp_f32 v54, v54
  v_exp_f32 v55, v55
  v_cvt_pk_bf16_f32 v108, v52, v53
  v_cvt_pk_bf16_f32 v109, v54, v55
  s_waitcnt vmcnt(10)
  s_cbranch_vccnz L_b169
  s_waitcnt vmcnt(8)
  s_bitcmp0_b32 s77, 31
  s_cbranch_scc1 L_b169
  s_cmp_gt_i32 s80, 40
  s_cbranch_scc0 L_n169
  s_waitcnt vmcnt(5)
L_n169:
  s_waitcnt vmcnt(6)
L_b169:
  buffer_load_dwordx4 v11, s[24:27], s65 offen offset:1024 nt lds
  s_cmp_eq_u32 s15, 0
  s_cselect_b32 s18, s16, 0x400000
  v_or_b32 v8, 40, v9
  buffer_store_dword v8, v6, s[44:47], s18 offen
  v_lshlrev_b32 v52, 16, v110
  v_and_b32 v53, 0xffff0000, v110
  v_lshlrev_b32 v54, 16, v111
  v_and_b32 v55, 0xffff0000, v111
  v_fma_f32 v52, v52, s71, v26
  v_fma_f32 v53, v53, s71, v26
  v_fma_f32 v54, v54, s71, v26
  v_fma_f32 v55, v55, s71, v26
  v_exp_f32 v52, v52
  v_exp_f32 v53, v53
  v_exp_f32 v54, v54
  v_exp_f32 v55, v55
  v_cvt_pk_bf16_f32 v110, v52, v53
  v_cvt_pk_bf16_f32 v111, v54, v55
  s_nop 1
  v_mfma_f32_16x16x32_bf16 a[128:131], v[56:59], v[108:111], a[128:131]
  s_waitcnt vmcnt(10)
  s_cbranch_vccnz L_b170
  s_waitcnt vmcnt(8)
  s_bitcmp0_b32 s77, 31
  s_cbranch_scc1 L_b170
  s_cmp_gt_i32 s80, 40
  s_cbranch_scc0 L_n170
  s_waitcnt vmcnt(5)
L_n170:
  s_waitcnt vmcnt(7)
L_b170:
  buffer_load_dwordx4 v10, s[24:27], s65 offen offset:2048 nt lds
  v_xor_b32 v50, s17, v50
  v_lshrrev_b32 v51, 8, v50
  v_cmp_eq_u32 s[82:83], 0, v51
  v_mov_b32 v51, 36
  s_nop 0
  v_cndmask_b32 v50, v51, v50, s[82:83]
  s_nop 1
  v_add_u32_dpp v50, v50, v50 row_ror:1 row_mask:0xf bank_mask:0xf
  s_nop 1
  v_add_u32_dpp v50, v50, v50 row_ror:2 row_mask:0xf bank_mask:0xf
  s_nop 1
  v_add_u32_dpp v50, v50, v50 row_ror:4 row_mask:0xf bank_mask:0xf
  s_nop 1
  v_add_u32_dpp v50, v50, v50 row_ror:8 row_mask:0xf bank_mask:0xf
  s_nop 0
  v_readlane_b32 s100, v50, 0
  v_readlane_b32 s101, v50, 16
  s_add_u32 s100, s100, s101
  s_sub_i32 s100, s100, 1155
  s_ashr_i32 s37, s100, 1
  s_add_i32 s62, s37, 128
  s_add_i32 s101, s100, 32
  s_mul_i32 s101, s101, -20
  s_ashr_i32 s101, s101, 8
  s_min_i32 s101, s101, 4
  s_add_i32 s80, s101, 41
  s_max_i32 s80, s80, s3
  s_mul_i32 s100, s100, 24
  s_ashr_i32 s100, s100, 8
  s_min_i32 s100, s100, 8
  s_add_i32 s14, s100, 41
  v_lshlrev_b32 v52, 16, v112
  v_and_b32 v53, 0xffff0000, v112
  v_lshlrev_b32 v54, 16, v113
  v_and_b32 v55, 0xffff0000, v113
  v_fma_f32 v52, v52, s71, v26
  v_fma_f32 v53, v53, s71, v26
  v_fma_f32 v54, v54, s71, v26
  v_fma_f32 v55, v55, s71, v26
  v_exp_f32 v52, v52
  v_exp_f32 v53, v53
  v_exp_f32 v54, v54
  v_exp_f32 v55, v55
  v_cvt_pk_bf16_f32 v112, v52, v53
  v_cvt_pk_bf16_f32 v113, v54, v55
  ds_read_b64_tr_b16 a[34:35], v16 offset:8192
  ds_read_b64_tr_b16 a[38:39], v17 offset:8192
  ds_read_b64_tr_b16 a[42:43], v18 offset:8192
  ds_read_b64_tr_b16 a[46:47], v19 offset:8192
  ds_read_b64_tr_b16 a[50:51], v20 offset:8192
  ds_read_b64_tr_b16 a[54:55], v21 offset:8192
  ds_read_b64_tr_b16 a[58:59], v22 offset:8192
  ds_read_b64_tr_b16 a[62:63], v23 offset:8192
  s_waitcnt vmcnt(9)
  s_cbranch_vccnz L_b171
  s_waitcnt vmcnt(8)
  s_bitcmp0_b32 s77, 31
  s_cbranch_scc1 L_b171
  s_cmp_gt_i32 s80, 40
  s_cbranch_scc0 L_n171
  s_waitcnt vmcnt(5)
L_n171:
  s_waitcnt vmcnt(6)
L_b171:
  buffer_load_dwordx4 v11, s[24:27], s65 offen offset:3072 nt lds
  s_mov_b32 s18, 33792
  buffer_load_dword v189, v182, s[44:47], s18 offen sc1
  v_lshlrev_b32 v52, 16, v114
  v_and_b32 v53, 0xffff0000, v114
  v_lshlrev_b32 v54, 16, v115
  v_and_b32 v55, 0xffff0000, v115
  v_fma_f32 v52, v52, s71, v26
  v_fma_f32 v53, v53, s71, v26
  v_fma_f32 v54, v54, s71, v26
  v_fma_f32 v55, v55, s71, v26
  v_exp_f32 v52, v52
  v_exp_f32 v53, v53
  v_exp_f32 v54, v54
  v_exp_f32 v55, v55
  v_cvt_pk_bf16_f32 v114, v52, v53
  v_cvt_pk_bf16_f32 v115, v54, v55
  s_nop 1
  v_mfma_f32_16x16x32_bf16 a[128:131], v[56:59], v[112:115], a[128:131]
  s_waitcnt lgkmcnt(0)
  v_mfma_f32_16x16x32_bf16 a[96:99], a[32:35], v[76:79], a[96:99]
  v_mfma_f32_16x16x32_bf16 a[100:103], a[36:39], v[76:79], a[100:103]
  v_mfma_f32_16x16x32_bf16 a[104:107], a[40:43], v[76:79], a[104:107]
  v_mfma_f32_16x16x32_bf16 a[108:111], a[44:47], v[76:79], a[108:111]
  s_xor_b32 s65, s64, 0x44000
  s_add_u32 m0, s66, 24576
  s_sub_i32 s77, s36, 42
  s_cmp_gt_i32 s14, 41
  s_cselect_b64 vcc, -1, 0
  s_waitcnt vmcnt(10)
  s_cbranch_vccnz L_b172
  s_waitcnt vmcnt(8)
  s_bitcmp0_b32 s77, 31
  s_cbranch_scc1 L_b172
  s_cmp_gt_i32 s80, 41
  s_cbranch_scc0 L_n172
  s_waitcnt vmcnt(5)
L_n172:
  s_waitcnt vmcnt(7)
L_b172:
  buffer_load_dwordx4 v10, s[24:27], s65 offen offset:0 nt lds
  v_lshlrev_b32 v52, 16, v116
  v_and_b32 v53, 0xffff0000, v116
  v_lshlrev_b32 v54, 16, v117
  v_and_b32 v55, 0xffff0000, v117
  v_fma_f32 v52, v52, s71, v26
  v_fma_f32 v53, v53, s71, v26
  v_fma_f32 v54, v54, s71, v26
  v_fma_f32 v55, v55, s71, v26
  v_exp_f32 v52, v52
  v_exp_f32 v53, v53
  v_exp_f32 v54, v54
  v_exp_f32 v55, v55
  v_cvt_pk_bf16_f32 v116, v52, v53
  v_cvt_pk_bf16_f32 v117, v54, v55
  v_mfma_f32_16x16x32_bf16 a[112:115], a[48:51], v[76:79], a[112:115]
  v_mfma_f32_16x16x32_bf16 a[116:119], a[52:55], v[76:79], a[116:119]
  v_mfma_f32_16x16x32_bf16 a[120:123], a[56:59], v[76:79], a[120:123]
  v_mfma_f32_16x16x32_bf16 a[124:127], a[60:63], v[76:79], a[124:127]
  s_waitcnt vmcnt(9)
  s_cbranch_vccnz L_b173
  s_waitcnt vmcnt(8)
  s_bitcmp0_b32 s77, 31
  s_cbranch_scc1 L_b173
  s_cmp_gt_i32 s80, 41
  s_cbranch_scc0 L_n173
  s_waitcnt vmcnt(5)
L_n173:
  s_waitcnt vmcnt(6)
L_b173:
  buffer_load_dwordx4 v11, s[24:27], s65 offen offset:1024 nt lds
  s_cmp_eq_u32 s15, 1
  s_cselect_b32 s18, s16, 0x400000
  v_or_b32 v8, 41, v9
  buffer_store_dword v8, v6, s[44:47], s18 offen
  v_lshlrev_b32 v52, 16, v118
  v_and_b32 v53, 0xffff0000, v118
  v_lshlrev_b32 v54, 16, v119
  v_and_b32 v55, 0xffff0000, v119
  v_fma_f32 v52, v52, s71, v26
  v_fma_f32 v53, v53, s71, v26
  v_fma_f32 v54, v54, s71, v26
  v_fma_f32 v55, v55, s71, v26
  v_exp_f32 v52, v52
  v_exp_f32 v53, v53
  v_exp_f32 v54, v54
  v_exp_f32 v55, v55
  v_cvt_pk_bf16_f32 v118, v52, v53
  v_cvt_pk_bf16_f32 v119, v54, v55
  s_nop 1
  v_mfma_f32_16x16x32_bf16 a[128:131], v[56:59], v[116:119], a[128:131]
  ds_read_b64_tr_b16 a[32:33], v16 offset:12288
  ds_read_b64_tr_b16 a[36:37], v17 offset:12288
  ds_read_b64_tr_b16 a[40:41], v18 offset:12288
  ds_read_b64_tr_b16 a[44:45], v19 offset:12288
  ds_read_b64_tr_b16 a[48:49], v20 offset:12288
  ds_read_b64_tr_b16 a[52:53], v21 offset:12288
  ds_read_b64_tr_b16 a[56:57], v22 offset:12288
  ds_read_b64_tr_b16 a[60:61], v23 offset:12288
  s_waitcnt vmcnt(10)
  s_cbranch_vccnz L_b174
  s_waitcnt vmcnt(8)
  s_bitcmp0_b32 s77, 31
  s_cbranch_scc1 L_b174
  s_cmp_gt_i32 s80, 41
  s_cbranch_scc0 L_n174
  s_waitcnt vmcnt(5)
L_n174:
  s_waitcnt vmcnt(7)
L_b174:
  buffer_load_dwordx4 v10, s[24:27], s65 offen offset:2048 nt lds
  v_lshlrev_b32 v52, 16, v120
  v_and_b32 v53, 0xffff0000, v120
  v_lshlrev_b32 v54, 16, v121
  v_and_b32 v55, 0xffff0000, v121
  v_fma_f32 v52, v52, s71, v26
  v_fma_f32 v53, v53, s71, v26
  v_fma_f32 v54, v54, s71, v26
  v_fma_f32 v55, v55, s71, v26
  v_exp_f32 v52, v52
  v_exp_f32 v53, v53
  v_exp_f32 v54, v54
  v_exp_f32 v55, v55
  v_cvt_pk_bf16_f32 v120, v52, v53
  v_cvt_pk_bf16_f32 v121, v54, v55
  s_waitcnt vmcnt(9)
  s_cbranch_vccnz L_b175
  s_waitcnt vmcnt(8)
  s_bitcmp0_b32 s77, 31
  s_cbranch_scc1 L_b175
  s_cmp_gt_i32 s80, 41
  s_cbranch_scc0 L_n175
  s_waitcnt vmcnt(5)
L_n175:
  s_waitcnt vmcnt(6)
L_b175:
  buffer_load_dwordx4 v11, s[24:27], s65 offen offset:3072 nt lds
  s_mov_b32 s18, 33792
  buffer_load_dword v190, v182, s[44:47], s18 offen sc1
  v_lshlrev_b32 v52, 16, v122
  v_and_b32 v53, 0xffff0000, v122
  v_lshlrev_b32 v54, 16, v123
  v_and_b32 v55, 0xffff0000, v123
  v_fma_f32 v52, v52, s71, v26
  v_fma_f32 v53, v53, s71, v26
  v_fma_f32 v54, v54, s71, v26
  v_fma_f32 v55, v55, s71, v26
  v_exp_f32 v52, v52
  v_exp_f32 v53, v53
  v_exp_f32 v54, v54
  v_exp_f32 v55, v55
  v_cvt_pk_bf16_f32 v122, v52, v53
  v_cvt_pk_bf16_f32 v123, v54, v55
  s_nop 1
  v_mfma_f32_16x16x32_bf16 a[128:131], v[56:59], v[120:123], a[128:131]
  s_xor_b32 s65, s64, 0x440000
  s_add_u32 m0, s66, 0
  s_sub_i32 s77, s36, 43
  s_cmp_gt_i32 s14, 42
  s_cselect_b64 vcc, -1, 0
  s_waitcnt vmcnt(10)
  s_cbranch_vccnz L_b176
  s_waitcnt vmcnt(8)
  s_bitcmp0_b32 s77, 31
  s_cbranch_scc1 L_b176
  s_cmp_gt_i32 s80, 42
  s_cbranch_scc0 L_n176
  s_waitcnt vmcnt(5)
L_n176:
  s_waitcnt vmcnt(7)
L_b176:
  buffer_load_dwordx4 v10, s[24:27], s65 offen offset:0 nt lds
  v_lshlrev_b32 v52, 16, v124
  v_and_b32 v53, 0xffff0000, v124
  v_lshlrev_b32 v54, 16, v125
  v_and_b32 v55, 0xffff0000, v125
  v_fma_f32 v52, v52, s71, v26
  v_fma_f32 v53, v53, s71, v26
  v_fma_f32 v54, v54, s71, v26
  v_fma_f32 v55, v55, s71, v26
  v_exp_f32 v52, v52
  v_exp_f32 v53, v53
  v_exp_f32 v54, v54
  v_exp_f32 v55, v55
  v_cvt_pk_bf16_f32 v124, v52, v53
  v_cvt_pk_bf16_f32 v125, v54, v55
  s_waitcnt vmcnt(9)
  s_cbranch_vccnz L_b177
  s_waitcnt vmcnt(8)
  s_bitcmp0_b32 s77, 31
  s_cbranch_scc1 L_b177
  s_cmp_gt_i32 s80, 42
  s_cbranch_scc0 L_n177
  s_waitcnt vmcnt(5)
L_n177:
  s_waitcnt vmcnt(6)
L_b177:
  buffer_load_dwordx4 v11, s[24:27], s65 offen offset:1024 nt lds
  s_cmp_eq_u32 s15, 2
  s_cselect_b32 s18, s16, 0x400000
  v_or_b32 v8, 42, v9
  buffer_store_dword v8, v6, s[44:47], s18 offen
  v_lshlrev_b32 v52, 16, v126
  v_and_b32 v53, 0xffff0000, v126
  v_lshlrev_b32 v54, 16, v127
  v_and_b32 v55, 0xffff0000, v127
  v_fma_f32 v52, v52, s71, v26
  v_fma_f32 v53, v53, s71, v26
  v_fma_f32 v54, v54, s71, v26
  v_fma_f32 v55, v55, s71, v26
  v_exp_f32 v52, v52
  v_exp_f32 v53, v53
  v_exp_f32 v54, v54
  v_exp_f32 v55, v55
  v_cvt_pk_bf16_f32 v126, v52, v53
  v_cvt_pk_bf16_f32 v127, v54, v55
  s_nop 1
  v_mfma_f32_16x16x32_bf16 a[128:131], v[56:59], v[124:127], a[128:131]
  ds_read_b64_tr_b16 a[34:35], v16 offset:16384
  ds_read_b64_tr_b16 a[38:39], v17 offset:16384
  ds_read_b64_tr_b16 a[42:43], v18 offset:16384
  ds_read_b64_tr_b16 a[46:47], v19 offset:16384
  ds_read_b64_tr_b16 a[50:51], v20 offset:16384
  ds_read_b64_tr_b16 a[54:55], v21 offset:16384
  ds_read_b64_tr_b16 a[58:59], v22 offset:16384
  ds_read_b64_tr_b16 a[62:63], v23 offset:16384
  s_waitcnt vmcnt(10)
  s_cbranch_vccnz L_b178
  s_waitcnt vmcnt(8)
  s_bitcmp0_b32 s77, 31
  s_cbranch_scc1 L_b178
  s_cmp_gt_i32 s80, 42
  s_cbranch_scc0 L_n178
  s_waitcnt vmcnt(5)
L_n178:
  s_waitcnt vmcnt(7)
L_b178:
  buffer_load_dwordx4 v10, s[24:27], s65 offen offset:2048 nt lds
  buffer_load_dword v50, v7, s[44:47], 0 offen sc1
  v_lshlrev_b32 v52, 16, v128
  v_and_b32 v53, 0xffff0000, v128
  v_lshlrev_b32 v54, 16, v129
  v_and_b32 v55, 0xffff0000, v129
  v_fma_f32 v52, v52, s71, v26
  v_fma_f32 v53, v53, s71, v26
  v_fma_f32 v54, v54, s71, v26
  v_fma_f32 v55, v55, s71, v26
  v_exp_f32 v52, v52
  v_exp_f32 v53, v53
  v_exp_f32 v54, v54
  v_exp_f32 v55, v55
  v_cvt_pk_bf16_f32 v128, v52, v53
  v_cvt_pk_bf16_f32 v129, v54, v55
  s_waitcnt lgkmcnt(0)
  v_mfma_f32_16x16x32_bf16 a[96:99], a[32:35], v[80:83], a[96:99]
  v_mfma_f32_16x16x32_bf16 a[100:103], a[36:39], v[80:83], a[100:103]
  v_mfma_f32_16x16x32_bf16 a[104:107], a[40:43], v[80:83], a[104:107]
  v_mfma_f32_16x16x32_bf16 a[108:111], a[44:47], v[80:83], a[108:111]
  s_waitcnt vmcnt(10)
  s_cbranch_vccnz L_b179
  s_waitcnt vmcnt(9)
  s_bitcmp0_b32 s77, 31
  s_cbranch_scc1 L_b179
  s_cmp_gt_i32 s80, 42
  s_cbranch_scc0 L_n179
  s_waitcnt vmcnt(6)
L_n179:
  s_waitcnt vmcnt(7)
L_b179:
  buffer_load_dwordx4 v11, s[24:27], s65 offen offset:3072 nt lds
  s_mov_b32 s18, 33792
  buffer_load_dword v191, v182, s[44:47], s18 offen sc1
  v_lshlrev_b32 v52, 16, v130
  v_and_b32 v53, 0xffff0000, v130
  v_lshlrev_b32 v54, 16, v131
  v_and_b32 v55, 0xffff0000, v131
  v_fma_f32 v52, v52, s71, v26
  v_fma_f32 v53, v53, s71, v26
  v_fma_f32 v54, v54, s71, v26
  v_fma_f32 v55, v55, s71, v26
  v_exp_f32 v52, v52
  v_exp_f32 v53, v53
  v_exp_f32 v54, v54
  v_exp_f32 v55, v55
  v_cvt_pk_bf16_f32 v130, v52, v53
  v_cvt_pk_bf16_f32 v131, v54, v55
  s_nop 1
  v_mfma_f32_16x16x32_bf16 a[128:131], v[56:59], v[128:131], a[128:131]
  v_mfma_f32_16x16x32_bf16 a[112:115], a[48:51], v[80:83], a[112:115]
  v_mfma_f32_16x16x32_bf16 a[116:119], a[52:55], v[80:83], a[116:119]
  v_mfma_f32_16x16x32_bf16 a[120:123], a[56:59], v[80:83], a[120:123]
  v_mfma_f32_16x16x32_bf16 a[124:127], a[60:63], v[80:83], a[124:127]
  s_xor_b32 s65, s64, 0x444000
  s_add_u32 m0, s66, 4096
  s_sub_i32 s77, s36, 44
  s_cmp_gt_i32 s14, 43
  s_cselect_b64 vcc, -1, 0
  s_waitcnt vmcnt(11)
  s_cbranch_vccnz L_b180
  s_waitcnt vmcnt(9)
  s_bitcmp0_b32 s77, 31
  s_cbranch_scc1 L_b180
  s_cmp_gt_i32 s80, 43
  s_cbranch_scc0 L_n180
  s_waitcnt vmcnt(6)
L_n180:
  s_waitcnt vmcnt(8)
L_b180:
  buffer_load_dwordx4 v10, s[24:27], s65 offen offset:0 nt lds
  s_waitcnt vmcnt(10)
  s_cbranch_vccnz L_b181
  s_waitcnt vmcnt(9)
  s_bitcmp0_b32 s77, 31
  s_cbranch_scc1 L_b181
  s_cmp_gt_i32 s80, 43
  s_cbranch_scc0 L_n181
  s_waitcnt vmcnt(6)
L_n181:
  s_waitcnt vmcnt(7)
L_b181:
  buffer_load_dwordx4 v11, s[24:27], s65 offen offset:1024 nt lds
  s_cmp_eq_u32 s15, 3
  s_cselect_b32 s18, s16, 0x400000
  v_or_b32 v8, 43, v9
  buffer_store_dword v8, v6, s[44:47], s18 offen
  s_waitcnt vmcnt(11)
  s_cbranch_vccnz L_b182
  s_waitcnt vmcnt(9)
  s_bitcmp0_b32 s77, 31
  s_cbranch_scc1 L_b182
  s_cmp_gt_i32 s80, 43
  s_cbranch_scc0 L_n182
  s_waitcnt vmcnt(6)
L_n182:
  s_waitcnt vmcnt(8)
L_b182:
  buffer_load_dwordx4 v10, s[24:27], s65 offen offset:2048 nt lds
  s_waitcnt vmcnt(10)
  s_cbranch_vccnz L_b183
  s_waitcnt vmcnt(9)
  s_bitcmp0_b32 s77, 31
  s_cbranch_scc1 L_b183
  s_cmp_gt_i32 s80, 43
  s_cbranch_scc0 L_n183
  s_waitcnt vmcnt(5)
L_n183:
  s_waitcnt vmcnt(7)
L_b183:
  buffer_load_dwordx4 v11, s[24:27], s65 offen offset:3072 nt lds
  ds_read_b64_tr_b16 a[32:33], v16 offset:20480
  ds_read_b64_tr_b16 a[36:37], v17 offset:20480
  ds_read_b64_tr_b16 a[40:41], v18 offset:20480
  ds_read_b64_tr_b16 a[44:45], v19 offset:20480
  ds_read_b64_tr_b16 a[48:49], v20 offset:20480
  ds_read_b64_tr_b16 a[52:53], v21 offset:20480
  ds_read_b64_tr_b16 a[56:57], v22 offset:20480
  ds_read_b64_tr_b16 a[60:61], v23 offset:20480
  s_xor_b32 s65, s64, 0x60000
  s_add_u32 m0, s66, 8192
  s_sub_i32 s77, s36, 45
  s_cmp_gt_i32 s14, 44
  s_cselect_b64 vcc, -1, 0
  s_waitcnt vmcnt(10)
  s_cbranch_vccnz L_b184
  s_waitcnt vmcnt(8)
  s_bitcmp0_b32 s77, 31
  s_cbranch_scc1 L_b184
  s_cmp_gt_i32 s80, 44
  s_cbranch_scc0 L_n184
  s_waitcnt vmcnt(4)
L_n184:
  s_waitcnt vmcnt(6)
L_b184:
  buffer_load_dwordx4 v10, s[24:27], s65 offen offset:0 nt lds
  s_waitcnt vmcnt(9)
  s_cbranch_vccnz L_b185
  s_waitcnt vmcnt(7)
  s_bitcmp0_b32 s77, 31
  s_cbranch_scc1 L_b185
  s_cmp_gt_i32 s80, 44
  s_cbranch_scc0 L_n185
  s_waitcnt vmcnt(4)
L_n185:
  s_waitcnt vmcnt(5)
L_b185:
  buffer_load_dwordx4 v11, s[24:27], s65 offen offset:1024 nt lds
  s_cmp_eq_u32 s15, 0
  s_cselect_b32 s18, s16, 0x400000
  v_or_b32 v8, 44, v9
  buffer_store_dword v8, v6, s[44:47], s18 offen
  ds_read_b64_tr_b16 a[34:35], v16 offset:24576
  ds_read_b64_tr_b16 a[38:39], v17 offset:24576
  ds_read_b64_tr_b16 a[42:43], v18 offset:24576
  ds_read_b64_tr_b16 a[46:47], v19 offset:24576
  ds_read_b64_tr_b16 a[50:51], v20 offset:24576
  ds_read_b64_tr_b16 a[54:55], v21 offset:24576
  ds_read_b64_tr_b16 a[58:59], v22 offset:24576
  ds_read_b64_tr_b16 a[62:63], v23 offset:24576
  s_waitcnt vmcnt(9)
  s_cbranch_vccnz L_b186
  s_waitcnt vmcnt(7)
  s_bitcmp0_b32 s77, 31
  s_cbranch_scc1 L_b186
  s_cmp_gt_i32 s80, 44
  s_cbranch_scc0 L_n186
  s_waitcnt vmcnt(4)
L_n186:
  s_waitcnt vmcnt(6)
L_b186:
  buffer_load_dwordx4 v10, s[24:27], s65 offen offset:2048 nt lds
  v_xor_b32 v50, s17, v50
  v_lshrrev_b32 v51, 8, v50
  v_cmp_eq_u32 s[82:83], 0, v51
  v_mov_b32 v51, 40
  s_nop 0
  v_cndmask_b32 v50, v51, v50, s[82:83]
  s_nop 1
  v_add_u32_dpp v50, v50, v50 row_ror:1 row_mask:0xf bank_mask:0xf
  s_nop 1
  v_add_u32_dpp v50, v50, v50 row_ror:2 row_mask:0xf bank_mask:0xf
  s_nop 1
  v_add_u32_dpp v50, v50, v50 row_ror:4 row_mask:0xf bank_mask:0xf
  s_nop 1
  v_add_u32_dpp v50, v50, v50 row_ror:8 row_mask:0xf bank_mask:0xf
  s_nop 0
  v_readlane_b32 s100, v50, 0
  v_readlane_b32 s101, v50, 16
  s_add_u32 s100, s100, s101
  s_sub_i32 s100, s100, 1283
  s_ashr_i32 s37, s100, 1
  s_add_i32 s101, s100, 32
  s_mul_i32 s101, s101, -20
  s_ashr_i32 s101, s101, 8
  s_min_i32 s101, s101, 4
  s_add_i32 s80, s101, 45
  s_max_i32 s80, s80, s3
  s_mul_i32 s100, s100, 24
  s_ashr_i32 s100, s100, 8
  s_min_i32 s100, s100, 8
  s_add_i32 s14, s100, 45
  s_waitcnt lgkmcnt(0)
  v_mfma_f32_16x16x32_bf16 a[96:99], a[32:35], v[84:87], a[96:99]
  v_mfma_f32_16x16x32_bf16 a[100:103], a[36:39], v[84:87], a[100:103]
  v_mfma_f32_16x16x32_bf16 a[104:107], a[40:43], v[84:87], a[104:107]
  v_mfma_f32_16x16x32_bf16 a[108:111], a[44:47], v[84:87], a[108:111]
  s_waitcnt vmcnt(8)
  s_cbranch_vccnz L_b187
  s_waitcnt vmcnt(7)
  s_bitcmp0_b32 s77, 31
  s_cbranch_scc1 L_b187
  s_cmp_gt_i32 s80, 44
  s_cbranch_scc0 L_n187
  s_waitcnt vmcnt(4)
L_n187:
  s_waitcnt vmcnt(5)
L_b187:
  buffer_load_dwordx4 v11, s[24:27], s65 offen offset:3072 nt lds
  s_bitcmp1_b32 s38, 30
  s_cbranch_scc1 L_ge1
  v_xor_b32 v184, s17, v184
  v_xor_b32 v185, s17, v185
  v_xor_b32 v186, s17, v186
  v_xor_b32 v187, s17, v187
  v_xor_b32 v188, s17, v188
  v_xor_b32 v189, s17, v189
  v_xor_b32 v190, s17, v190
  v_xor_b32 v191, s17, v191
  v_min_u32 v180, 0x100, v191
  v_lshrrev_b32 v181, 1, v180
  v_and_b32 v181, 0x80, v181
  v_and_b32 v180, 0xff, v180
  v_add_u32 v180, v180, v181
  v_lshrrev_b32 v184, 8, v184
  v_min_u32 v184, 1, v184
  v_lshlrev_b32 v184, 4, v184
  v_sub_u32 v180, v180, v184
  v_lshrrev_b32 v185, 8, v185
  v_min_u32 v185, 1, v185
  v_lshlrev_b32 v185, 4, v185
  v_sub_u32 v180, v180, v185
  v_lshrrev_b32 v186, 8, v186
  v_min_u32 v186, 1, v186
  v_lshlrev_b32 v186, 4, v186
  v_sub_u32 v180, v180, v186
  v_lshrrev_b32 v187, 8, v187
  v_min_u32 v187, 1, v187
  v_lshlrev_b32 v187, 4, v187
  v_sub_u32 v180, v180, v187
  v_lshrrev_b32 v188, 8, v188
  v_min_u32 v188, 1, v188
  v_lshlrev_b32 v188, 4, v188
  v_sub_u32 v180, v180, v188
  v_lshrrev_b32 v189, 8, v189
  v_min_u32 v189, 1, v189
  v_lshlrev_b32 v189, 4, v189
  v_sub_u32 v180, v180, v189
  v_lshrrev_b32 v190, 8, v190
  v_min_u32 v190, 1, v190
  v_lshlrev_b32 v190, 4, v190
  v_sub_u32 v180, v180, v190
  v_lshrrev_b32 v191, 8, v191
  v_min_u32 v191, 1, v191
  v_lshlrev_b32 v191, 4, v191
  v_sub_u32 v180, v180, v191
  s_and_b32 s101, s2, 7
  s_sub_i32 s100, s62, 64
  s_mov_b32 m0, s101
  v_writelane_b32 v180, s100, m0
  s_add_u32 m0, s66, 8192
  s_nop 1
  v_add_u32_dpp v180, v180, v180 quad_perm:[1,0,3,2] row_mask:0xf bank_mask:0xf
  s_nop 1
  v_add_u32_dpp v180, v180, v180 quad_perm:[2,3,0,1] row_mask:0xf bank_mask:0xf
  s_nop 1
  v_add_u32_dpp v180, v180, v180 row_half_mirror row_mask:0xf bank_mask:0xf
  s_nop 0
  v_readlane_b32 s101, v180, 0
  s_lshl_b32 s100, s100, 3
  s_sub_i32 s100, s101, s100
  s_add_i32 s100, s100, -32
  s_mul_i32 s100, s100, 96
  s_add_i32 s100, s100, 512
  s_ashr_i32 s100, s100, 10
  s_max_i32 s100, s100, -16
  s_min_i32 s100, s100, 16
  s_add_i32 s100, s100, 128
  v_or_b32 v180, s100, v9
  buffer_store_dword v180, v6, s[44:47], s39 offen offset:4
L_ge1:
  v_mfma_f32_16x16x32_bf16 a[112:115], a[48:51], v[84:87], a[112:115]
  v_mfma_f32_16x16x32_bf16 a[116:119], a[52:55], v[84:87], a[116:119]
  v_mfma_f32_16x16x32_bf16 a[120:123], a[56:59], v[84:87], a[120:123]
  v_mfma_f32_16x16x32_bf16 a[124:127], a[60:63], v[84:87], a[124:127]
  s_xor_b32 s65, s64, 0x64000
  s_add_u32 m0, s66, 12288
  s_sub_i32 s77, s36, 46
  s_cmp_gt_i32 s14, 45
  s_cselect_b64 vcc, -1, 0
  s_waitcnt vmcnt(8)
  s_cbranch_vccnz L_b188
  s_waitcnt vmcnt(6)
  s_bitcmp0_b32 s77, 31
  s_cbranch_scc1 L_b188
  s_cmp_gt_i32 s80, 45
  s_cbranch_scc0 L_n188
  s_waitcnt vmcnt(4)
L_n188:
  s_waitcnt vmcnt(5)
L_b188:
  buffer_load_dwordx4 v10, s[24:27], s65 offen offset:0 nt lds
  ds_read_b64_tr_b16 a[32:33], v16 offset:0
  ds_read_b64_tr_b16 a[36:37], v17 offset:0
  ds_read_b64_tr_b16 a[40:41], v18 offset:0
  ds_read_b64_tr_b16 a[44:45], v19 offset:0
  ds_read_b64_tr_b16 a[48:49], v20 offset:0
  ds_read_b64_tr_b16 a[52:53], v21 offset:0
  ds_read_b64_tr_b16 a[56:57], v22 offset:0
  ds_read_b64_tr_b16 a[60:61], v23 offset:0
  s_waitcnt vmcnt(7)
  s_cbranch_vccnz L_b189
  s_waitcnt vmcnt(6)
  s_bitcmp0_b32 s77, 31
  s_cbranch_scc1 L_b189
  s_cmp_gt_i32 s80, 45
  s_cbranch_scc0 L_n189
  s_waitcnt vmcnt(4)
L_n189:
  s_waitcnt vmcnt(5)
L_b189:
  buffer_load_dwordx4 v11, s[24:27], s65 offen offset:1024 nt lds
  s_cmp_eq_u32 s15, 1
  s_cselect_b32 s18, s16, 0x400000
  v_or_b32 v8, 45, v9
  buffer_store_dword v8, v6, s[44:47], s18 offen
  s_waitcnt vmcnt(8)
  s_cbranch_vccnz L_b190
  s_waitcnt vmcnt(7)
  s_bitcmp0_b32 s77, 31
  s_cbranch_scc1 L_b190
  s_cmp_gt_i32 s80, 45
  s_cbranch_scc0 L_n190
  s_waitcnt vmcnt(4)
L_n190:
  s_waitcnt vmcnt(6)
L_b190:
  buffer_load_dwordx4 v10, s[24:27], s65 offen offset:2048 nt lds
  s_waitcnt vmcnt(8)
  s_cbranch_vccnz L_b191
  s_waitcnt vmcnt(7)
  s_bitcmp0_b32 s77, 31
  s_cbranch_scc1 L_b191
  s_cmp_gt_i32 s80, 45
  s_cbranch_scc0 L_n191
  s_waitcnt vmcnt(4)
L_n191:
  s_waitcnt vmcnt(5)
L_b191:
  buffer_load_dwordx4 v11, s[24:27], s65 offen offset:3072 nt lds
  s_xor_b32 s65, s64, 0x460000
  s_add_u32 m0, s66, 16384
  s_sub_i32 s77, s36, 47
  s_cmp_gt_i32 s14, 46
  s_cselect_b64 vcc, -1, 0
  s_waitcnt vmcnt(8)
  s_cbranch_vccnz L_b192
  s_waitcnt vmcnt(6)
  s_bitcmp0_b32 s77, 31
  s_cbranch_scc1 L_b192
  s_cmp_gt_i32 s80, 46
  s_cbranch_scc0 L_n192
  s_waitcnt vmcnt(4)
L_n192:
  s_waitcnt vmcnt(5)
L_b192:
  buffer_load_dwordx4 v10, s[24:27], s65 offen offset:0 nt lds
  ds_read_b64_tr_b16 a[34:35], v16 offset:4096
  ds_read_b64_tr_b16 a[38:39], v17 offset:4096
  ds_read_b64_tr_b16 a[42:43], v18 offset:4096
  ds_read_b64_tr_b16 a[46:47], v19 offset:4096
  ds_read_b64_tr_b16 a[50:51], v20 offset:4096
  ds_read_b64_tr_b16 a[54:55], v21 offset:4096
  ds_read_b64_tr_b16 a[58:59], v22 offset:4096
  ds_read_b64_tr_b16 a[62:63], v23 offset:4096
  s_waitcnt vmcnt(7)
  s_cbranch_vccnz L_b193
  s_waitcnt vmcnt(6)
  s_bitcmp0_b32 s77, 31
  s_cbranch_scc1 L_b193
  s_cmp_gt_i32 s80, 46
  s_cbranch_scc0 L_n193
  s_waitcnt vmcnt(4)
L_n193:
  s_waitcnt vmcnt(5)
L_b193:
  buffer_load_dwordx4 v11, s[24:27], s65 offen offset:1024 nt lds
  s_cmp_eq_u32 s15, 2
  s_cselect_b32 s18, s16, 0x400000
  v_or_b32 v8, 46, v9
  buffer_store_dword v8, v6, s[44:47], s18 offen
  s_waitcnt lgkmcnt(0)
  v_mfma_f32_16x16x32_bf16 a[96:99], a[32:35], v[88:91], a[96:99]
  v_mfma_f32_16x16x32_bf16 a[100:103], a[36:39], v[88:91], a[100:103]
  v_mfma_f32_16x16x32_bf16 a[104:107], a[40:43], v[88:91], a[104:107]
  v_mfma_f32_16x16x32_bf16 a[108:111], a[44:47], v[88:91], a[108:111]
  s_waitcnt vmcnt(8)
  s_cbranch_vccnz L_b194
  s_waitcnt vmcnt(7)
  s_bitcmp0_b32 s77, 31
  s_cbranch_scc1 L_b194
  s_cmp_gt_i32 s80, 46
  s_cbranch_scc0 L_n194
  s_waitcnt vmcnt(4)
L_n194:
  s_waitcnt vmcnt(6)
L_b194:
  buffer_load_dwordx4 v10, s[24:27], s65 offen offset:2048 nt lds
  buffer_load_dword v50, v7, s[44:47], 0 offen sc1
  v_mfma_f32_16x16x32_bf16 a[112:115], a[48:51], v[88:91], a[112:115]
  v_mfma_f32_16x16x32_bf16 a[116:119], a[52:55], v[88:91], a[116:119]
  v_mfma_f32_16x16x32_bf16 a[120:123], a[56:59], v[88:91], a[120:123]
  v_mfma_f32_16x16x32_bf16 a[124:127], a[60:63], v[88:91], a[124:127]
  s_waitcnt vmcnt(9)
  s_cbranch_vccnz L_b195
  s_waitcnt vmcnt(8)
  s_bitcmp0_b32 s77, 31
  s_cbranch_scc1 L_b195
  s_cmp_gt_i32 s80, 46
  s_cbranch_scc0 L_n195
  s_waitcnt vmcnt(5)
L_n195:
  s_waitcnt vmcnt(6)
L_b195:
  buffer_load_dwordx4 v11, s[24:27], s65 offen offset:3072 nt lds
  s_xor_b32 s65, s64, 0x464000
  s_add_u32 m0, s66, 20480
  s_sub_i32 s77, s36, 48
  s_cmp_gt_i32 s14, 47
  s_cselect_b64 vcc, -1, 0
  s_waitcnt vmcnt(9)
  s_cbranch_vccnz L_b196
  s_waitcnt vmcnt(7)
  s_bitcmp0_b32 s77, 31
  s_cbranch_scc1 L_b196
  s_cmp_gt_i32 s80, 47
  s_cbranch_scc0 L_n196
  s_waitcnt vmcnt(5)
L_n196:
  s_waitcnt vmcnt(6)
L_b196:
  buffer_load_dwordx4 v10, s[24:27], s65 offen offset:0 nt lds
  s_waitcnt vmcnt(8)
  s_cbranch_vccnz L_b197
  s_waitcnt vmcnt(7)
  s_bitcmp0_b32 s77, 31
  s_cbranch_scc1 L_b197
  s_cmp_gt_i32 s80, 47
  s_cbranch_scc0 L_n197
  s_waitcnt vmcnt(5)
L_n197:
  s_waitcnt vmcnt(6)
L_b197:
  buffer_load_dwordx4 v11, s[24:27], s65 offen offset:1024 nt lds
  s_cmp_eq_u32 s15, 3
  s_cselect_b32 s18, s16, 0x400000
  v_or_b32 v8, 47, v9
  buffer_store_dword v8, v6, s[44:47], s18 offen
  ds_read_b64_tr_b16 a[32:33], v16 offset:8192
  ds_read_b64_tr_b16 a[36:37], v17 offset:8192
  ds_read_b64_tr_b16 a[40:41], v18 offset:8192
  ds_read_b64_tr_b16 a[44:45], v19 offset:8192
  ds_read_b64_tr_b16 a[48:49], v20 offset:8192
  ds_read_b64_tr_b16 a[52:53], v21 offset:8192
  ds_read_b64_tr_b16 a[56:57], v22 offset:8192
  ds_read_b64_tr_b16 a[60:61], v23 offset:8192
  s_waitcnt vmcnt(9)
  s_cbranch_vccnz L_b198
  s_waitcnt vmcnt(8)
  s_bitcmp0_b32 s77, 31
  s_cbranch_scc1 L_b198
  s_cmp_gt_i32 s80, 47
  s_cbranch_scc0 L_n198
  s_waitcnt vmcnt(5)
L_n198:
  s_waitcnt vmcnt(7)
L_b198:
  buffer_load_dwordx4 v10, s[24:27], s65 offen offset:2048 nt lds
  s_waitcnt vmcnt(9)
  s_cbranch_vccnz L_b199
  s_waitcnt vmcnt(8)
  s_bitcmp0_b32 s77, 31
  s_cbranch_scc1 L_b199
  s_cmp_gt_i32 s80, 47
  s_cbranch_scc0 L_n199
  s_waitcnt vmcnt(4)
L_n199:
  s_waitcnt vmcnt(6)
L_b199:
  buffer_load_dwordx4 v11, s[24:27], s65 offen offset:3072 nt lds
  s_xor_b32 s65, s64, 0x80000
  s_add_u32 m0, s66, 24576
  s_sub_i32 s77, s36, 49
  s_cmp_gt_i32 s14, 48
  s_cselect_b64 vcc, -1, 0
  s_waitcnt vmcnt(9)
  s_cbranch_vccnz L_b200
  s_waitcnt vmcnt(7)
  s_bitcmp0_b32 s77, 31
  s_cbranch_scc1 L_b200
  s_cmp_gt_i32 s80, 48
  s_cbranch_scc0 L_n200
  s_waitcnt vmcnt(4)
L_n200:
  s_waitcnt vmcnt(5)
L_b200:
  buffer_load_dwordx4 v10, s[24:27], s65 offen offset:0 nt lds
  s_waitcnt vmcnt(8)
  s_cbranch_vccnz L_b201
  s_waitcnt vmcnt(6)
  s_bitcmp0_b32 s77, 31
  s_cbranch_scc1 L_b201
  s_cmp_gt_i32 s80, 48
  s_cbranch_scc0 L_n201
  s_waitcnt vmcnt(4)
L_n201:
  s_waitcnt vmcnt(5)
L_b201:
  buffer_load_dwordx4 v11, s[24:27], s65 offen offset:1024 nt lds
  s_cmp_eq_u32 s15, 0
  s_cselect_b32 s18, s16, 0x400000
  v_or_b32 v8, 48, v9
  buffer_store_dword v8, v6, s[44:47], s18 offen
  ds_read_b64_tr_b16 a[34:35], v16 offset:12288
  ds_read_b64_tr_b16 a[38:39], v17 offset:12288
  ds_read_b64_tr_b16 a[42:43], v18 offset:12288
  ds_read_b64_tr_b16 a[46:47], v19 offset:12288
  ds_read_b64_tr_b16 a[50:51], v20 offset:12288
  ds_read_b64_tr_b16 a[54:55], v21 offset:12288
  ds_read_b64_tr_b16 a[58:59], v22 offset:12288
  ds_read_b64_tr_b16 a[62:63], v23 offset:12288
  s_waitcnt vmcnt(8)
  s_cbranch_vccnz L_b202
  s_waitcnt vmcnt(7)
  s_bitcmp0_b32 s77, 31
  s_cbranch_scc1 L_b202
  s_cmp_gt_i32 s80, 48
  s_cbranch_scc0 L_n202
  s_waitcnt vmcnt(4)
L_n202:
  s_waitcnt vmcnt(6)
L_b202:
  buffer_load_dwordx4 v10, s[24:27], s65 offen offset:2048 nt lds
  v_xor_b32 v50, s17, v50
  v_lshrrev_b32 v51, 8, v50
  v_readlane_b32 s100, v50, 33
  s_cmp_lt_u32 s100, 256
  s_cselect_b32 s100, s100, 128
  s_add_i32 s36, s100, -79
  s_sub_i32 s3, 122, s100
  s_ashr_i32 s3, s3, 2
  s_add_i32 s3, s3, 49
  v_cmp_eq_u32 s[82:83], 0, v51
  v_mov_b32 v51, 44
  s_nop 0
  v_cndmask_b32 v50, v51, v50, s[82:83]
  s_nop 1
  v_add_u32_dpp v50, v50, v50 row_ror:1 row_mask:0xf bank_mask:0xf
  s_nop 1
  v_add_u32_dpp v50, v50, v50 row_ror:2 row_mask:0xf bank_mask:0xf
  s_nop 1
  v_add_u32_dpp v50, v50, v50 row_ror:4 row_mask:0xf bank_mask:0xf
  s_nop 1
  v_add_u32_dpp v50, v50, v50 row_ror:8 row_mask:0xf bank_mask:0xf
  s_nop 0
  v_readlane_b32 s100, v50, 0
  v_readlane_b32 s101, v50, 16
  s_add_u32 s100, s100, s101
  s_sub_i32 s100, s100, 1411
  s_ashr_i32 s37, s100, 1
  s_add_i32 s101, s100, 32
  s_mul_i32 s101, s101, -20
  s_ashr_i32 s101, s101, 8
  s_min_i32 s101, s101, 4
  s_add_i32 s80, s101, 49
  s_max_i32 s80, s80, s3
  s_mul_i32 s100, s100, 24
  s_ashr_i32 s100, s100, 8
  s_min_i32 s100, s100, 8
  s_add_i32 s14, s100, 49
  s_waitcnt lgkmcnt(0)
  v_mfma_f32_16x16x32_bf16 a[96:99], a[32:35], v[92:95], a[96:99]
  v_mfma_f32_16x16x32_bf16 a[100:103], a[36:39], v[92:95], a[100:103]
  v_mfma_f32_16x16x32_bf16 a[104:107], a[40:43], v[92:95], a[104:107]
  v_mfma_f32_16x16x32_bf16 a[108:111], a[44:47], v[92:95], a[108:111]
  s_waitcnt vmcnt(8)
  s_cbranch_vccnz L_b203
  s_waitcnt vmcnt(7)
  s_bitcmp0_b32 s77, 31
  s_cbranch_scc1 L_b203
  s_cmp_gt_i32 s80, 48
  s_cbranch_scc0 L_n203
  s_waitcnt vmcnt(4)
L_n203:
  s_waitcnt vmcnt(5)
L_b203:
  buffer_load_dwordx4 v11, s[24:27], s65 offen offset:3072 nt lds
  v_mfma_f32_16x16x32_bf16 a[112:115], a[48:51], v[92:95], a[112:115]
  v_mfma_f32_16x16x32_bf16 a[116:119], a[52:55], v[92:95], a[116:119]
  v_mfma_f32_16x16x32_bf16 a[120:123], a[56:59], v[92:95], a[120:123]
  v_mfma_f32_16x16x32_bf16 a[124:127], a[60:63], v[92:95], a[124:127]
  s_xor_b32 s65, s64, 0x84000
  s_add_u32 m0, s66, 0
  s_sub_i32 s77, s36, 50
  s_cmp_gt_i32 s14, 49
  s_cselect_b64 vcc, -1, 0
  s_waitcnt vmcnt(8)
  s_cbranch_vccnz L_b204
  s_waitcnt vmcnt(6)
  s_bitcmp0_b32 s77, 31
  s_cbranch_scc1 L_b204
  s_cmp_gt_i32 s80, 49
  s_cbranch_scc0 L_n204
  s_waitcnt vmcnt(4)
L_n204:
  s_waitcnt vmcnt(5)
L_b204:
  buffer_load_dwordx4 v10, s[24:27], s65 offen offset:0 nt lds
  ds_read_b64_tr_b16 a[32:33], v16 offset:16384
  ds_read_b64_tr_b16 a[36:37], v17 offset:16384
  ds_read_b64_tr_b16 a[40:41], v18 offset:16384
  ds_read_b64_tr_b16 a[44:45], v19 offset:16384
  ds_read_b64_tr_b16 a[48:49], v20 offset:16384
  ds_read_b64_tr_b16 a[52:53], v21 offset:16384
  ds_read_b64_tr_b16 a[56:57], v22 offset:16384
  ds_read_b64_tr_b16 a[60:61], v23 offset:16384
  s_waitcnt vmcnt(7)
  s_cbranch_vccnz L_b205
  s_waitcnt vmcnt(6)
  s_bitcmp0_b32 s77, 31
  s_cbranch_scc1 L_b205
  s_cmp_gt_i32 s80, 49
  s_cbranch_scc0 L_n205
  s_waitcnt vmcnt(4)
L_n205:
  s_waitcnt vmcnt(5)
L_b205:
  buffer_load_dwordx4 v11, s[24:27], s65 offen offset:1024 nt lds
  s_cmp_eq_u32 s15, 1
  s_cselect_b32 s18, s16, 0x400000
  v_or_b32 v8, 49, v9
  buffer_store_dword v8, v6, s[44:47], s18 offen
  s_waitcnt vmcnt(8)
  s_cbranch_vccnz L_b206
  s_waitcnt vmcnt(7)
  s_bitcmp0_b32 s77, 31
  s_cbranch_scc1 L_b206
  s_cmp_gt_i32 s80, 49
  s_cbranch_scc0 L_n206
  s_waitcnt vmcnt(4)
L_n206:
  s_waitcnt vmcnt(6)
L_b206:
  buffer_load_dwordx4 v10, s[24:27], s65 offen offset:2048 nt lds
  s_waitcnt vmcnt(8)
  s_cbranch_vccnz L_b207
  s_waitcnt vmcnt(7)
  s_bitcmp0_b32 s77, 31
  s_cbranch_scc1 L_b207
  s_cmp_gt_i32 s80, 49
  s_cbranch_scc0 L_n207
  s_waitcnt vmcnt(4)
L_n207:
  s_waitcnt vmcnt(5)
L_b207:
  buffer_load_dwordx4 v11, s[24:27], s65 offen offset:3072 nt lds
  s_xor_b32 s65, s64, 0x480000
  s_add_u32 m0, s66, 4096
  s_sub_i32 s77, s36, 51
  s_cmp_gt_i32 s14, 50
  s_cselect_b64 vcc, -1, 0
  s_waitcnt vmcnt(8)
  s_cbranch_vccnz L_b208
  s_waitcnt vmcnt(6)
  s_bitcmp0_b32 s77, 31
  s_cbranch_scc1 L_b208
  s_cmp_gt_i32 s80, 50
  s_cbranch_scc0 L_n208
  s_waitcnt vmcnt(4)
L_n208:
  s_waitcnt vmcnt(5)
L_b208:
  buffer_load_dwordx4 v10, s[24:27], s65 offen offset:0 nt lds
  ds_read_b64_tr_b16 a[34:35], v16 offset:20480
  ds_read_b64_tr_b16 a[38:39], v17 offset:20480
  ds_read_b64_tr_b16 a[42:43], v18 offset:20480
  ds_read_b64_tr_b16 a[46:47], v19 offset:20480
  ds_read_b64_tr_b16 a[50:51], v20 offset:20480
  ds_read_b64_tr_b16 a[54:55], v21 offset:20480
  ds_read_b64_tr_b16 a[58:59], v22 offset:20480
  ds_read_b64_tr_b16 a[62:63], v23 offset:20480
  s_waitcnt vmcnt(7)
  s_cbranch_vccnz L_b209
  s_waitcnt vmcnt(6)
  s_bitcmp0_b32 s77, 31
  s_cbranch_scc1 L_b209
  s_cmp_gt_i32 s80, 50
  s_cbranch_scc0 L_n209
  s_waitcnt vmcnt(4)
L_n209:
  s_waitcnt vmcnt(5)
L_b209:
  buffer_load_dwordx4 v11, s[24:27], s65 offen offset:1024 nt lds
  s_cmp_eq_u32 s15, 2
  s_cselect_b32 s18, s16, 0x400000
  v_or_b32 v8, 50, v9
  buffer_store_dword v8, v6, s[44:47], s18 offen
  s_waitcnt lgkmcnt(0)
  v_mfma_f32_16x16x32_bf16 a[96:99], a[32:35], v[96:99], a[96:99]
  v_mfma_f32_16x16x32_bf16 a[100:103], a[36:39], v[96:99], a[100:103]
  v_mfma_f32_16x16x32_bf16 a[104:107], a[40:43], v[96:99], a[104:107]
  v_mfma_f32_16x16x32_bf16 a[108:111], a[44:47], v[96:99], a[108:111]
  s_waitcnt vmcnt(8)
  s_cbranch_vccnz L_b210
  s_waitcnt vmcnt(7)
  s_bitcmp0_b32 s77, 31
  s_cbranch_scc1 L_b210
  s_cmp_gt_i32 s80, 50
  s_cbranch_scc0 L_n210
  s_waitcnt vmcnt(4)
L_n210:
  s_waitcnt vmcnt(6)
L_b210:
  buffer_load_dwordx4 v10, s[24:27], s65 offen offset:2048 nt lds
  buffer_load_dword v50, v7, s[44:47], 0 offen sc1
  v_mfma_f32_16x16x32_bf16 a[112:115], a[48:51], v[96:99], a[112:115]
  v_mfma_f32_16x16x32_bf16 a[116:119], a[52:55], v[96:99], a[116:119]
  v_mfma_f32_16x16x32_bf16 a[120:123], a[56:59], v[96:99], a[120:123]
  v_mfma_f32_16x16x32_bf16 a[124:127], a[60:63], v[96:99], a[124:127]
  s_waitcnt vmcnt(9)
  s_cbranch_vccnz L_b211
  s_waitcnt vmcnt(8)
  s_bitcmp0_b32 s77, 31
  s_cbranch_scc1 L_b211
  s_cmp_gt_i32 s80, 50
  s_cbranch_scc0 L_n211
  s_waitcnt vmcnt(5)
L_n211:
  s_waitcnt vmcnt(6)
L_b211:
  buffer_load_dwordx4 v11, s[24:27], s65 offen offset:3072 nt lds
  s_xor_b32 s65, s64, 0x484000
  s_add_u32 m0, s66, 8192
  s_sub_i32 s77, s36, 52
  s_cmp_gt_i32 s14, 51
  s_cselect_b64 vcc, -1, 0
  s_waitcnt vmcnt(9)
  s_cbranch_vccnz L_b212
  s_waitcnt vmcnt(7)
  s_bitcmp0_b32 s77, 31
  s_cbranch_scc1 L_b212
  s_cmp_gt_i32 s80, 51
  s_cbranch_scc0 L_n212
  s_waitcnt vmcnt(5)
L_n212:
  s_waitcnt vmcnt(6)
L_b212:
  buffer_load_dwordx4 v10, s[24:27], s65 offen offset:0 nt lds
  s_waitcnt vmcnt(8)
  s_cbranch_vccnz L_b213
  s_waitcnt vmcnt(7)
  s_bitcmp0_b32 s77, 31
  s_cbranch_scc1 L_b213
  s_cmp_gt_i32 s80, 51
  s_cbranch_scc0 L_n213
  s_waitcnt vmcnt(5)
L_n213:
  s_waitcnt vmcnt(6)
L_b213:
  buffer_load_dwordx4 v11, s[24:27], s65 offen offset:1024 nt lds
  s_cmp_eq_u32 s15, 3
  s_cselect_b32 s18, s16, 0x400000
  v_or_b32 v8, 51, v9
  buffer_store_dword v8, v6, s[44:47], s18 offen
  ds_read_b64_tr_b16 a[32:33], v16 offset:24576
  ds_read_b64_tr_b16 a[36:37], v17 offset:24576
  ds_read_b64_tr_b16 a[40:41], v18 offset:24576
  ds_read_b64_tr_b16 a[44:45], v19 offset:24576
  ds_read_b64_tr_b16 a[48:49], v20 offset:24576
  ds_read_b64_tr_b16 a[52:53], v21 offset:24576
  ds_read_b64_tr_b16 a[56:57], v22 offset:24576
  ds_read_b64_tr_b16 a[60:61], v23 offset:24576
  s_waitcnt vmcnt(9)
  s_cbranch_vccnz L_b214
  s_waitcnt vmcnt(8)
  s_bitcmp0_b32 s77, 31
  s_cbranch_scc1 L_b214
  s_cmp_gt_i32 s80, 51
  s_cbranch_scc0 L_n214
  s_waitcnt vmcnt(5)
L_n214:
  s_waitcnt vmcnt(7)
L_b214:
  buffer_load_dwordx4 v10, s[24:27], s65 offen offset:2048 nt lds
  s_waitcnt vmcnt(9)
  s_cbranch_vccnz L_b215
  s_waitcnt vmcnt(8)
  s_bitcmp0_b32 s77, 31
  s_cbranch_scc1 L_b215
  s_cmp_gt_i32 s80, 51
  s_cbranch_scc0 L_n215
  s_waitcnt vmcnt(4)
L_n215:
  s_waitcnt vmcnt(6)
L_b215:
  buffer_load_dwordx4 v11, s[24:27], s65 offen offset:3072 nt lds
  s_mov_b32 s18, 67584
  buffer_load_dword v184, v182, s[44:47], s18 offen sc1
  s_xor_b32 s65, s64, 0xa0000
  s_add_u32 m0, s66, 12288
  s_sub_i32 s77, s36, 53
  s_cmp_gt_i32 s14, 52
  s_cselect_b64 vcc, -1, 0
  s_waitcnt vmcnt(10)
  s_cbranch_vccnz L_b216
  s_waitcnt vmcnt(8)
  s_bitcmp0_b32 s77, 31
  s_cbranch_scc1 L_b216
  s_cmp_gt_i32 s80, 52
  s_cbranch_scc0 L_n216
  s_waitcnt vmcnt(5)
L_n216:
  s_waitcnt vmcnt(6)
L_b216:
  buffer_load_dwordx4 v10, s[24:27], s65 offen offset:0 nt lds
  s_waitcnt vmcnt(9)
  s_cbranch_vccnz L_b217
  s_waitcnt vmcnt(7)
  s_bitcmp0_b32 s77, 31
  s_cbranch_scc1 L_b217
  s_cmp_gt_i32 s80, 52
  s_cbranch_scc0 L_n217
  s_waitcnt vmcnt(5)
L_n217:
  s_waitcnt vmcnt(6)
L_b217:
  buffer_load_dwordx4 v11, s[24:27], s65 offen offset:1024 nt lds
  s_cmp_eq_u32 s15, 0
  s_cselect_b32 s18, s16, 0x400000
  v_or_b32 v8, 52, v9
  buffer_store_dword v8, v6, s[44:47], s18 offen
  ds_read_b64_tr_b16 a[34:35], v16 offset:0
  ds_read_b64_tr_b16 a[38:39], v17 offset:0
  ds_read_b64_tr_b16 a[42:43], v18 offset:0
  ds_read_b64_tr_b16 a[46:47], v19 offset:0
  ds_read_b64_tr_b16 a[50:51], v20 offset:0
  ds_read_b64_tr_b16 a[54:55], v21 offset:0
  ds_read_b64_tr_b16 a[58:59], v22 offset:0
  ds_read_b64_tr_b16 a[62:63], v23 offset:0
  s_waitcnt vmcnt(9)
  s_cbranch_vccnz L_b218
  s_waitcnt vmcnt(8)
  s_bitcmp0_b32 s77, 31
  s_cbranch_scc1 L_b218
  s_cmp_gt_i32 s80, 52
  s_cbranch_scc0 L_n218
  s_waitcnt vmcnt(5)
L_n218:
  s_waitcnt vmcnt(7)
L_b218:
  buffer_load_dwordx4 v10, s[24:27], s65 offen offset:2048 nt lds
  v_xor_b32 v50, s17, v50
  v_lshrrev_b32 v51, 8, v50
  v_cmp_eq_u32 s[82:83], 0, v51
  v_mov_b32 v51, 48
  s_nop 0
  v_cndmask_b32 v50, v51, v50, s[82:83]
  s_nop 1
  v_add_u32_dpp v50, v50, v50 row_ror:1 row_mask:0xf bank_mask:0xf
  s_nop 1
  v_add_u32_dpp v50, v50, v50 row_ror:2 row_mask:0xf bank_mask:0xf
  s_nop 1
  v_add_u32_dpp v50, v50, v50 row_ror:4 row_mask:0xf bank_mask:0xf
  s_nop 1
  v_add_u32_dpp v50, v50, v50 row_ror:8 row_mask:0xf bank_mask:0xf
  s_nop 0
  v_readlane_b32 s100, v50, 0
  v_readlane_b32 s101, v50, 16
  s_add_u32 s100, s100, s101
  s_sub_i32 s100, s100, 1539
  s_ashr_i32 s37, s100, 1
  s_add_i32 s101, s100, 32
  s_mul_i32 s101, s101, -20
  s_ashr_i32 s101, s101, 8
  s_min_i32 s101, s101, 4
  s_add_i32 s80, s101, 53
  s_max_i32 s80, s80, s3
  s_mul_i32 s100, s100, 24
  s_ashr_i32 s100, s100, 8
  s_min_i32 s100, s100, 8
  s_add_i32 s14, s100, 53
  s_waitcnt lgkmcnt(0)
  v_mfma_f32_16x16x32_bf16 a[96:99], a[32:35], v[100:103], a[96:99]
  v_mfma_f32_16x16x32_bf16 a[100:103], a[36:39], v[100:103], a[100:103]
  v_mfma_f32_16x16x32_bf16 a[104:107], a[40:43], v[100:103], a[104:107]
  v_mfma_f32_16x16x32_bf16 a[108:111], a[44:47], v[100:103], a[108:111]
  s_waitcnt vmcnt(9)
  s_cbranch_vccnz L_b219
  s_waitcnt vmcnt(8)
  s_bitcmp0_b32 s77, 31
  s_cbranch_scc1 L_b219
  s_cmp_gt_i32 s80, 52
  s_cbranch_scc0 L_n219
  s_waitcnt vmcnt(5)
L_n219:
  s_waitcnt vmcnt(6)
L_b219:
  buffer_load_dwordx4 v11, s[24:27], s65 offen offset:3072 nt lds
  s_mov_b32 s18, 67584
  buffer_load_dword v185, v182, s[44:47], s18 offen sc1
  v_mfma_f32_16x16x32_bf16 a[112:115], a[48:51], v[100:103], a[112:115]
  v_mfma_f32_16x16x32_bf16 a[116:119], a[52:55], v[100:103], a[116:119]
  v_mfma_f32_16x16x32_bf16 a[120:123], a[56:59], v[100:103], a[120:123]
  v_mfma_f32_16x16x32_bf16 a[124:127], a[60:63], v[100:103], a[124:127]
  s_xor_b32 s65, s64, 0xa4000
  s_add_u32 m0, s66, 16384
  s_sub_i32 s77, s36, 54
  s_cmp_gt_i32 s14, 53
  s_cselect_b64 vcc, -1, 0
  s_waitcnt vmcnt(10)
  s_cbranch_vccnz L_b220
  s_waitcnt vmcnt(8)
  s_bitcmp0_b32 s77, 31
  s_cbranch_scc1 L_b220
  s_cmp_gt_i32 s80, 53
  s_cbranch_scc0 L_n220
  s_waitcnt vmcnt(5)
L_n220:
  s_waitcnt vmcnt(7)
L_b220:
  buffer_load_dwordx4 v10, s[24:27], s65 offen offset:0 nt lds
  s_waitcnt vmcnt(9)
  s_cbranch_vccnz L_b221
  s_waitcnt vmcnt(8)
  s_bitcmp0_b32 s77, 31
  s_cbranch_scc1 L_b221
  s_cmp_gt_i32 s80, 53
  s_cbranch_scc0 L_n221
  s_waitcnt vmcnt(5)
L_n221:
  s_waitcnt vmcnt(6)
L_b221:
  buffer_load_dwordx4 v11, s[24:27], s65 offen offset:1024 nt lds
  s_cmp_eq_u32 s15, 1
  s_cselect_b32 s18, s16, 0x400000
  v_or_b32 v8, 53, v9
  buffer_store_dword v8, v6, s[44:47], s18 offen
  ds_read_b64_tr_b16 a[32:33], v16 offset:4096
  ds_read_b64_tr_b16 a[36:37], v17 offset:4096
  ds_read_b64_tr_b16 a[40:41], v18 offset:4096
  ds_read_b64_tr_b16 a[44:45], v19 offset:4096
  ds_read_b64_tr_b16 a[48:49], v20 offset:4096
  ds_read_b64_tr_b16 a[52:53], v21 offset:4096
  ds_read_b64_tr_b16 a[56:57], v22 offset:4096
  ds_read_b64_tr_b16 a[60:61], v23 offset:4096
  s_waitcnt vmcnt(10)
  s_cbranch_vccnz L_b222
  s_waitcnt vmcnt(8)
  s_bitcmp0_b32 s77, 31
  s_cbranch_scc1 L_b222
  s_cmp_gt_i32 s80, 53
  s_cbranch_scc0 L_n222
  s_waitcnt vmcnt(5)
L_n222:
  s_waitcnt vmcnt(7)
L_b222:
  buffer_load_dwordx4 v10, s[24:27], s65 offen offset:2048 nt lds
  s_waitcnt vmcnt(9)
  s_cbranch_vccnz L_b223
  s_waitcnt vmcnt(8)
  s_bitcmp0_b32 s77, 31
  s_cbranch_scc1 L_b223
  s_cmp_gt_i32 s80, 53
  s_cbranch_scc0 L_n223
  s_waitcnt vmcnt(5)
L_n223:
  s_waitcnt vmcnt(6)
L_b223:
  buffer_load_dwordx4 v11, s[24:27], s65 offen offset:3072 nt lds
  s_mov_b32 s18, 67584
  buffer_load_dword v186, v182, s[44:47], s18 offen sc1
  s_xor_b32 s65, s64, 0x4a0000
  s_add_u32 m0, s66, 20480
  s_sub_i32 s77, s36, 55
  s_cmp_gt_i32 s14, 54
  s_cselect_b64 vcc, -1, 0
  s_waitcnt vmcnt(10)
  s_cbranch_vccnz L_b224
  s_waitcnt vmcnt(8)
  s_bitcmp0_b32 s77, 31
  s_cbranch_scc1 L_b224
  s_cmp_gt_i32 s80, 54
  s_cbranch_scc0 L_n224
  s_waitcnt vmcnt(5)
L_n224:
  s_waitcnt vmcnt(7)
L_b224:
  buffer_load_dwordx4 v10, s[24:27], s65 offen offset:0 nt lds
  s_waitcnt vmcnt(9)
  s_cbranch_vccnz L_b225
  s_waitcnt vmcnt(8)
  s_bitcmp0_b32 s77, 31
  s_cbranch_scc1 L_b225
  s_cmp_gt_i32 s80, 54
  s_cbranch_scc0 L_n225
  s_waitcnt vmcnt(5)
L_n225:
  s_waitcnt vmcnt(6)
L_b225:
  buffer_load_dwordx4 v11, s[24:27], s65 offen offset:1024 nt lds
  s_cmp_eq_u32 s15, 2
  s_cselect_b32 s18, s16, 0x400000
  v_or_b32 v8, 54, v9
  buffer_store_dword v8, v6, s[44:47], s18 offen
  ds_read_b64_tr_b16 a[34:35], v16 offset:8192
  ds_read_b64_tr_b16 a[38:39], v17 offset:8192
  ds_read_b64_tr_b16 a[42:43], v18 offset:8192
  ds_read_b64_tr_b16 a[46:47], v19 offset:8192
  ds_read_b64_tr_b16 a[50:51], v20 offset:8192
  ds_read_b64_tr_b16 a[54:55], v21 offset:8192
  ds_read_b64_tr_b16 a[58:59], v22 offset:8192
  ds_read_b64_tr_b16 a[62:63], v23 offset:8192
  s_waitcnt vmcnt(10)
  s_cbranch_vccnz L_b226
  s_waitcnt vmcnt(8)
  s_bitcmp0_b32 s77, 31
  s_cbranch_scc1 L_b226
  s_cmp_gt_i32 s80, 54
  s_cbranch_scc0 L_n226
  s_waitcnt vmcnt(5)
L_n226:
  s_waitcnt vmcnt(7)
L_b226:
  buffer_load_dwordx4 v10, s[24:27], s65 offen offset:2048 nt lds
  buffer_load_dword v50, v7, s[44:47], 0 offen sc1
  s_bitcmp1_b32 s38, 30
  s_cbranch_scc1 L_gp2
  s_add_i32 s100, s37, 128
  s_max_i32 s100, s100, 0
  s_min_i32 s100, s100, 255
  s_mov_b32 s62, s100
  v_or_b32 v180, s100, v9
  s_add_u32 s18, s38, 67584
  buffer_store_dword v180, v6, s[44:47], s18 offen sc1
L_gp2:
  s_waitcnt lgkmcnt(0)
  v_mfma_f32_16x16x32_bf16 a[96:99], a[32:35], v[104:107], a[96:99]
  v_mfma_f32_16x16x32_bf16 a[100:103], a[36:39], v[104:107], a[100:103]
  v_mfma_f32_16x16x32_bf16 a[104:107], a[40:43], v[104:107], a[104:107]
  v_mfma_f32_16x16x32_bf16 a[108:111], a[44:47], v[104:107], a[108:111]
  s_waitcnt vmcnt(10)
  s_cbranch_vccnz L_b227
  s_waitcnt vmcnt(9)
  s_bitcmp0_b32 s77, 31
  s_cbranch_scc1 L_b227
  s_cmp_gt_i32 s80, 54
  s_cbranch_scc0 L_n227
  s_waitcnt vmcnt(6)
L_n227:
  s_waitcnt vmcnt(7)
L_b227:
  buffer_load_dwordx4 v11, s[24:27], s65 offen offset:3072 nt lds
  s_mov_b32 s18, 67584
  buffer_load_dword v187, v182, s[44:47], s18 offen sc1
  v_mfma_f32_16x16x32_bf16 a[112:115], a[48:51], v[104:107], a[112:115]
  v_mfma_f32_16x16x32_bf16 a[116:119], a[52:55], v[104:107], a[116:119]
  v_mfma_f32_16x16x32_bf16 a[120:123], a[56:59], v[104:107], a[120:123]
  v_mfma_f32_16x16x32_bf16 a[124:127], a[60:63], v[104:107], a[124:127]
  s_xor_b32 s65, s64, 0x4a4000
  s_add_u32 m0, s66, 24576
  s_sub_i32 s77, s36, 56
  s_cmp_gt_i32 s14, 55
  s_cselect_b64 vcc, -1, 0
  s_waitcnt vmcnt(11)
  s_cbranch_vccnz L_b228
  s_waitcnt vmcnt(9)
  s_bitcmp0_b32 s77, 31
  s_cbranch_scc1 L_b228
  s_cmp_gt_i32 s80, 55
  s_cbranch_scc0 L_n228
  s_waitcnt vmcnt(6)
L_n228:
  s_waitcnt vmcnt(8)
L_b228:
  buffer_load_dwordx4 v10, s[24:27], s65 offen offset:0 nt lds
  s_waitcnt vmcnt(10)
  s_cbranch_vccnz L_b229
  s_waitcnt vmcnt(9)
  s_bitcmp0_b32 s77, 31
  s_cbranch_scc1 L_b229
  s_cmp_gt_i32 s80, 55
  s_cbranch_scc0 L_n229
  s_waitcnt vmcnt(6)
L_n229:
  s_waitcnt vmcnt(7)
L_b229:
  buffer_load_dwordx4 v11, s[24:27], s65 offen offset:1024 nt lds
  s_cmp_eq_u32 s15, 3
  s_cselect_b32 s18, s16, 0x400000
  v_or_b32 v8, 55, v9
  buffer_store_dword v8, v6, s[44:47], s18 offen
  s_waitcnt vmcnt(11)
  s_cbranch_vccnz L_b230
  s_waitcnt vmcnt(9)
  s_bitcmp0_b32 s77, 31
  s_cbranch_scc1 L_b230
  s_cmp_gt_i32 s80, 55
  s_cbranch_scc0 L_n230
  s_waitcnt vmcnt(6)
L_n230:
  s_waitcnt vmcnt(8)
L_b230:
  buffer_load_dwordx4 v10, s[24:27], s65 offen offset:2048 nt lds
  s_waitcnt vmcnt(10)
  s_cbranch_vccnz L_b231
  s_waitcnt vmcnt(9)
  s_bitcmp0_b32 s77, 31
  s_cbranch_scc1 L_b231
  s_cmp_gt_i32 s80, 55
  s_cbranch_scc0 L_n231
  s_waitcnt vmcnt(5)
L_n231:
  s_waitcnt vmcnt(7)
L_b231:
  buffer_load_dwordx4 v11, s[24:27], s65 offen offset:3072 nt lds
  s_mov_b32 s18, 67584
  buffer_load_dword v188, v182, s[44:47], s18 offen sc1
  ds_read_b64_tr_b16 a[32:33], v16 offset:12288
  ds_read_b64_tr_b16 a[36:37], v17 offset:12288
  ds_read_b64_tr_b16 a[40:41], v18 offset:12288
  ds_read_b64_tr_b16 a[44:45], v19 offset:12288
  ds_read_b64_tr_b16 a[48:49], v20 offset:12288
  ds_read_b64_tr_b16 a[52:53], v21 offset:12288
  ds_read_b64_tr_b16 a[56:57], v22 offset:12288
  ds_read_b64_tr_b16 a[60:61], v23 offset:12288
  s_xor_b32 s65, s64, 0xc0000
  s_add_u32 m0, s66, 0
  s_sub_i32 s77, s36, 57
  s_cmp_gt_i32 s14, 56
  s_cselect_b64 vcc, -1, 0
  s_waitcnt vmcnt(11)
  s_cbranch_vccnz L_b232
  s_waitcnt vmcnt(9)
  s_bitcmp0_b32 s77, 31
  s_cbranch_scc1 L_b232
  s_cmp_gt_i32 s80, 56
  s_cbranch_scc0 L_n232
  s_waitcnt vmcnt(5)
L_n232:
  s_waitcnt vmcnt(7)
L_b232:
  buffer_load_dwordx4 v10, s[24:27], s65 offen offset:0 nt lds
  s_waitcnt vmcnt(10)
  s_cbranch_vccnz L_b233
  s_waitcnt vmcnt(8)
  s_bitcmp0_b32 s77, 31
  s_cbranch_scc1 L_b233
  s_cmp_gt_i32 s80, 56
  s_cbranch_scc0 L_n233
  s_waitcnt vmcnt(5)
L_n233:
  s_waitcnt vmcnt(6)
L_b233:
  buffer_load_dwordx4 v11, s[24:27], s65 offen offset:1024 nt lds
  s_cmp_eq_u32 s15, 0
  s_cselect_b32 s18, s16, 0x400000
  v_or_b32 v8, 56, v9
  buffer_store_dword v8, v6, s[44:47], s18 offen
  s_waitcnt vmcnt(10)
  s_cbranch_vccnz L_b234
  s_waitcnt vmcnt(8)
  s_bitcmp0_b32 s77, 31
  s_cbranch_scc1 L_b234
  s_cmp_gt_i32 s80, 56
  s_cbranch_scc0 L_n234
  s_waitcnt vmcnt(5)
L_n234:
  s_waitcnt vmcnt(7)
L_b234:
  buffer_load_dwordx4 v10, s[24:27], s65 offen offset:2048 nt lds
  v_xor_b32 v50, s17, v50
  v_lshrrev_b32 v51, 8, v50
  v_cmp_eq_u32 s[82:83], 0, v51
  v_mov_b32 v51, 52
  s_nop 0
  v_cndmask_b32 v50, v51, v50, s[82:83]
  s_nop 1
  v_add_u32_dpp v50, v50, v50 row_ror:1 row_mask:0xf bank_mask:0xf
  s_nop 1
  v_add_u32_dpp v50, v50, v50 row_ror:2 row_mask:0xf bank_mask:0xf
  s_nop 1
  v_add_u32_dpp v50, v50, v50 row_ror:4 row_mask:0xf bank_mask:0xf
  s_nop 1
  v_add_u32_dpp v50, v50, v50 row_ror:8 row_mask:0xf bank_mask:0xf
  s_nop 0
  v_readlane_b32 s100, v50, 0
  v_readlane_b32 s101, v50, 16
  s_add_u32 s100, s100, s101
  s_sub_i32 s100, s100, 1667
  s_ashr_i32 s37, s100, 1
  s_add_i32 s62, s37, 128
  s_add_i32 s101, s100, 32
  s_mul_i32 s101, s101, -20
  s_ashr_i32 s101, s101, 8
  s_min_i32 s101, s101, 4
  s_add_i32 s80, s101, 57
  s_max_i32 s80, s80, s3
  s_mul_i32 s100, s100, 24
  s_ashr_i32 s100, s100, 8
  s_min_i32 s100, s100, 8
  s_add_i32 s14, s100, 57
  ds_read_b64_tr_b16 a[34:35], v16 offset:16384
  ds_read_b64_tr_b16 a[38:39], v17 offset:16384
  ds_read_b64_tr_b16 a[42:43], v18 offset:16384
  ds_read_b64_tr_b16 a[46:47], v19 offset:16384
  ds_read_b64_tr_b16 a[50:51], v20 offset:16384
  ds_read_b64_tr_b16 a[54:55], v21 offset:16384
  ds_read_b64_tr_b16 a[58:59], v22 offset:16384
  ds_read_b64_tr_b16 a[62:63], v23 offset:16384
  s_waitcnt vmcnt(9)
  s_cbranch_vccnz L_b235
  s_waitcnt vmcnt(8)
  s_bitcmp0_b32 s77, 31
  s_cbranch_scc1 L_b235
  s_cmp_gt_i32 s80, 56
  s_cbranch_scc0 L_n235
  s_waitcnt vmcnt(5)
L_n235:
  s_waitcnt vmcnt(6)
L_b235:
  buffer_load_dwordx4 v11, s[24:27], s65 offen offset:3072 nt lds
  s_mov_b32 s18, 67584
  buffer_load_dword v189, v182, s[44:47], s18 offen sc1
  s_waitcnt lgkmcnt(0)
  v_mfma_f32_16x16x32_bf16 a[96:99], a[32:35], v[108:111], a[96:99]
  v_mfma_f32_16x16x32_bf16 a[100:103], a[36:39], v[108:111], a[100:103]
  v_mfma_f32_16x16x32_bf16 a[104:107], a[40:43], v[108:111], a[104:107]
  v_mfma_f32_16x16x32_bf16 a[108:111], a[44:47], v[108:111], a[108:111]
  s_xor_b32 s65, s64, 0xc4000
  s_add_u32 m0, s66, 4096
  s_sub_i32 s77, s36, 58
  s_cmp_gt_i32 s14, 57
  s_cselect_b64 vcc, -1, 0
  s_waitcnt vmcnt(10)
  s_cbranch_vccnz L_b236
  s_waitcnt vmcnt(8)
  s_bitcmp0_b32 s77, 31
  s_cbranch_scc1 L_b236
  s_cmp_gt_i32 s80, 57
  s_cbranch_scc0 L_n236
  s_waitcnt vmcnt(5)
L_n236:
  s_waitcnt vmcnt(7)
L_b236:
  buffer_load_dwordx4 v10, s[24:27], s65 offen offset:0 nt lds
  v_mfma_f32_16x16x32_bf16 a[112:115], a[48:51], v[108:111], a[112:115]
  v_mfma_f32_16x16x32_bf16 a[116:119], a[52:55], v[108:111], a[116:119]
  v_mfma_f32_16x16x32_bf16 a[120:123], a[56:59], v[108:111], a[120:123]
  v_mfma_f32_16x16x32_bf16 a[124:127], a[60:63], v[108:111], a[124:127]
  s_waitcnt vmcnt(9)
  s_cbranch_vccnz L_b237
  s_waitcnt vmcnt(8)
  s_bitcmp0_b32 s77, 31
  s_cbranch_scc1 L_b237
  s_cmp_gt_i32 s80, 57
  s_cbranch_scc0 L_n237
  s_waitcnt vmcnt(5)
L_n237:
  s_waitcnt vmcnt(6)
L_b237:
  buffer_load_dwordx4 v11, s[24:27], s65 offen offset:1024 nt lds
  s_cmp_eq_u32 s15, 1
  s_cselect_b32 s18, s16, 0x400000
  v_or_b32 v8, 57, v9
  buffer_store_dword v8, v6, s[44:47], s18 offen
  ds_read_b64_tr_b16 a[32:33], v16 offset:20480
  ds_read_b64_tr_b16 a[36:37], v17 offset:20480
  ds_read_b64_tr_b16 a[40:41], v18 offset:20480
  ds_read_b64_tr_b16 a[44:45], v19 offset:20480
  ds_read_b64_tr_b16 a[48:49], v20 offset:20480
  ds_read_b64_tr_b16 a[52:53], v21 offset:20480
  ds_read_b64_tr_b16 a[56:57], v22 offset:20480
  ds_read_b64_tr_b16 a[60:61], v23 offset:20480
  s_waitcnt vmcnt(10)
  s_cbranch_vccnz L_b238
  s_waitcnt vmcnt(8)
  s_bitcmp0_b32 s77, 31
  s_cbranch_scc1 L_b238
  s_cmp_gt_i32 s80, 57
  s_cbranch_scc0 L_n238
  s_waitcnt vmcnt(5)
L_n238:
  s_waitcnt vmcnt(7)
L_b238:
  buffer_load_dwordx4 v10, s[24:27], s65 offen offset:2048 nt lds
  s_waitcnt vmcnt(9)
  s_cbranch_vccnz L_b239
  s_waitcnt vmcnt(8)
  s_bitcmp0_b32 s77, 31
  s_cbranch_scc1 L_b239
  s_cmp_gt_i32 s80, 57
  s_cbranch_scc0 L_n239
  s_waitcnt vmcnt(5)
L_n239:
  s_waitcnt vmcnt(6)
L_b239:
  buffer_load_dwordx4 v11, s[24:27], s65 offen offset:3072 nt lds
  s_mov_b32 s18, 67584
  buffer_load_dword v190, v182, s[44:47], s18 offen sc1
  s_xor_b32 s65, s64, 0x4c0000
  s_add_u32 m0, s66, 8192
  s_sub_i32 s77, s36, 59
  s_cmp_gt_i32 s14, 58
  s_cselect_b64 vcc, -1, 0
  s_waitcnt vmcnt(10)
  s_cbranch_vccnz L_b240
  s_waitcnt vmcnt(8)
  s_bitcmp0_b32 s77, 31
  s_cbranch_scc1 L_b240
  s_cmp_gt_i32 s80, 58
  s_cbranch_scc0 L_n240
  s_waitcnt vmcnt(5)
L_n240:
  s_waitcnt vmcnt(7)
L_b240:
  buffer_load_dwordx4 v10, s[24:27], s65 offen offset:0 nt lds
  s_waitcnt vmcnt(9)
  s_cbranch_vccnz L_b241
  s_waitcnt vmcnt(8)
  s_bitcmp0_b32 s77, 31
  s_cbranch_scc1 L_b241
  s_cmp_gt_i32 s80, 58
  s_cbranch_scc0 L_n241
  s_waitcnt vmcnt(5)
L_n241:
  s_waitcnt vmcnt(6)
L_b241:
  buffer_load_dwordx4 v11, s[24:27], s65 offen offset:1024 nt lds
  s_cmp_eq_u32 s15, 2
  s_cselect_b32 s18, s16, 0x400000
  v_or_b32 v8, 58, v9
  buffer_store_dword v8, v6, s[44:47], s18 offen
  ds_read_b64_tr_b16 a[34:35], v16 offset:24576
  ds_read_b64_tr_b16 a[38:39], v17 offset:24576
  ds_read_b64_tr_b16 a[42:43], v18 offset:24576
  ds_read_b64_tr_b16 a[46:47], v19 offset:24576
  ds_read_b64_tr_b16 a[50:51], v20 offset:24576
  ds_read_b64_tr_b16 a[54:55], v21 offset:24576
  ds_read_b64_tr_b16 a[58:59], v22 offset:24576
  ds_read_b64_tr_b16 a[62:63], v23 offset:24576
  s_waitcnt vmcnt(10)
  s_cbranch_vccnz L_b242
  s_waitcnt vmcnt(8)
  s_bitcmp0_b32 s77, 31
  s_cbranch_scc1 L_b242
  s_cmp_gt_i32 s80, 58
  s_cbranch_scc0 L_n242
  s_waitcnt vmcnt(5)
L_n242:
  s_waitcnt vmcnt(7)
L_b242:
  buffer_load_dwordx4 v10, s[24:27], s65 offen offset:2048 nt lds
  buffer_load_dword v50, v7, s[44:47], 0 offen sc1
  s_waitcnt lgkmcnt(0)
  v_mfma_f32_16x16x32_bf16 a[96:99], a[32:35], v[112:115], a[96:99]
  v_mfma_f32_16x16x32_bf16 a[100:103], a[36:39], v[112:115], a[100:103]
  v_mfma_f32_16x16x32_bf16 a[104:107], a[40:43], v[112:115], a[104:107]
  v_mfma_f32_16x16x32_bf16 a[108:111], a[44:47], v[112:115], a[108:111]
  s_waitcnt vmcnt(10)
  s_cbranch_vccnz L_b243
  s_waitcnt vmcnt(9)
  s_bitcmp0_b32 s77, 31
  s_cbranch_scc1 L_b243
  s_cmp_gt_i32 s80, 58
  s_cbranch_scc0 L_n243
  s_waitcnt vmcnt(6)
L_n243:
  s_waitcnt vmcnt(7)
L_b243:
  buffer_load_dwordx4 v11, s[24:27], s65 offen offset:3072 nt lds
  s_mov_b32 s18, 67584
  buffer_load_dword v191, v182, s[44:47], s18 offen sc1
  v_mfma_f32_16x16x32_bf16 a[112:115], a[48:51], v[112:115], a[112:115]
  v_mfma_f32_16x16x32_bf16 a[116:119], a[52:55], v[112:115], a[116:119]
  v_mfma_f32_16x16x32_bf16 a[120:123], a[56:59], v[112:115], a[120:123]
  v_mfma_f32_16x16x32_bf16 a[124:127], a[60:63], v[112:115], a[124:127]
  s_xor_b32 s65, s64, 0x4c4000
  s_add_u32 m0, s66, 12288
  s_sub_i32 s77, s36, 60
  s_cmp_gt_i32 s14, 59
  s_cselect_b64 vcc, -1, 0
  s_waitcnt vmcnt(11)
  s_cbranch_vccnz L_b244
  s_waitcnt vmcnt(9)
  s_bitcmp0_b32 s77, 31
  s_cbranch_scc1 L_b244
  s_cmp_gt_i32 s80, 59
  s_cbranch_scc0 L_n244
  s_waitcnt vmcnt(6)
L_n244:
  s_waitcnt vmcnt(8)
L_b244:
  buffer_load_dwordx4 v10, s[24:27], s65 offen offset:0 nt lds
  s_waitcnt vmcnt(10)
  s_cbranch_vccnz L_b245
  s_waitcnt vmcnt(9)
  s_bitcmp0_b32 s77, 31
  s_cbranch_scc1 L_b245
  s_cmp_gt_i32 s80, 59
  s_cbranch_scc0 L_n245
  s_waitcnt vmcnt(6)
L_n245:
  s_waitcnt vmcnt(7)
L_b245:
  buffer_load_dwordx4 v11, s[24:27], s65 offen offset:1024 nt lds
  s_cmp_eq_u32 s15, 3
  s_cselect_b32 s18, s16, 0x400000
  v_or_b32 v8, 59, v9
  buffer_store_dword v8, v6, s[44:47], s18 offen
  s_waitcnt vmcnt(11)
  s_cbranch_vccnz L_b246
  s_waitcnt vmcnt(9)
  s_bitcmp0_b32 s77, 31
  s_cbranch_scc1 L_b246
  s_cmp_gt_i32 s80, 59
  s_cbranch_scc0 L_n246
  s_waitcnt vmcnt(6)
L_n246:
  s_waitcnt vmcnt(8)
L_b246:
  buffer_load_dwordx4 v10, s[24:27], s65 offen offset:2048 nt lds
  s_waitcnt vmcnt(10)
  s_cbranch_vccnz L_b247
  s_waitcnt vmcnt(9)
  s_bitcmp0_b32 s77, 31
  s_cbranch_scc1 L_b247
  s_cmp_gt_i32 s80, 59
  s_cbranch_scc0 L_n247
  s_waitcnt vmcnt(5)
L_n247:
  s_waitcnt vmcnt(7)
L_b247:
  buffer_load_dwordx4 v11, s[24:27], s65 offen offset:3072 nt lds
  ds_read_b64_tr_b16 a[32:33], v16 offset:0
  ds_read_b64_tr_b16 a[36:37], v17 offset:0
  ds_read_b64_tr_b16 a[40:41], v18 offset:0
  ds_read_b64_tr_b16 a[44:45], v19 offset:0
  ds_read_b64_tr_b16 a[48:49], v20 offset:0
  ds_read_b64_tr_b16 a[52:53], v21 offset:0
  ds_read_b64_tr_b16 a[56:57], v22 offset:0
  ds_read_b64_tr_b16 a[60:61], v23 offset:0
  s_xor_b32 s65, s64, 0xe0000
  s_add_u32 m0, s66, 16384
  s_sub_i32 s77, s36, 61
  s_cmp_gt_i32 s14, 60
  s_cselect_b64 vcc, -1, 0
  s_waitcnt vmcnt(10)
  s_cbranch_vccnz L_b248
  s_waitcnt vmcnt(8)
  s_bitcmp0_b32 s77, 31
  s_cbranch_scc1 L_b248
  s_cmp_gt_i32 s80, 60
  s_cbranch_scc0 L_n248
  s_waitcnt vmcnt(4)
L_n248:
  s_waitcnt vmcnt(6)
L_b248:
  buffer_load_dwordx4 v10, s[24:27], s65 offen offset:0 nt lds
  s_waitcnt vmcnt(9)
  s_cbranch_vccnz L_b249
  s_waitcnt vmcnt(7)
  s_bitcmp0_b32 s77, 31
  s_cbranch_scc1 L_b249
  s_cmp_gt_i32 s80, 60
  s_cbranch_scc0 L_n249
  s_waitcnt vmcnt(4)
L_n249:
  s_waitcnt vmcnt(5)
L_b249:
  buffer_load_dwordx4 v11, s[24:27], s65 offen offset:1024 nt lds
  s_cmp_eq_u32 s15, 0
  s_cselect_b32 s18, s16, 0x400000
  v_or_b32 v8, 60, v9
  buffer_store_dword v8, v6, s[44:47], s18 offen
  ds_read_b64_tr_b16 a[34:35], v16 offset:4096
  ds_read_b64_tr_b16 a[38:39], v17 offset:4096
  ds_read_b64_tr_b16 a[42:43], v18 offset:4096
  ds_read_b64_tr_b16 a[46:47], v19 offset:4096
  ds_read_b64_tr_b16 a[50:51], v20 offset:4096
  ds_read_b64_tr_b16 a[54:55], v21 offset:4096
  ds_read_b64_tr_b16 a[58:59], v22 offset:4096
  ds_read_b64_tr_b16 a[62:63], v23 offset:4096
  s_waitcnt vmcnt(9)
  s_cbranch_vccnz L_b250
  s_waitcnt vmcnt(7)
  s_bitcmp0_b32 s77, 31
  s_cbranch_scc1 L_b250
  s_cmp_gt_i32 s80, 60
  s_cbranch_scc0 L_n250
  s_waitcnt vmcnt(4)
L_n250:
  s_waitcnt vmcnt(6)
L_b250:
  buffer_load_dwordx4 v10, s[24:27], s65 offen offset:2048 nt lds
  v_xor_b32 v50, s17, v50
  v_lshrrev_b32 v51, 8, v50
  v_cmp_eq_u32 s[82:83], 0, v51
  v_mov_b32 v51, 56
  s_nop 0
  v_cndmask_b32 v50, v51, v50, s[82:83]
  s_nop 1
  v_add_u32_dpp v50, v50, v50 row_ror:1 row_mask:0xf bank_mask:0xf
  s_nop 1
  v_add_u32_dpp v50, v50, v50 row_ror:2 row_mask:0xf bank_mask:0xf
  s_nop 1
  v_add_u32_dpp v50, v50, v50 row_ror:4 row_mask:0xf bank_mask:0xf
  s_nop 1
  v_add_u32_dpp v50, v50, v50 row_ror:8 row_mask:0xf bank_mask:0xf
  s_nop 0
  v_readlane_b32 s100, v50, 0
  v_readlane_b32 s101, v50, 16
  s_add_u32 s100, s100, s101
  s_sub_i32 s100, s100, 1795
  s_ashr_i32 s37, s100, 1
  s_add_i32 s101, s100, 32
  s_mul_i32 s101, s101, -20
  s_ashr_i32 s101, s101, 8
  s_min_i32 s101, s101, 4
  s_add_i32 s80, s101, 61
  s_max_i32 s80, s80, s3
  s_mul_i32 s100, s100, 24
  s_ashr_i32 s100, s100, 8
  s_min_i32 s100, s100, 8
  s_add_i32 s14, s100, 61
  s_waitcnt lgkmcnt(0)
  v_mfma_f32_16x16x32_bf16 a[96:99], a[32:35], v[116:119], a[96:99]
  v_mfma_f32_16x16x32_bf16 a[100:103], a[36:39], v[116:119], a[100:103]
  v_mfma_f32_16x16x32_bf16 a[104:107], a[40:43], v[116:119], a[104:107]
  v_mfma_f32_16x16x32_bf16 a[108:111], a[44:47], v[116:119], a[108:111]
  s_waitcnt vmcnt(8)
  s_cbranch_vccnz L_b251
  s_waitcnt vmcnt(7)
  s_bitcmp0_b32 s77, 31
  s_cbranch_scc1 L_b251
  s_cmp_gt_i32 s80, 60
  s_cbranch_scc0 L_n251
  s_waitcnt vmcnt(4)
L_n251:
  s_waitcnt vmcnt(5)
L_b251:
  buffer_load_dwordx4 v11, s[24:27], s65 offen offset:3072 nt lds
  s_bitcmp1_b32 s38, 30
  s_cbranch_scc1 L_ge2
  v_xor_b32 v184, s17, v184
  v_xor_b32 v185, s17, v185
  v_xor_b32 v186, s17, v186
  v_xor_b32 v187, s17, v187
  v_xor_b32 v188, s17, v188
  v_xor_b32 v189, s17, v189
  v_xor_b32 v190, s17, v190
  v_xor_b32 v191, s17, v191
  v_min_u32 v180, 0x100, v191
  v_lshrrev_b32 v181, 1, v180
  v_and_b32 v181, 0x80, v181
  v_and_b32 v180, 0xff, v180
  v_add_u32 v180, v180, v181
  v_lshrrev_b32 v184, 8, v184
  v_min_u32 v184, 1, v184
  v_lshlrev_b32 v184, 4, v184
  v_sub_u32 v180, v180, v184
  v_lshrrev_b32 v185, 8, v185
  v_min_u32 v185, 1, v185
  v_lshlrev_b32 v185, 4, v185
  v_sub_u32 v180, v180, v185
  v_lshrrev_b32 v186, 8, v186
  v_min_u32 v186, 1, v186
  v_lshlrev_b32 v186, 4, v186
  v_sub_u32 v180, v180, v186
  v_lshrrev_b32 v187, 8, v187
  v_min_u32 v187, 1, v187
  v_lshlrev_b32 v187, 4, v187
  v_sub_u32 v180, v180, v187
  v_lshrrev_b32 v188, 8, v188
  v_min_u32 v188, 1, v188
  v_lshlrev_b32 v188, 4, v188
  v_sub_u32 v180, v180, v188
  v_lshrrev_b32 v189, 8, v189
  v_min_u32 v189, 1, v189
  v_lshlrev_b32 v189, 4, v189
  v_sub_u32 v180, v180, v189
  v_lshrrev_b32 v190, 8, v190
  v_min_u32 v190, 1, v190
  v_lshlrev_b32 v190, 4, v190
  v_sub_u32 v180, v180, v190
  v_lshrrev_b32 v191, 8, v191
  v_min_u32 v191, 1, v191
  v_lshlrev_b32 v191, 4, v191
  v_sub_u32 v180, v180, v191
  s_and_b32 s101, s2, 7
  s_sub_i32 s100, s62, 64
  s_mov_b32 m0, s101
  v_writelane_b32 v180, s100, m0
  s_add_u32 m0, s66, 16384
  s_nop 1
  v_add_u32_dpp v180, v180, v180 quad_perm:[1,0,3,2] row_mask:0xf bank_mask:0xf
  s_nop 1
  v_add_u32_dpp v180, v180, v180 quad_perm:[2,3,0,1] row_mask:0xf bank_mask:0xf
  s_nop 1
  v_add_u32_dpp v180, v180, v180 row_half_mirror row_mask:0xf bank_mask:0xf
  s_nop 0
  v_readlane_b32 s101, v180, 0
  s_lshl_b32 s100, s100, 3
  s_sub_i32 s100, s101, s100
  s_add_i32 s100, s100, -32
  s_mul_i32 s100, s100, 96
  s_add_i32 s100, s100, 512
  s_ashr_i32 s100, s100, 10
  s_max_i32 s100, s100, -16
  s_min_i32 s100, s100, 16
  s_add_i32 s100, s100, 128
  v_or_b32 v180, s100, v9
  buffer_store_dword v180, v6, s[44:47], s39 offen offset:8
L_ge2:
  v_mfma_f32_16x16x32_bf16 a[112:115], a[48:51], v[116:119], a[112:115]
  v_mfma_f32_16x16x32_bf16 a[116:119], a[52:55], v[116:119], a[116:119]
  v_mfma_f32_16x16x32_bf16 a[120:123], a[56:59], v[116:119], a[120:123]
  v_mfma_f32_16x16x32_bf16 a[124:127], a[60:63], v[116:119], a[124:127]
  s_xor_b32 s65, s64, 0xe4000
  s_add_u32 m0, s66, 20480
  s_sub_i32 s77, s36, 62
  s_cmp_gt_i32 s14, 61
  s_cselect_b64 vcc, -1, 0
  s_waitcnt vmcnt(8)
  s_cbranch_vccnz L_b252
  s_waitcnt vmcnt(6)
  s_bitcmp0_b32 s77, 31
  s_cbranch_scc1 L_b252
  s_cmp_gt_i32 s80, 61
  s_cbranch_scc0 L_n252
  s_waitcnt vmcnt(4)
L_n252:
  s_waitcnt vmcnt(5)
L_b252:
  buffer_load_dwordx4 v10, s[24:27], s65 offen offset:0 nt lds
  ds_read_b64_tr_b16 a[32:33], v16 offset:8192
  ds_read_b64_tr_b16 a[36:37], v17 offset:8192
  ds_read_b64_tr_b16 a[40:41], v18 offset:8192
  ds_read_b64_tr_b16 a[44:45], v19 offset:8192
  ds_read_b64_tr_b16 a[48:49], v20 offset:8192
  ds_read_b64_tr_b16 a[52:53], v21 offset:8192
  ds_read_b64_tr_b16 a[56:57], v22 offset:8192
  ds_read_b64_tr_b16 a[60:61], v23 offset:8192
  s_waitcnt vmcnt(7)
  s_cbranch_vccnz L_b253
  s_waitcnt vmcnt(6)
  s_bitcmp0_b32 s77, 31
  s_cbranch_scc1 L_b253
  s_cmp_gt_i32 s80, 61
  s_cbranch_scc0 L_n253
  s_waitcnt vmcnt(4)
L_n253:
  s_waitcnt vmcnt(5)
L_b253:
  buffer_load_dwordx4 v11, s[24:27], s65 offen offset:1024 nt lds
  s_cmp_eq_u32 s15, 1
  s_cselect_b32 s18, s16, 0x400000
  v_or_b32 v8, 61, v9
  buffer_store_dword v8, v6, s[44:47], s18 offen
  s_waitcnt vmcnt(8)
  s_cbranch_vccnz L_b254
  s_waitcnt vmcnt(7)
  s_bitcmp0_b32 s77, 31
  s_cbranch_scc1 L_b254
  s_cmp_gt_i32 s80, 61
  s_cbranch_scc0 L_n254
  s_waitcnt vmcnt(4)
L_n254:
  s_waitcnt vmcnt(6)
L_b254:
  buffer_load_dwordx4 v10, s[24:27], s65 offen offset:2048 nt lds
  s_waitcnt vmcnt(8)
  s_cbranch_vccnz L_b255
  s_waitcnt vmcnt(7)
  s_bitcmp0_b32 s77, 31
  s_cbranch_scc1 L_b255
  s_cmp_gt_i32 s80, 61
  s_cbranch_scc0 L_n255
  s_waitcnt vmcnt(4)
L_n255:
  s_waitcnt vmcnt(5)
L_b255:
  buffer_load_dwordx4 v11, s[24:27], s65 offen offset:3072 nt lds
  s_xor_b32 s65, s64, 0x4e0000
  s_add_u32 m0, s66, 24576
  s_sub_i32 s77, s36, 63
  s_cmp_gt_i32 s14, 62
  s_cselect_b64 vcc, -1, 0
  s_waitcnt vmcnt(8)
  s_cbranch_vccnz L_b256
  s_waitcnt vmcnt(6)
  s_bitcmp0_b32 s77, 31
  s_cbranch_scc1 L_b256
  s_cmp_gt_i32 s80, 62
  s_cbranch_scc0 L_n256
  s_waitcnt vmcnt(4)
L_n256:
  s_waitcnt vmcnt(5)
L_b256:
  buffer_load_dwordx4 v10, s[24:27], s65 offen offset:0 nt lds
  ds_read_b64_tr_b16 a[34:35], v16 offset:12288
  ds_read_b64_tr_b16 a[38:39], v17 offset:12288
  ds_read_b64_tr_b16 a[42:43], v18 offset:12288
  ds_read_b64_tr_b16 a[46:47], v19 offset:12288
  ds_read_b64_tr_b16 a[50:51], v20 offset:12288
  ds_read_b64_tr_b16 a[54:55], v21 offset:12288
  ds_read_b64_tr_b16 a[58:59], v22 offset:12288
  ds_read_b64_tr_b16 a[62:63], v23 offset:12288
  s_waitcnt vmcnt(7)
  s_cbranch_vccnz L_b257
  s_waitcnt vmcnt(6)
  s_bitcmp0_b32 s77, 31
  s_cbranch_scc1 L_b257
  s_cmp_gt_i32 s80, 62
  s_cbranch_scc0 L_n257
  s_waitcnt vmcnt(4)
L_n257:
  s_waitcnt vmcnt(5)
L_b257:
  buffer_load_dwordx4 v11, s[24:27], s65 offen offset:1024 nt lds
  s_cmp_eq_u32 s15, 2
  s_cselect_b32 s18, s16, 0x400000
  v_or_b32 v8, 62, v9
  buffer_store_dword v8, v6, s[44:47], s18 offen
  s_waitcnt lgkmcnt(0)
  v_mfma_f32_16x16x32_bf16 a[96:99], a[32:35], v[120:123], a[96:99]
  v_mfma_f32_16x16x32_bf16 a[100:103], a[36:39], v[120:123], a[100:103]
  v_mfma_f32_16x16x32_bf16 a[104:107], a[40:43], v[120:123], a[104:107]
  v_mfma_f32_16x16x32_bf16 a[108:111], a[44:47], v[120:123], a[108:111]
  s_waitcnt vmcnt(8)
  s_cbranch_vccnz L_b258
  s_waitcnt vmcnt(7)
  s_bitcmp0_b32 s77, 31
  s_cbranch_scc1 L_b258
  s_cmp_gt_i32 s80, 62
  s_cbranch_scc0 L_n258
  s_waitcnt vmcnt(4)
L_n258:
  s_waitcnt vmcnt(6)
L_b258:
  buffer_load_dwordx4 v10, s[24:27], s65 offen offset:2048 nt lds
  buffer_load_dword v50, v7, s[44:47], 0 offen sc1
  v_mfma_f32_16x16x32_bf16 a[112:115], a[48:51], v[120:123], a[112:115]
  v_mfma_f32_16x16x32_bf16 a[116:119], a[52:55], v[120:123], a[116:119]
  v_mfma_f32_16x16x32_bf16 a[120:123], a[56:59], v[120:123], a[120:123]
  v_mfma_f32_16x16x32_bf16 a[124:127], a[60:63], v[120:123], a[124:127]
  s_waitcnt vmcnt(9)
  s_cbranch_vccnz L_b259
  s_waitcnt vmcnt(8)
  s_bitcmp0_b32 s77, 31
  s_cbranch_scc1 L_b259
  s_cmp_gt_i32 s80, 62
  s_cbranch_scc0 L_n259
  s_waitcnt vmcnt(5)
L_n259:
  s_waitcnt vmcnt(6)
L_b259:
  buffer_load_dwordx4 v11, s[24:27], s65 offen offset:3072 nt lds
  s_xor_b32 s65, s64, 0x4e4000
  s_add_u32 m0, s66, 0
  s_sub_i32 s77, s36, 64
  s_cmp_gt_i32 s14, 63
  s_cselect_b64 vcc, -1, 0
  s_waitcnt vmcnt(9)
  s_cbranch_vccnz L_b260
  s_waitcnt vmcnt(7)
  s_bitcmp0_b32 s77, 31
  s_cbranch_scc1 L_b260
  s_cmp_gt_i32 s80, 63
  s_cbranch_scc0 L_n260
  s_waitcnt vmcnt(5)
L_n260:
  s_waitcnt vmcnt(6)
L_b260:
  buffer_load_dwordx4 v10, s[24:27], s65 offen offset:0 nt lds
  s_waitcnt vmcnt(8)
  s_cbranch_vccnz L_b261
  s_waitcnt vmcnt(7)
  s_bitcmp0_b32 s77, 31
  s_cbranch_scc1 L_b261
  s_cmp_gt_i32 s80, 63
  s_cbranch_scc0 L_n261
  s_waitcnt vmcnt(5)
L_n261:
  s_waitcnt vmcnt(6)
L_b261:
  buffer_load_dwordx4 v11, s[24:27], s65 offen offset:1024 nt lds
  s_cmp_eq_u32 s15, 3
  s_cselect_b32 s18, s16, 0x400000
  v_or_b32 v8, 63, v9
  buffer_store_dword v8, v6, s[44:47], s18 offen
  ds_read_b64_tr_b16 a[32:33], v16 offset:16384
  ds_read_b64_tr_b16 a[36:37], v17 offset:16384
  ds_read_b64_tr_b16 a[40:41], v18 offset:16384
  ds_read_b64_tr_b16 a[44:45], v19 offset:16384
  ds_read_b64_tr_b16 a[48:49], v20 offset:16384
  ds_read_b64_tr_b16 a[52:53], v21 offset:16384
  ds_read_b64_tr_b16 a[56:57], v22 offset:16384
  ds_read_b64_tr_b16 a[60:61], v23 offset:16384
  s_waitcnt vmcnt(9)
  s_cbranch_vccnz L_b262
  s_waitcnt vmcnt(8)
  s_bitcmp0_b32 s77, 31
  s_cbranch_scc1 L_b262
  s_cmp_gt_i32 s80, 63
  s_cbranch_scc0 L_n262
  s_waitcnt vmcnt(5)
L_n262:
  s_waitcnt vmcnt(7)
L_b262:
  buffer_load_dwordx4 v10, s[24:27], s65 offen offset:2048 nt lds
  s_waitcnt vmcnt(9)
  s_cbranch_vccnz L_b263
  s_waitcnt vmcnt(8)
  s_bitcmp0_b32 s77, 31
  s_cbranch_scc1 L_b263
  s_cmp_gt_i32 s80, 63
  s_cbranch_scc0 L_n263
  s_waitcnt vmcnt(4)
L_n263:
  s_waitcnt vmcnt(6)
L_b263:
  buffer_load_dwordx4 v11, s[24:27], s65 offen offset:3072 nt lds
  s_xor_b32 s65, s64, 0x0
  s_add_u32 m0, s66, 4096
  s_sub_i32 s77, s36, 65
  s_cmp_gt_i32 s14, 64
  s_cselect_b64 vcc, -1, 0
  s_waitcnt vmcnt(9)
  s_cbranch_vccnz L_b264
  s_waitcnt vmcnt(7)
  s_bitcmp0_b32 s77, 31
  s_cbranch_scc1 L_b264
  s_cmp_gt_i32 s80, 64
  s_cbranch_scc0 L_n264
  s_waitcnt vmcnt(4)
L_n264:
  s_waitcnt vmcnt(5)
L_b264:
  buffer_load_dwordx4 v10, s[28:31], s65 offen offset:0 nt lds
  s_waitcnt vmcnt(8)
  s_cbranch_vccnz L_b265
  s_waitcnt vmcnt(6)
  s_bitcmp0_b32 s77, 31
  s_cbranch_scc1 L_b265
  s_cmp_gt_i32 s80, 64
  s_cbranch_scc0 L_n265
  s_waitcnt vmcnt(4)
L_n265:
  s_waitcnt vmcnt(5)
L_b265:
  buffer_load_dwordx4 v11, s[28:31], s65 offen offset:1024 nt lds
  s_cmp_eq_u32 s15, 0
  s_cselect_b32 s18, s16, 0x400000
  v_or_b32 v8, 64, v9
  buffer_store_dword v8, v6, s[44:47], s18 offen
  ds_read_b64_tr_b16 a[34:35], v16 offset:20480
  ds_read_b64_tr_b16 a[38:39], v17 offset:20480
  ds_read_b64_tr_b16 a[42:43], v18 offset:20480
  ds_read_b64_tr_b16 a[46:47], v19 offset:20480
  ds_read_b64_tr_b16 a[50:51], v20 offset:20480
  ds_read_b64_tr_b16 a[54:55], v21 offset:20480
  ds_read_b64_tr_b16 a[58:59], v22 offset:20480
  ds_read_b64_tr_b16 a[62:63], v23 offset:20480
  s_waitcnt vmcnt(8)
  s_cbranch_vccnz L_b266
  s_waitcnt vmcnt(7)
  s_bitcmp0_b32 s77, 31
  s_cbranch_scc1 L_b266
  s_cmp_gt_i32 s80, 64
  s_cbranch_scc0 L_n266
  s_waitcnt vmcnt(4)
L_n266:
  s_waitcnt vmcnt(6)
L_b266:
  buffer_load_dwordx4 v10, s[28:31], s65 offen offset:2048 nt lds
  v_xor_b32 v50, s17, v50
  v_lshrrev_b32 v51, 8, v50
  v_readlane_b32 s100, v50, 34
  s_cmp_lt_u32 s100, 256
  s_cselect_b32 s100, s100, 128
  s_add_i32 s36, s100, -63
  s_sub_i32 s3, 122, s100
  s_ashr_i32 s3, s3, 2
  s_add_i32 s3, s3, 65
  v_cmp_eq_u32 s[82:83], 0, v51
  v_mov_b32 v51, 60
  s_nop 0
  v_cndmask_b32 v50, v51, v50, s[82:83]
  s_nop 1
  v_add_u32_dpp v50, v50, v50 row_ror:1 row_mask:0xf bank_mask:0xf
  s_nop 1
  v_add_u32_dpp v50, v50, v50 row_ror:2 row_mask:0xf bank_mask:0xf
  s_nop 1
  v_add_u32_dpp v50, v50, v50 row_ror:4 row_mask:0xf bank_mask:0xf
  s_nop 1
  v_add_u32_dpp v50, v50, v50 row_ror:8 row_mask:0xf bank_mask:0xf
  s_nop 0
  v_readlane_b32 s100, v50, 0
  v_readlane_b32 s101, v50, 16
  s_add_u32 s100, s100, s101
  s_sub_i32 s100, s100, 1923
  s_ashr_i32 s37, s100, 1
  s_add_i32 s101, s100, 32
  s_mul_i32 s101, s101, -20
  s_ashr_i32 s101, s101, 8
  s_min_i32 s101, s101, 4
  s_add_i32 s80, s101, 65
  s_max_i32 s80, s80, s3
  s_mul_i32 s100, s100, 24
  s_ashr_i32 s100, s100, 8
  s_min_i32 s100, s100, 8
  s_add_i32 s14, s100, 65
  s_waitcnt lgkmcnt(0)
  v_mfma_f32_16x16x32_bf16 a[96:99], a[32:35], v[124:127], a[96:99]
  v_mfma_f32_16x16x32_bf16 a[100:103], a[36:39], v[124:127], a[100:103]
  v_mfma_f32_16x16x32_bf16 a[104:107], a[40:43], v[124:127], a[104:107]
  v_mfma_f32_16x16x32_bf16 a[108:111], a[44:47], v[124:127], a[108:111]
  s_waitcnt vmcnt(8)
  s_cbranch_vccnz L_b267
  s_waitcnt vmcnt(7)
  s_bitcmp0_b32 s77, 31
  s_cbranch_scc1 L_b267
  s_cmp_gt_i32 s80, 64
  s_cbranch_scc0 L_n267
  s_waitcnt vmcnt(4)
L_n267:
  s_waitcnt vmcnt(5)
L_b267:
  buffer_load_dwordx4 v11, s[28:31], s65 offen offset:3072 nt lds
  v_mfma_f32_16x16x32_bf16 a[112:115], a[48:51], v[124:127], a[112:115]
  v_mfma_f32_16x16x32_bf16 a[116:119], a[52:55], v[124:127], a[116:119]
  v_mfma_f32_16x16x32_bf16 a[120:123], a[56:59], v[124:127], a[120:123]
  v_mfma_f32_16x16x32_bf16 a[124:127], a[60:63], v[124:127], a[124:127]
  s_xor_b32 s65, s64, 0x4000
  s_add_u32 m0, s66, 8192
  s_sub_i32 s77, s36, 66
  s_cmp_gt_i32 s14, 65
  s_cselect_b64 vcc, -1, 0
  s_waitcnt vmcnt(8)
  s_cbranch_vccnz L_b268
  s_waitcnt vmcnt(6)
  s_bitcmp0_b32 s77, 31
  s_cbranch_scc1 L_b268
  s_cmp_gt_i32 s80, 65
  s_cbranch_scc0 L_n268
  s_waitcnt vmcnt(4)
L_n268:
  s_waitcnt vmcnt(5)
L_b268:
  buffer_load_dwordx4 v10, s[28:31], s65 offen offset:0 nt lds
  ds_read_b64_tr_b16 a[32:33], v16 offset:24576
  ds_read_b64_tr_b16 a[36:37], v17 offset:24576
  ds_read_b64_tr_b16 a[40:41], v18 offset:24576
  ds_read_b64_tr_b16 a[44:45], v19 offset:24576
  ds_read_b64_tr_b16 a[48:49], v20 offset:24576
  ds_read_b64_tr_b16 a[52:53], v21 offset:24576
  ds_read_b64_tr_b16 a[56:57], v22 offset:24576
  ds_read_b64_tr_b16 a[60:61], v23 offset:24576
  s_waitcnt vmcnt(7)
  s_cbranch_vccnz L_b269
  s_waitcnt vmcnt(6)
  s_bitcmp0_b32 s77, 31
  s_cbranch_scc1 L_b269
  s_cmp_gt_i32 s80, 65
  s_cbranch_scc0 L_n269
  s_waitcnt vmcnt(4)
L_n269:
  s_waitcnt vmcnt(5)
L_b269:
  buffer_load_dwordx4 v11, s[28:31], s65 offen offset:1024 nt lds
  s_cmp_eq_u32 s15, 1
  s_cselect_b32 s18, s16, 0x400000
  v_or_b32 v8, 65, v9
  buffer_store_dword v8, v6, s[44:47], s18 offen
  s_waitcnt vmcnt(8)
  s_cbranch_vccnz L_b270
  s_waitcnt vmcnt(7)
  s_bitcmp0_b32 s77, 31
  s_cbranch_scc1 L_b270
  s_cmp_gt_i32 s80, 65
  s_cbranch_scc0 L_n270
  s_waitcnt vmcnt(4)
L_n270:
  s_waitcnt vmcnt(6)
L_b270:
  buffer_load_dwordx4 v10, s[28:31], s65 offen offset:2048 nt lds
  s_waitcnt vmcnt(8)
  s_cbranch_vccnz L_b271
  s_waitcnt vmcnt(7)
  s_bitcmp0_b32 s77, 31
  s_cbranch_scc1 L_b271
  s_cmp_gt_i32 s80, 65
  s_cbranch_scc0 L_n271
  s_waitcnt vmcnt(4)
L_n271:
  s_waitcnt vmcnt(5)
L_b271:
  buffer_load_dwordx4 v11, s[28:31], s65 offen offset:3072 nt lds
  s_xor_b32 s65, s64, 0x400000
  s_add_u32 m0, s66, 12288
  s_sub_i32 s77, s36, 67
  s_cmp_gt_i32 s14, 66
  s_cselect_b64 vcc, -1, 0
  s_waitcnt vmcnt(8)
  s_cbranch_vccnz L_b272
  s_waitcnt vmcnt(6)
  s_bitcmp0_b32 s77, 31
  s_cbranch_scc1 L_b272
  s_cmp_gt_i32 s80, 66
  s_cbranch_scc0 L_n272
  s_waitcnt vmcnt(4)
L_n272:
  s_waitcnt vmcnt(5)
L_b272:
  buffer_load_dwordx4 v10, s[28:31], s65 offen offset:0 nt lds
  ds_read_b64_tr_b16 a[34:35], v16 offset:0
  ds_read_b64_tr_b16 a[38:39], v17 offset:0
  ds_read_b64_tr_b16 a[42:43], v18 offset:0
  ds_read_b64_tr_b16 a[46:47], v19 offset:0
  ds_read_b64_tr_b16 a[50:51], v20 offset:0
  ds_read_b64_tr_b16 a[54:55], v21 offset:0
  ds_read_b64_tr_b16 a[58:59], v22 offset:0
  ds_read_b64_tr_b16 a[62:63], v23 offset:0
  s_waitcnt vmcnt(7)
  s_cbranch_vccnz L_b273
  s_waitcnt vmcnt(6)
  s_bitcmp0_b32 s77, 31
  s_cbranch_scc1 L_b273
  s_cmp_gt_i32 s80, 66
  s_cbranch_scc0 L_n273
  s_waitcnt vmcnt(4)
L_n273:
  s_waitcnt vmcnt(5)
L_b273:
  buffer_load_dwordx4 v11, s[28:31], s65 offen offset:1024 nt lds
  s_cmp_eq_u32 s15, 2
  s_cselect_b32 s18, s16, 0x400000
  v_or_b32 v8, 66, v9
  buffer_store_dword v8, v6, s[44:47], s18 offen
  s_waitcnt lgkmcnt(0)
  v_mfma_f32_16x16x32_bf16 a[96:99], a[32:35], v[128:131], a[96:99]
  v_mfma_f32_16x16x32_bf16 a[100:103], a[36:39], v[128:131], a[100:103]
  v_mfma_f32_16x16x32_bf16 a[104:107], a[40:43], v[128:131], a[104:107]
  v_mfma_f32_16x16x32_bf16 a[108:111], a[44:47], v[128:131], a[108:111]
  s_waitcnt vmcnt(8)
  s_cbranch_vccnz L_b274
  s_waitcnt vmcnt(7)
  s_bitcmp0_b32 s77, 31
  s_cbranch_scc1 L_b274
  s_cmp_gt_i32 s80, 66
  s_cbranch_scc0 L_n274
  s_waitcnt vmcnt(4)
L_n274:
  s_waitcnt vmcnt(6)
L_b274:
  buffer_load_dwordx4 v10, s[28:31], s65 offen offset:2048 nt lds
  buffer_load_dword v50, v7, s[44:47], 0 offen sc1
  v_mfma_f32_16x16x32_bf16 a[112:115], a[48:51], v[128:131], a[112:115]
  v_mfma_f32_16x16x32_bf16 a[116:119], a[52:55], v[128:131], a[116:119]
  v_mfma_f32_16x16x32_bf16 a[120:123], a[56:59], v[128:131], a[120:123]
  v_mfma_f32_16x16x32_bf16 a[124:127], a[60:63], v[128:131], a[124:127]
  s_waitcnt vmcnt(9)
  s_cbranch_vccnz L_b275
  s_waitcnt vmcnt(8)
  s_bitcmp0_b32 s77, 31
  s_cbranch_scc1 L_b275
  s_cmp_gt_i32 s80, 66
  s_cbranch_scc0 L_n275
  s_waitcnt vmcnt(5)
L_n275:
  s_waitcnt vmcnt(6)
L_b275:
  buffer_load_dwordx4 v11, s[28:31], s65 offen offset:3072 nt lds
  s_nop 5
  s_mov_b32 exec_lo, 0x000f000f
  s_mov_b32 exec_hi, 0x000f000f
  ds_write_b32 v37, v25 offset:0
  ds_write_b32 v37, a128 offset:128
  ds_write_b128 v35, a[96:99] offset:0
  ds_write_b128 v35, a[100:103] offset:64
  ds_write_b128 v35, a[104:107] offset:128
  ds_write_b128 v35, a[108:111] offset:192
  ds_write_b128 v35, a[112:115] offset:256
  ds_write_b128 v35, a[116:119] offset:320
  ds_write_b128 v35, a[120:123] offset:384
  ds_write_b128 v35, a[124:127] offset:448
  s_mov_b64 exec, -1
  s_xor_b32 s65, s64, 0x404000
  s_add_u32 m0, s66, 16384
  s_sub_i32 s77, s36, 68
  s_cmp_gt_i32 s14, 67
  s_cselect_b64 vcc, -1, 0
  s_waitcnt vmcnt(9)
  s_cbranch_vccnz L_b276
  s_waitcnt vmcnt(7)
  s_bitcmp0_b32 s77, 31
  s_cbranch_scc1 L_b276
  s_cmp_gt_i32 s80, 67
  s_cbranch_scc0 L_n276
  s_waitcnt vmcnt(5)
L_n276:
  s_waitcnt vmcnt(6)
L_b276:
  buffer_load_dwordx4 v10, s[28:31], s65 offen offset:0 nt lds
  s_waitcnt vmcnt(8)
  s_cbranch_vccnz L_b277
  s_waitcnt vmcnt(7)
  s_bitcmp0_b32 s77, 31
  s_cbranch_scc1 L_b277
  s_cmp_gt_i32 s80, 67
  s_cbranch_scc0 L_n277
  s_waitcnt vmcnt(5)
L_n277:
  s_waitcnt vmcnt(6)
L_b277:
  buffer_load_dwordx4 v11, s[28:31], s65 offen offset:1024 nt lds
  s_cmp_eq_u32 s15, 3
  s_cselect_b32 s18, s16, 0x400000
  v_or_b32 v8, 67, v9
  buffer_store_dword v8, v6, s[44:47], s18 offen
  ds_read_b128 a[196:199], v12 offset:4096
  ds_read_b128 a[200:203], v13 offset:4096
  ds_read_b128 a[204:207], v14 offset:4096
  ds_read_b128 a[208:211], v15 offset:4096
  s_waitcnt vmcnt(9)
  s_cbranch_vccnz L_b278
  s_waitcnt vmcnt(8)
  s_bitcmp0_b32 s77, 31
  s_cbranch_scc1 L_b278
  s_cmp_gt_i32 s80, 67
  s_cbranch_scc0 L_n278
  s_waitcnt vmcnt(5)
L_n278:
  s_waitcnt vmcnt(7)
L_b278:
  buffer_load_dwordx4 v10, s[28:31], s65 offen offset:2048 nt lds
  s_waitcnt lgkmcnt(0)
  v_mfma_f32_16x16x32_bf16 v[52:55], a[196:199], a[16:19], 0
  v_mfma_f32_16x16x32_bf16 v[52:55], a[200:203], a[20:23], v[52:55]
  v_mfma_f32_16x16x32_bf16 v[52:55], a[204:207], a[24:27], v[52:55]
  v_mfma_f32_16x16x32_bf16 v[52:55], a[208:211], a[28:31], v[52:55]
  s_waitcnt vmcnt(9)
  s_cbranch_vccnz L_b279
  s_waitcnt vmcnt(8)
  s_bitcmp0_b32 s77, 31
  s_cbranch_scc1 L_b279
  s_cmp_gt_i32 s80, 67
  s_cbranch_scc0 L_n279
  s_waitcnt vmcnt(4)
L_n279:
  s_waitcnt vmcnt(6)
L_b279:
  buffer_load_dwordx4 v11, s[28:31], s65 offen offset:3072 nt lds
  s_mov_b32 s18, 101376
  buffer_load_dword v184, v182, s[44:47], s18 offen sc1
  s_nop 7
  v_cvt_pk_bf16_f32 v52, 0, v52
  v_cvt_pk_bf16_f32 v53, 0, v53
  v_cvt_pk_bf16_f32 v54, 0, v54
  v_cvt_pk_bf16_f32 v55, 0, v55
  v_mul_f32 v52, s72, v52
  v_mul_f32 v53, s72, v53
  v_mul_f32 v54, s72, v54
  v_mul_f32 v55, s72, v55
  v_max_f32 v24, v52, v53
  v_cvt_pk_bf16_f32 v68, v52, v53
  v_max3_f32 v24, v24, v54, v55
  v_cvt_pk_bf16_f32 v69, v54, v55
  s_xor_b32 s65, s64, 0x20000
  s_add_u32 m0, s66, 20480
  s_sub_i32 s77, s36, 69
  s_cmp_gt_i32 s14, 68
  s_cselect_b64 vcc, -1, 0
  s_waitcnt vmcnt(10)
  s_cbranch_vccnz L_b280
  s_waitcnt vmcnt(8)
  s_bitcmp0_b32 s77, 31
  s_cbranch_scc1 L_b280
  s_cmp_gt_i32 s80, 68
  s_cbranch_scc0 L_n280
  s_waitcnt vmcnt(5)
L_n280:
  s_waitcnt vmcnt(6)
L_b280:
  buffer_load_dwordx4 v10, s[28:31], s65 offen offset:0 nt lds
  s_waitcnt vmcnt(9)
  s_cbranch_vccnz L_b281
  s_waitcnt vmcnt(7)
  s_bitcmp0_b32 s77, 31
  s_cbranch_scc1 L_b281
  s_cmp_gt_i32 s80, 68
  s_cbranch_scc0 L_n281
  s_waitcnt vmcnt(5)
L_n281:
  s_waitcnt vmcnt(6)
L_b281:
  buffer_load_dwordx4 v11, s[28:31], s65 offen offset:1024 nt lds
  s_cmp_eq_u32 s15, 0
  s_cselect_b32 s18, s16, 0x400000
  v_or_b32 v8, 68, v9
  buffer_store_dword v8, v6, s[44:47], s18 offen
  ds_read_b128 a[132:135], v12 offset:8192
  ds_read_b128 a[136:139], v13 offset:8192
  ds_read_b128 a[140:143], v14 offset:8192
  ds_read_b128 a[144:147], v15 offset:8192
  s_waitcnt vmcnt(9)
  s_cbranch_vccnz L_b282
  s_waitcnt vmcnt(8)
  s_bitcmp0_b32 s77, 31
  s_cbranch_scc1 L_b282
  s_cmp_gt_i32 s80, 68
  s_cbranch_scc0 L_n282
  s_waitcnt vmcnt(5)
L_n282:
  s_waitcnt vmcnt(7)
L_b282:
  buffer_load_dwordx4 v10, s[28:31], s65 offen offset:2048 nt lds
  v_xor_b32 v50, s17, v50
  v_lshrrev_b32 v51, 8, v50
  v_cmp_eq_u32 s[82:83], 0, v51
  v_mov_b32 v51, 64
  s_nop 0
  v_cndmask_b32 v50, v51, v50, s[82:83]
  s_nop 1
  v_add_u32_dpp v50, v50, v50 row_ror:1 row_mask:0xf bank_mask:0xf
  s_nop 1
  v_add_u32_dpp v50, v50, v50 row_ror:2 row_mask:0xf bank_mask:0xf
  s_nop 1
  v_add_u32_dpp v50, v50, v50 row_ror:4 row_mask:0xf bank_mask:0xf
  s_nop 1
  v_add_u32_dpp v50, v50, v50 row_ror:8 row_mask:0xf bank_mask:0xf
  s_nop 0
  v_readlane_b32 s100, v50, 0
  v_readlane_b32 s101, v50, 16
  s_add_u32 s100, s100, s101
  s_sub_i32 s100, s100, 2051
  s_ashr_i32 s37, s100, 1
  s_add_i32 s101, s100, 32
  s_mul_i32 s101, s101, -20
  s_ashr_i32 s101, s101, 8
  s_min_i32 s101, s101, 4
  s_add_i32 s80, s101, 69
  s_max_i32 s80, s80, s3
  s_mul_i32 s100, s100, 24
  s_ashr_i32 s100, s100, 8
  s_min_i32 s100, s100, 8
  s_add_i32 s14, s100, 69
  s_waitcnt lgkmcnt(0)
  v_mfma_f32_16x16x32_bf16 v[52:55], a[132:135], a[16:19], 0
  v_mfma_f32_16x16x32_bf16 v[52:55], a[136:139], a[20:23], v[52:55]
  v_mfma_f32_16x16x32_bf16 v[52:55], a[140:143], a[24:27], v[52:55]
  v_mfma_f32_16x16x32_bf16 v[52:55], a[144:147], a[28:31], v[52:55]
  s_waitcnt vmcnt(9)
  s_cbranch_vccnz L_b283
  s_waitcnt vmcnt(8)
  s_bitcmp0_b32 s77, 31
  s_cbranch_scc1 L_b283
  s_cmp_gt_i32 s80, 68
  s_cbranch_scc0 L_n283
  s_waitcnt vmcnt(5)
L_n283:
  s_waitcnt vmcnt(6)
L_b283:
  buffer_load_dwordx4 v11, s[28:31], s65 offen offset:3072 nt lds
  s_mov_b32 s18, 101376
  buffer_load_dword v185, v182, s[44:47], s18 offen sc1
  s_nop 7
  v_cvt_pk_bf16_f32 v52, 0, v52
  v_cvt_pk_bf16_f32 v53, 0, v53
  v_cvt_pk_bf16_f32 v54, 0, v54
  v_cvt_pk_bf16_f32 v55, 0, v55
  v_mul_f32 v52, s72, v52
  v_mul_f32 v53, s72, v53
  v_mul_f32 v54, s72, v54
  v_mul_f32 v55, s72, v55
  v_max3_f32 v24, v24, v52, v53
  v_cvt_pk_bf16_f32 v70, v52, v53
  v_max3_f32 v24, v24, v54, v55
  v_cvt_pk_bf16_f32 v71, v54, v55
  s_xor_b32 s65, s64, 0x24000
  s_add_u32 m0, s66, 24576
  s_sub_i32 s77, s36, 70
  s_cmp_gt_i32 s14, 69
  s_cselect_b64 vcc, -1, 0
  s_waitcnt vmcnt(10)
  s_cbranch_vccnz L_b284
  s_waitcnt vmcnt(8)
  s_bitcmp0_b32 s77, 31
  s_cbranch_scc1 L_b284
  s_cmp_gt_i32 s80, 69
  s_cbranch_scc0 L_n284
  s_waitcnt vmcnt(5)
L_n284:
  s_waitcnt vmcnt(7)
L_b284:
  buffer_load_dwordx4 v10, s[28:31], s65 offen offset:0 nt lds
  s_waitcnt vmcnt(9)
  s_cbranch_vccnz L_b285
  s_waitcnt vmcnt(8)
  s_bitcmp0_b32 s77, 31
  s_cbranch_scc1 L_b285
  s_cmp_gt_i32 s80, 69
  s_cbranch_scc0 L_n285
  s_waitcnt vmcnt(5)
L_n285:
  s_waitcnt vmcnt(6)
L_b285:
  buffer_load_dwordx4 v11, s[28:31], s65 offen offset:1024 nt lds
  s_cmp_eq_u32 s15, 1
  s_cselect_b32 s18, s16, 0x400000
  v_or_b32 v8, 69, v9
  buffer_store_dword v8, v6, s[44:47], s18 offen
  ds_read_b128 a[148:151], v12 offset:12288
  ds_read_b128 a[152:155], v13 offset:12288
  ds_read_b128 a[156:159], v14 offset:12288
  ds_read_b128 a[160:163], v15 offset:12288
  s_waitcnt vmcnt(10)
  s_cbranch_vccnz L_b286
  s_waitcnt vmcnt(8)
  s_bitcmp0_b32 s77, 31
  s_cbranch_scc1 L_b286
  s_cmp_gt_i32 s80, 69
  s_cbranch_scc0 L_n286
  s_waitcnt vmcnt(5)
L_n286:
  s_waitcnt vmcnt(7)
L_b286:
  buffer_load_dwordx4 v10, s[28:31], s65 offen offset:2048 nt lds
  s_waitcnt lgkmcnt(0)
  v_mfma_f32_16x16x32_bf16 v[52:55], a[148:151], a[16:19], 0
  v_mfma_f32_16x16x32_bf16 v[52:55], a[152:155], a[20:23], v[52:55]
  v_mfma_f32_16x16x32_bf16 v[52:55], a[156:159], a[24:27], v[52:55]
  v_mfma_f32_16x16x32_bf16 v[52:55], a[160:163], a[28:31], v[52:55]
  s_waitcnt vmcnt(9)
  s_cbranch_vccnz L_b287
  s_waitcnt vmcnt(8)
  s_bitcmp0_b32 s77, 31
  s_cbranch_scc1 L_b287
  s_cmp_gt_i32 s80, 69
  s_cbranch_scc0 L_n287
  s_waitcnt vmcnt(5)
L_n287:
  s_waitcnt vmcnt(6)
L_b287:
  buffer_load_dwordx4 v11, s[28:31], s65 offen offset:3072 nt lds
  s_mov_b32 s18, 101376
  buffer_load_dword v186, v182, s[44:47], s18 offen sc1
  s_nop 7
  v_cvt_pk_bf16_f32 v52, 0, v52
  v_cvt_pk_bf16_f32 v53, 0, v53
  v_cvt_pk_bf16_f32 v54, 0, v54
  v_cvt_pk_bf16_f32 v55, 0, v55
  v_mul_f32 v52, s72, v52
  v_mul_f32 v53, s72, v53
  v_mul_f32 v54, s72, v54
  v_mul_f32 v55, s72, v55
  v_max3_f32 v24, v24, v52, v53
  v_cvt_pk_bf16_f32 v72, v52, v53
  v_max3_f32 v24, v24, v54, v55
  v_cvt_pk_bf16_f32 v73, v54, v55
  s_xor_b32 s65, s64, 0x420000
  s_add_u32 m0, s66, 0
  s_sub_i32 s77, s36, 71
  s_cmp_gt_i32 s14, 70
  s_cselect_b64 vcc, -1, 0
  s_waitcnt vmcnt(10)
  s_cbranch_vccnz L_b288
  s_waitcnt vmcnt(8)
  s_bitcmp0_b32 s77, 31
  s_cbranch_scc1 L_b288
  s_cmp_gt_i32 s80, 70
  s_cbranch_scc0 L_n288
  s_waitcnt vmcnt(5)
L_n288:
  s_waitcnt vmcnt(7)
L_b288:
  buffer_load_dwordx4 v10, s[28:31], s65 offen offset:0 nt lds
  s_waitcnt vmcnt(9)
  s_cbranch_vccnz L_b289
  s_waitcnt vmcnt(8)
  s_bitcmp0_b32 s77, 31
  s_cbranch_scc1 L_b289
  s_cmp_gt_i32 s80, 70
  s_cbranch_scc0 L_n289
  s_waitcnt vmcnt(5)
L_n289:
  s_waitcnt vmcnt(6)
L_b289:
  buffer_load_dwordx4 v11, s[28:31], s65 offen offset:1024 nt lds
  s_cmp_eq_u32 s15, 2
  s_cselect_b32 s18, s16, 0x400000
  v_or_b32 v8, 70, v9
  buffer_store_dword v8, v6, s[44:47], s18 offen
  ds_read_b128 a[164:167], v12 offset:16384
  ds_read_b128 a[168:171], v13 offset:16384
  ds_read_b128 a[172:175], v14 offset:16384
  ds_read_b128 a[176:179], v15 offset:16384
  s_waitcnt vmcnt(10)
  s_cbranch_vccnz L_b290
  s_waitcnt vmcnt(8)
  s_bitcmp0_b32 s77, 31
  s_cbranch_scc1 L_b290
  s_cmp_gt_i32 s80, 70
  s_cbranch_scc0 L_n290
  s_waitcnt vmcnt(5)
L_n290:
  s_waitcnt vmcnt(7)
L_b290:
  buffer_load_dwordx4 v10, s[28:31], s65 offen offset:2048 nt lds
  buffer_load_dword v50, v7, s[44:47], 0 offen sc1
  s_bitcmp1_b32 s38, 30
  s_cbranch_scc1 L_gp3
  s_add_i32 s100, s37, 128
  s_max_i32 s100, s100, 0
  s_min_i32 s100, s100, 255
  s_mov_b32 s62, s100
  v_or_b32 v180, s100, v9
  s_add_u32 s18, s38, 101376
  buffer_store_dword v180, v6, s[44:47], s18 offen sc1
L_gp3:
  s_waitcnt lgkmcnt(0)
  v_mfma_f32_16x16x32_bf16 v[52:55], a[164:167], a[16:19], 0
  v_mfma_f32_16x16x32_bf16 v[52:55], a[168:171], a[20:23], v[52:55]
  v_mfma_f32_16x16x32_bf16 v[52:55], a[172:175], a[24:27], v[52:55]
  v_mfma_f32_16x16x32_bf16 v[52:55], a[176:179], a[28:31], v[52:55]
  s_waitcnt vmcnt(10)
  s_cbranch_vccnz L_b291
  s_waitcnt vmcnt(9)
  s_bitcmp0_b32 s77, 31
  s_cbranch_scc1 L_b291
  s_cmp_gt_i32 s80, 70
  s_cbranch_scc0 L_n291
  s_waitcnt vmcnt(6)
L_n291:
  s_waitcnt vmcnt(7)
L_b291:
  buffer_load_dwordx4 v11, s[28:31], s65 offen offset:3072 nt lds
  s_mov_b32 s18, 101376
  buffer_load_dword v187, v182, s[44:47], s18 offen sc1
  s_nop 7
  v_cvt_pk_bf16_f32 v52, 0, v52
  v_cvt_pk_bf16_f32 v53, 0, v53
  v_cvt_pk_bf16_f32 v54, 0, v54
  v_cvt_pk_bf16_f32 v55, 0, v55
  v_mul_f32 v52, s72, v52
  v_mul_f32 v53, s72, v53
  v_mul_f32 v54, s72, v54
  v_mul_f32 v55, s72, v55
  v_max3_f32 v24, v24, v52, v53
  v_cvt_pk_bf16_f32 v74, v52, v53
  v_max3_f32 v24, v24, v54, v55
  v_cvt_pk_bf16_f32 v75, v54, v55
  s_xor_b32 s65, s64, 0x424000
  s_add_u32 m0, s66, 4096
  s_sub_i32 s77, s36, 72
  s_cmp_gt_i32 s14, 71
  s_cselect_b64 vcc, -1, 0
  s_waitcnt vmcnt(11)
  s_cbranch_vccnz L_b292
  s_waitcnt vmcnt(9)
  s_bitcmp0_b32 s77, 31
  s_cbranch_scc1 L_b292
  s_cmp_gt_i32 s80, 71
  s_cbranch_scc0 L_n292
  s_waitcnt vmcnt(6)
L_n292:
  s_waitcnt vmcnt(8)
L_b292:
  buffer_load_dwordx4 v10, s[28:31], s65 offen offset:0 nt lds
  s_waitcnt vmcnt(10)
  s_cbranch_vccnz L_b293
  s_waitcnt vmcnt(9)
  s_bitcmp0_b32 s77, 31
  s_cbranch_scc1 L_b293
  s_cmp_gt_i32 s80, 71
  s_cbranch_scc0 L_n293
  s_waitcnt vmcnt(6)
L_n293:
  s_waitcnt vmcnt(7)
L_b293:
  buffer_load_dwordx4 v11, s[28:31], s65 offen offset:1024 nt lds
  s_cmp_eq_u32 s15, 3
  s_cselect_b32 s18, s16, 0x400000
  v_or_b32 v8, 71, v9
  buffer_store_dword v8, v6, s[44:47], s18 offen
  s_waitcnt vmcnt(11)
  s_cbranch_vccnz L_b294
  s_waitcnt vmcnt(9)
  s_bitcmp0_b32 s77, 31
  s_cbranch_scc1 L_b294
  s_cmp_gt_i32 s80, 71
  s_cbranch_scc0 L_n294
  s_waitcnt vmcnt(6)
L_n294:
  s_waitcnt vmcnt(8)
L_b294:
  buffer_load_dwordx4 v10, s[28:31], s65 offen offset:2048 nt lds
  s_waitcnt vmcnt(10)
  s_cbranch_vccnz L_b295
  s_waitcnt vmcnt(9)
  s_bitcmp0_b32 s77, 31
  s_cbranch_scc1 L_b295
  s_cmp_gt_i32 s80, 71
  s_cbranch_scc0 L_n295
  s_waitcnt vmcnt(5)
L_n295:
  s_waitcnt vmcnt(7)
L_b295:
  buffer_load_dwordx4 v11, s[28:31], s65 offen offset:3072 nt lds
  s_mov_b32 s18, 101376
  buffer_load_dword v188, v182, s[44:47], s18 offen sc1
  ds_read_b128 a[180:183], v12 offset:20480
  ds_read_b128 a[184:187], v13 offset:20480
  ds_read_b128 a[188:191], v14 offset:20480
  ds_read_b128 a[192:195], v15 offset:20480
  s_xor_b32 s65, s64, 0x40000
  s_add_u32 m0, s66, 8192
  s_sub_i32 s77, s36, 73
  s_cmp_gt_i32 s14, 72
  s_cselect_b64 vcc, -1, 0
  s_waitcnt vmcnt(11)
  s_cbranch_vccnz L_b296
  s_waitcnt vmcnt(9)
  s_bitcmp0_b32 s77, 31
  s_cbranch_scc1 L_b296
  s_cmp_gt_i32 s80, 72
  s_cbranch_scc0 L_n296
  s_waitcnt vmcnt(5)
L_n296:
  s_waitcnt vmcnt(7)
L_b296:
  buffer_load_dwordx4 v10, s[28:31], s65 offen offset:0 nt lds
  s_waitcnt lgkmcnt(0)
  v_mfma_f32_16x16x32_bf16 v[52:55], a[180:183], a[16:19], 0
  v_mfma_f32_16x16x32_bf16 v[52:55], a[184:187], a[20:23], v[52:55]
  v_mfma_f32_16x16x32_bf16 v[52:55], a[188:191], a[24:27], v[52:55]
  v_mfma_f32_16x16x32_bf16 v[52:55], a[192:195], a[28:31], v[52:55]
  s_waitcnt vmcnt(10)
  s_cbranch_vccnz L_b297
  s_waitcnt vmcnt(8)
  s_bitcmp0_b32 s77, 31
  s_cbranch_scc1 L_b297
  s_cmp_gt_i32 s80, 72
  s_cbranch_scc0 L_n297
  s_waitcnt vmcnt(5)
L_n297:
  s_waitcnt vmcnt(6)
L_b297:
  buffer_load_dwordx4 v11, s[28:31], s65 offen offset:1024 nt lds
  s_cmp_eq_u32 s15, 0
  s_cselect_b32 s18, s16, 0x400000
  v_or_b32 v8, 72, v9
  buffer_store_dword v8, v6, s[44:47], s18 offen
  s_nop 7
  v_cvt_pk_bf16_f32 v52, 0, v52
  v_cvt_pk_bf16_f32 v53, 0, v53
  v_cvt_pk_bf16_f32 v54, 0, v54
  v_cvt_pk_bf16_f32 v55, 0, v55
  v_mul_f32 v52, s72, v52
  v_mul_f32 v53, s72, v53
  v_mul_f32 v54, s72, v54
  v_mul_f32 v55, s72, v55
  v_max3_f32 v24, v24, v52, v53
  v_cvt_pk_bf16_f32 v76, v52, v53
  v_max3_f32 v24, v24, v54, v55
  v_cvt_pk_bf16_f32 v77, v54, v55
  s_waitcnt vmcnt(10)
  s_cbranch_vccnz L_b298
  s_waitcnt vmcnt(8)
  s_bitcmp0_b32 s77, 31
  s_cbranch_scc1 L_b298
  s_cmp_gt_i32 s80, 72
  s_cbranch_scc0 L_n298
  s_waitcnt vmcnt(5)
L_n298:
  s_waitcnt vmcnt(7)
L_b298:
  buffer_load_dwordx4 v10, s[28:31], s65 offen offset:2048 nt lds
  v_xor_b32 v50, s17, v50
  v_lshrrev_b32 v51, 8, v50
  v_cmp_eq_u32 s[82:83], 0, v51
  v_mov_b32 v51, 68
  s_nop 0
  v_cndmask_b32 v50, v51, v50, s[82:83]
  s_nop 1
  v_add_u32_dpp v50, v50, v50 row_ror:1 row_mask:0xf bank_mask:0xf
  s_nop 1
  v_add_u32_dpp v50, v50, v50 row_ror:2 row_mask:0xf bank_mask:0xf
  s_nop 1
  v_add_u32_dpp v50, v50, v50 row_ror:4 row_mask:0xf bank_mask:0xf
  s_nop 1
  v_add_u32_dpp v50, v50, v50 row_ror:8 row_mask:0xf bank_mask:0xf
  s_nop 0
  v_readlane_b32 s100, v50, 0
  v_readlane_b32 s101, v50, 16
  s_add_u32 s100, s100, s101
  s_sub_i32 s100, s100, 2179
  s_ashr_i32 s37, s100, 1
  s_add_i32 s62, s37, 128
  s_add_i32 s101, s100, 32
  s_mul_i32 s101, s101, -20
  s_ashr_i32 s101, s101, 8
  s_min_i32 s101, s101, 4
  s_add_i32 s80, s101, 73
  s_max_i32 s80, s80, s3
  s_mul_i32 s100, s100, 24
  s_ashr_i32 s100, s100, 8
  s_min_i32 s100, s100, 8
  s_add_i32 s14, s100, 73
  ds_read_b128 a[196:199], v12 offset:24576
  ds_read_b128 a[200:203], v13 offset:24576
  ds_read_b128 a[204:207], v14 offset:24576
  ds_read_b128 a[208:211], v15 offset:24576
  s_waitcnt vmcnt(9)
  s_cbranch_vccnz L_b299
  s_waitcnt vmcnt(8)
  s_bitcmp0_b32 s77, 31
  s_cbranch_scc1 L_b299
  s_cmp_gt_i32 s80, 72
  s_cbranch_scc0 L_n299
  s_waitcnt vmcnt(5)
L_n299:
  s_waitcnt vmcnt(6)
L_b299:
  buffer_load_dwordx4 v11, s[28:31], s65 offen offset:3072 nt lds
  s_mov_b32 s18, 101376
  buffer_load_dword v189, v182, s[44:47], s18 offen sc1
  s_waitcnt lgkmcnt(0)
  v_mfma_f32_16x16x32_bf16 v[52:55], a[196:199], a[16:19], 0
  v_mfma_f32_16x16x32_bf16 v[52:55], a[200:203], a[20:23], v[52:55]
  v_mfma_f32_16x16x32_bf16 v[52:55], a[204:207], a[24:27], v[52:55]
  v_mfma_f32_16x16x32_bf16 v[52:55], a[208:211], a[28:31], v[52:55]
  s_xor_b32 s65, s64, 0x44000
  s_add_u32 m0, s66, 12288
  s_sub_i32 s77, s36, 74
  s_cmp_gt_i32 s14, 73
  s_cselect_b64 vcc, -1, 0
  s_waitcnt vmcnt(10)
  s_cbranch_vccnz L_b300
  s_waitcnt vmcnt(8)
  s_bitcmp0_b32 s77, 31
  s_cbranch_scc1 L_b300
  s_cmp_gt_i32 s80, 73
  s_cbranch_scc0 L_n300
  s_waitcnt vmcnt(5)
L_n300:
  s_waitcnt vmcnt(7)
L_b300:
  buffer_load_dwordx4 v10, s[28:31], s65 offen offset:0 nt lds
  s_nop 7
  v_cvt_pk_bf16_f32 v52, 0, v52
  v_cvt_pk_bf16_f32 v53, 0, v53
  v_cvt_pk_bf16_f32 v54, 0, v54
  v_cvt_pk_bf16_f32 v55, 0, v55
  v_mul_f32 v52, s72, v52
  v_mul_f32 v53, s72, v53
  v_mul_f32 v54, s72, v54
  v_mul_f32 v55, s72, v55
  v_max3_f32 v24, v24, v52, v53
  v_cvt_pk_bf16_f32 v78, v52, v53
  v_max3_f32 v24, v24, v54, v55
  v_cvt_pk_bf16_f32 v79, v54, v55
  s_waitcnt vmcnt(9)
  s_cbranch_vccnz L_b301
  s_waitcnt vmcnt(8)
  s_bitcmp0_b32 s77, 31
  s_cbranch_scc1 L_b301
  s_cmp_gt_i32 s80, 73
  s_cbranch_scc0 L_n301
  s_waitcnt vmcnt(5)
L_n301:
  s_waitcnt vmcnt(6)
L_b301:
  buffer_load_dwordx4 v11, s[28:31], s65 offen offset:1024 nt lds
  s_cmp_eq_u32 s15, 1
  s_cselect_b32 s18, s16, 0x400000
  v_or_b32 v8, 73, v9
  buffer_store_dword v8, v6, s[44:47], s18 offen
  ds_read_b128 a[132:135], v12 offset:0
  ds_read_b128 a[136:139], v13 offset:0
  ds_read_b128 a[140:143], v14 offset:0
  ds_read_b128 a[144:147], v15 offset:0
  s_waitcnt vmcnt(10)
  s_cbranch_vccnz L_b302
  s_waitcnt vmcnt(8)
  s_bitcmp0_b32 s77, 31
  s_cbranch_scc1 L_b302
  s_cmp_gt_i32 s80, 73
  s_cbranch_scc0 L_n302
  s_waitcnt vmcnt(5)
L_n302:
  s_waitcnt vmcnt(7)
L_b302:
  buffer_load_dwordx4 v10, s[28:31], s65 offen offset:2048 nt lds
  s_waitcnt lgkmcnt(0)
  v_mfma_f32_16x16x32_bf16 v[52:55], a[132:135], a[16:19], 0
  v_mfma_f32_16x16x32_bf16 v[52:55], a[136:139], a[20:23], v[52:55]
  v_mfma_f32_16x16x32_bf16 v[52:55], a[140:143], a[24:27], v[52:55]
  v_mfma_f32_16x16x32_bf16 v[52:55], a[144:147], a[28:31], v[52:55]
  s_waitcnt vmcnt(9)
  s_cbranch_vccnz L_b303
  s_waitcnt vmcnt(8)
  s_bitcmp0_b32 s77, 31
  s_cbranch_scc1 L_b303
  s_cmp_gt_i32 s80, 73
  s_cbranch_scc0 L_n303
  s_waitcnt vmcnt(5)
L_n303:
  s_waitcnt vmcnt(6)
L_b303:
  buffer_load_dwordx4 v11, s[28:31], s65 offen offset:3072 nt lds
  s_mov_b32 s18, 101376
  buffer_load_dword v190, v182, s[44:47], s18 offen sc1
  s_nop 7
  v_cvt_pk_bf16_f32 v52, 0, v52
  v_cvt_pk_bf16_f32 v53, 0, v53
  v_cvt_pk_bf16_f32 v54, 0, v54
  v_cvt_pk_bf16_f32 v55, 0, v55
  v_mul_f32 v52, s72, v52
  v_mul_f32 v53, s72, v53
  v_mul_f32 v54, s72, v54
  v_mul_f32 v55, s72, v55
  v_max3_f32 v24, v24, v52, v53
  v_cvt_pk_bf16_f32 v80, v52, v53
  v_max3_f32 v24, v24, v54, v55
  v_cvt_pk_bf16_f32 v81, v54, v55
  s_xor_b32 s65, s64, 0x440000
  s_add_u32 m0, s66, 16384
  s_sub_i32 s77, s36, 75
  s_cmp_gt_i32 s14, 74
  s_cselect_b64 vcc, -1, 0
  s_waitcnt vmcnt(10)
  s_cbranch_vccnz L_b304
  s_waitcnt vmcnt(8)
  s_bitcmp0_b32 s77, 31
  s_cbranch_scc1 L_b304
  s_cmp_gt_i32 s80, 74
  s_cbranch_scc0 L_n304
  s_waitcnt vmcnt(5)
L_n304:
  s_waitcnt vmcnt(7)
L_b304:
  buffer_load_dwordx4 v10, s[28:31], s65 offen offset:0 nt lds
  s_waitcnt vmcnt(9)
  s_cbranch_vccnz L_b305
  s_waitcnt vmcnt(8)
  s_bitcmp0_b32 s77, 31
  s_cbranch_scc1 L_b305
  s_cmp_gt_i32 s80, 74
  s_cbranch_scc0 L_n305
  s_waitcnt vmcnt(5)
L_n305:
  s_waitcnt vmcnt(6)
L_b305:
  buffer_load_dwordx4 v11, s[28:31], s65 offen offset:1024 nt lds
  s_cmp_eq_u32 s15, 2
  s_cselect_b32 s18, s16, 0x400000
  v_or_b32 v8, 74, v9
  buffer_store_dword v8, v6, s[44:47], s18 offen
  ds_read_b128 a[148:151], v12 offset:4096
  ds_read_b128 a[152:155], v13 offset:4096
  ds_read_b128 a[156:159], v14 offset:4096
  ds_read_b128 a[160:163], v15 offset:4096
  s_waitcnt vmcnt(10)
  s_cbranch_vccnz L_b306
  s_waitcnt vmcnt(8)
  s_bitcmp0_b32 s77, 31
  s_cbranch_scc1 L_b306
  s_cmp_gt_i32 s80, 74
  s_cbranch_scc0 L_n306
  s_waitcnt vmcnt(5)
L_n306:
  s_waitcnt vmcnt(7)
L_b306:
  buffer_load_dwordx4 v10, s[28:31], s65 offen offset:2048 nt lds
  buffer_load_dword v50, v7, s[44:47], 0 offen sc1
  s_waitcnt lgkmcnt(0)
  v_mfma_f32_16x16x32_bf16 v[52:55], a[148:151], a[16:19], 0
  v_mfma_f32_16x16x32_bf16 v[52:55], a[152:155], a[20:23], v[52:55]
  v_mfma_f32_16x16x32_bf16 v[52:55], a[156:159], a[24:27], v[52:55]
  v_mfma_f32_16x16x32_bf16 v[52:55], a[160:163], a[28:31], v[52:55]
  s_waitcnt vmcnt(10)
  s_cbranch_vccnz L_b307
  s_waitcnt vmcnt(9)
  s_bitcmp0_b32 s77, 31
  s_cbranch_scc1 L_b307
  s_cmp_gt_i32 s80, 74
  s_cbranch_scc0 L_n307
  s_waitcnt vmcnt(6)
L_n307:
  s_waitcnt vmcnt(7)
L_b307:
  buffer_load_dwordx4 v11, s[28:31], s65 offen offset:3072 nt lds
  s_mov_b32 s18, 101376
  buffer_load_dword v191, v182, s[44:47], s18 offen sc1
  s_nop 7
  v_cvt_pk_bf16_f32 v52, 0, v52
  v_cvt_pk_bf16_f32 v53, 0, v53
  v_cvt_pk_bf16_f32 v54, 0, v54
  v_cvt_pk_bf16_f32 v55, 0, v55
  v_mul_f32 v52, s72, v52
  v_mul_f32 v53, s72, v53
  v_mul_f32 v54, s72, v54
  v_mul_f32 v55, s72, v55
  v_max3_f32 v24, v24, v52, v53
  v_cvt_pk_bf16_f32 v82, v52, v53
  v_max3_f32 v24, v24, v54, v55
  v_cvt_pk_bf16_f32 v83, v54, v55
  s_xor_b32 s65, s64, 0x444000
  s_add_u32 m0, s66, 20480
  s_sub_i32 s77, s36, 76
  s_cmp_gt_i32 s14, 75
  s_cselect_b64 vcc, -1, 0
  s_waitcnt vmcnt(11)
  s_cbranch_vccnz L_b308
  s_waitcnt vmcnt(9)
  s_bitcmp0_b32 s77, 31
  s_cbranch_scc1 L_b308
  s_cmp_gt_i32 s80, 75
  s_cbranch_scc0 L_n308
  s_waitcnt vmcnt(6)
L_n308:
  s_waitcnt vmcnt(8)
L_b308:
  buffer_load_dwordx4 v10, s[28:31], s65 offen offset:0 nt lds
  s_waitcnt vmcnt(10)
  s_cbranch_vccnz L_b309
  s_waitcnt vmcnt(9)
  s_bitcmp0_b32 s77, 31
  s_cbranch_scc1 L_b309
  s_cmp_gt_i32 s80, 75
  s_cbranch_scc0 L_n309
  s_waitcnt vmcnt(6)
L_n309:
  s_waitcnt vmcnt(7)
L_b309:
  buffer_load_dwordx4 v11, s[28:31], s65 offen offset:1024 nt lds
  s_cmp_eq_u32 s15, 3
  s_cselect_b32 s18, s16, 0x400000
  v_or_b32 v8, 75, v9
  buffer_store_dword v8, v6, s[44:47], s18 offen
  s_waitcnt vmcnt(11)
  s_cbranch_vccnz L_b310
  s_waitcnt vmcnt(9)
  s_bitcmp0_b32 s77, 31
  s_cbranch_scc1 L_b310
  s_cmp_gt_i32 s80, 75
  s_cbranch_scc0 L_n310
  s_waitcnt vmcnt(6)
L_n310:
  s_waitcnt vmcnt(8)
L_b310:
  buffer_load_dwordx4 v10, s[28:31], s65 offen offset:2048 nt lds
  s_waitcnt vmcnt(10)
  s_cbranch_vccnz L_b311
  s_waitcnt vmcnt(9)
  s_bitcmp0_b32 s77, 31
  s_cbranch_scc1 L_b311
  s_cmp_gt_i32 s80, 75
  s_cbranch_scc0 L_n311
  s_waitcnt vmcnt(5)
L_n311:
  s_waitcnt vmcnt(7)
L_b311:
  buffer_load_dwordx4 v11, s[28:31], s65 offen offset:3072 nt lds
  ds_read_b128 a[164:167], v12 offset:8192
  ds_read_b128 a[168:171], v13 offset:8192
  ds_read_b128 a[172:175], v14 offset:8192
  ds_read_b128 a[176:179], v15 offset:8192
  s_xor_b32 s65, s64, 0x60000
  s_add_u32 m0, s66, 24576
  s_sub_i32 s77, s36, 77
  s_cmp_gt_i32 s14, 76
  s_cselect_b64 vcc, -1, 0
  s_waitcnt vmcnt(10)
  s_cbranch_vccnz L_b312
  s_waitcnt vmcnt(8)
  s_bitcmp0_b32 s77, 31
  s_cbranch_scc1 L_b312
  s_cmp_gt_i32 s80, 76
  s_cbranch_scc0 L_n312
  s_waitcnt vmcnt(4)
L_n312:
  s_waitcnt vmcnt(6)
L_b312:
  buffer_load_dwordx4 v10, s[28:31], s65 offen offset:0 nt lds
  s_waitcnt lgkmcnt(0)
  v_mfma_f32_16x16x32_bf16 v[52:55], a[164:167], a[16:19], 0
  v_mfma_f32_16x16x32_bf16 v[52:55], a[168:171], a[20:23], v[52:55]
  v_mfma_f32_16x16x32_bf16 v[52:55], a[172:175], a[24:27], v[52:55]
  v_mfma_f32_16x16x32_bf16 v[52:55], a[176:179], a[28:31], v[52:55]
  s_waitcnt vmcnt(9)
  s_cbranch_vccnz L_b313
  s_waitcnt vmcnt(7)
  s_bitcmp0_b32 s77, 31
  s_cbranch_scc1 L_b313
  s_cmp_gt_i32 s80, 76
  s_cbranch_scc0 L_n313
  s_waitcnt vmcnt(4)
L_n313:
  s_waitcnt vmcnt(5)
L_b313:
  buffer_load_dwordx4 v11, s[28:31], s65 offen offset:1024 nt lds
  s_cmp_eq_u32 s15, 0
  s_cselect_b32 s18, s16, 0x400000
  v_or_b32 v8, 76, v9
  buffer_store_dword v8, v6, s[44:47], s18 offen
  s_nop 7
  v_cvt_pk_bf16_f32 v52, 0, v52
  v_cvt_pk_bf16_f32 v53, 0, v53
  v_cvt_pk_bf16_f32 v54, 0, v54
  v_cvt_pk_bf16_f32 v55, 0, v55
  v_mul_f32 v52, s72, v52
  v_mul_f32 v53, s72, v53
  v_mul_f32 v54, s72, v54
  v_mul_f32 v55, s72, v55
  v_max3_f32 v24, v24, v52, v53
  v_cvt_pk_bf16_f32 v84, v52, v53
  v_max3_f32 v24, v24, v54, v55
  v_cvt_pk_bf16_f32 v85, v54, v55
  s_waitcnt vmcnt(9)
  s_cbranch_vccnz L_b314
  s_waitcnt vmcnt(7)
  s_bitcmp0_b32 s77, 31
  s_cbranch_scc1 L_b314
  s_cmp_gt_i32 s80, 76
  s_cbranch_scc0 L_n314
  s_waitcnt vmcnt(4)
L_n314:
  s_waitcnt vmcnt(6)
L_b314:
  buffer_load_dwordx4 v10, s[28:31], s65 offen offset:2048 nt lds
  v_xor_b32 v50, s17, v50
  v_lshrrev_b32 v51, 8, v50
  v_cmp_eq_u32 s[82:83], 0, v51
  v_mov_b32 v51, 72
  s_nop 0
  v_cndmask_b32 v50, v51, v50, s[82:83]
  s_nop 1
  v_add_u32_dpp v50, v50, v50 row_ror:1 row_mask:0xf bank_mask:0xf
  s_nop 1
  v_add_u32_dpp v50, v50, v50 row_ror:2 row_mask:0xf bank_mask:0xf
  s_nop 1
  v_add_u32_dpp v50, v50, v50 row_ror:4 row_mask:0xf bank_mask:0xf
  s_nop 1
  v_add_u32_dpp v50, v50, v50 row_ror:8 row_mask:0xf bank_mask:0xf
  s_nop 0
  v_readlane_b32 s100, v50, 0
  v_readlane_b32 s101, v50, 16
  s_add_u32 s100, s100, s101
  s_sub_i32 s100, s100, 2307
  s_ashr_i32 s37, s100, 1
  s_add_i32 s101, s100, 32
  s_mul_i32 s101, s101, -20
  s_ashr_i32 s101, s101, 8
  s_min_i32 s101, s101, 4
  s_add_i32 s80, s101, 77
  s_max_i32 s80, s80, s3
  s_mul_i32 s100, s100, 24
  s_ashr_i32 s100, s100, 8
  s_min_i32 s100, s100, 8
  s_add_i32 s14, s100, 77
  ds_read_b128 a[180:183], v12 offset:12288
  ds_read_b128 a[184:187], v13 offset:12288
  ds_read_b128 a[188:191], v14 offset:12288
  ds_read_b128 a[192:195], v15 offset:12288
  s_waitcnt vmcnt(8)
  s_cbranch_vccnz L_b315
  s_waitcnt vmcnt(7)
  s_bitcmp0_b32 s77, 31
  s_cbranch_scc1 L_b315
  s_cmp_gt_i32 s80, 76
  s_cbranch_scc0 L_n315
  s_waitcnt vmcnt(4)
L_n315:
  s_waitcnt vmcnt(5)
L_b315:
  buffer_load_dwordx4 v11, s[28:31], s65 offen offset:3072 nt lds
  s_bitcmp1_b32 s38, 30
  s_cbranch_scc1 L_ge3
  v_xor_b32 v184, s17, v184
  v_xor_b32 v185, s17, v185
  v_xor_b32 v186, s17, v186
  v_xor_b32 v187, s17, v187
  v_xor_b32 v188, s17, v188
  v_xor_b32 v189, s17, v189
  v_xor_b32 v190, s17, v190
  v_xor_b32 v191, s17, v191
  v_min_u32 v180, 0x100, v191
  v_lshrrev_b32 v181, 1, v180
  v_and_b32 v181, 0x80, v181
  v_and_b32 v180, 0xff, v180
  v_add_u32 v180, v180, v181
  v_lshrrev_b32 v184, 8, v184
  v_min_u32 v184, 1, v184
  v_lshlrev_b32 v184, 4, v184
  v_sub_u32 v180, v180, v184
  v_lshrrev_b32 v185, 8, v185
  v_min_u32 v185, 1, v185
  v_lshlrev_b32 v185, 4, v185
  v_sub_u32 v180, v180, v185
  v_lshrrev_b32 v186, 8, v186
  v_min_u32 v186, 1, v186
  v_lshlrev_b32 v186, 4, v186
  v_sub_u32 v180, v180, v186
  v_lshrrev_b32 v187, 8, v187
  v_min_u32 v187, 1, v187
  v_lshlrev_b32 v187, 4, v187
  v_sub_u32 v180, v180, v187
  v_lshrrev_b32 v188, 8, v188
  v_min_u32 v188, 1, v188
  v_lshlrev_b32 v188, 4, v188
  v_sub_u32 v180, v180, v188
  v_lshrrev_b32 v189, 8, v189
  v_min_u32 v189, 1, v189
  v_lshlrev_b32 v189, 4, v189
  v_sub_u32 v180, v180, v189
  v_lshrrev_b32 v190, 8, v190
  v_min_u32 v190, 1, v190
  v_lshlrev_b32 v190, 4, v190
  v_sub_u32 v180, v180, v190
  v_lshrrev_b32 v191, 8, v191
  v_min_u32 v191, 1, v191
  v_lshlrev_b32 v191, 4, v191
  v_sub_u32 v180, v180, v191
  s_and_b32 s101, s2, 7
  s_sub_i32 s100, s62, 64
  s_mov_b32 m0, s101
  v_writelane_b32 v180, s100, m0
  s_add_u32 m0, s66, 24576
  s_nop 1
  v_add_u32_dpp v180, v180, v180 quad_perm:[1,0,3,2] row_mask:0xf bank_mask:0xf
  s_nop 1
  v_add_u32_dpp v180, v180, v180 quad_perm:[2,3,0,1] row_mask:0xf bank_mask:0xf
  s_nop 1
  v_add_u32_dpp v180, v180, v180 row_half_mirror row_mask:0xf bank_mask:0xf
  s_nop 0
  v_readlane_b32 s101, v180, 0
  s_lshl_b32 s100, s100, 3
  s_sub_i32 s100, s101, s100
  s_add_i32 s100, s100, -32
  s_mul_i32 s100, s100, 96
  s_add_i32 s100, s100, 512
  s_ashr_i32 s100, s100, 10
  s_max_i32 s100, s100, -16
  s_min_i32 s100, s100, 16
  s_add_i32 s100, s100, 128
  v_or_b32 v180, s100, v9
  buffer_store_dword v180, v6, s[44:47], s39 offen offset:12
L_ge3:
  s_waitcnt lgkmcnt(0)
  v_mfma_f32_16x16x32_bf16 v[52:55], a[180:183], a[16:19], 0
  v_mfma_f32_16x16x32_bf16 v[52:55], a[184:187], a[20:23], v[52:55]
  v_mfma_f32_16x16x32_bf16 v[52:55], a[188:191], a[24:27], v[52:55]
  v_mfma_f32_16x16x32_bf16 v[52:55], a[192:195], a[28:31], v[52:55]
  s_xor_b32 s65, s64, 0x64000
  s_add_u32 m0, s66, 0
  s_sub_i32 s77, s36, 78
  s_cmp_gt_i32 s14, 77
  s_cselect_b64 vcc, -1, 0
  s_waitcnt vmcnt(8)
  s_cbranch_vccnz L_b316
  s_waitcnt vmcnt(6)
  s_bitcmp0_b32 s77, 31
  s_cbranch_scc1 L_b316
  s_cmp_gt_i32 s80, 77
  s_cbranch_scc0 L_n316
  s_waitcnt vmcnt(4)
L_n316:
  s_waitcnt vmcnt(5)
L_b316:
  buffer_load_dwordx4 v10, s[28:31], s65 offen offset:0 nt lds
  s_nop 7
  v_cvt_pk_bf16_f32 v52, 0, v52
  v_cvt_pk_bf16_f32 v53, 0, v53
  v_cvt_pk_bf16_f32 v54, 0, v54
  v_cvt_pk_bf16_f32 v55, 0, v55
  v_mul_f32 v52, s72, v52
  v_mul_f32 v53, s72, v53
  v_mul_f32 v54, s72, v54
  v_mul_f32 v55, s72, v55
  v_max3_f32 v24, v24, v52, v53
  v_cvt_pk_bf16_f32 v86, v52, v53
  v_max3_f32 v24, v24, v54, v55
  v_cvt_pk_bf16_f32 v87, v54, v55
  s_waitcnt vmcnt(7)
  s_cbranch_vccnz L_b317
  s_waitcnt vmcnt(6)
  s_bitcmp0_b32 s77, 31
  s_cbranch_scc1 L_b317
  s_cmp_gt_i32 s80, 77
  s_cbranch_scc0 L_n317
  s_waitcnt vmcnt(4)
L_n317:
  s_waitcnt vmcnt(5)
L_b317:
  buffer_load_dwordx4 v11, s[28:31], s65 offen offset:1024 nt lds
  s_cmp_eq_u32 s15, 1
  s_cselect_b32 s18, s16, 0x400000
  v_or_b32 v8, 77, v9
  buffer_store_dword v8, v6, s[44:47], s18 offen
  ds_read_b128 a[196:199], v12 offset:16384
  ds_read_b128 a[200:203], v13 offset:16384
  ds_read_b128 a[204:207], v14 offset:16384
  ds_read_b128 a[208:211], v15 offset:16384
  s_waitcnt vmcnt(8)
  s_cbranch_vccnz L_b318
  s_waitcnt vmcnt(7)
  s_bitcmp0_b32 s77, 31
  s_cbranch_scc1 L_b318
  s_cmp_gt_i32 s80, 77
  s_cbranch_scc0 L_n318
  s_waitcnt vmcnt(4)
L_n318:
  s_waitcnt vmcnt(6)
L_b318:
  buffer_load_dwordx4 v10, s[28:31], s65 offen offset:2048 nt lds
  s_waitcnt lgkmcnt(0)
  v_mfma_f32_16x16x32_bf16 v[52:55], a[196:199], a[16:19], 0
  v_mfma_f32_16x16x32_bf16 v[52:55], a[200:203], a[20:23], v[52:55]
  v_mfma_f32_16x16x32_bf16 v[52:55], a[204:207], a[24:27], v[52:55]
  v_mfma_f32_16x16x32_bf16 v[52:55], a[208:211], a[28:31], v[52:55]
  s_waitcnt vmcnt(8)
  s_cbranch_vccnz L_b319
  s_waitcnt vmcnt(7)
  s_bitcmp0_b32 s77, 31
  s_cbranch_scc1 L_b319
  s_cmp_gt_i32 s80, 77
  s_cbranch_scc0 L_n319
  s_waitcnt vmcnt(4)
L_n319:
  s_waitcnt vmcnt(5)
L_b319:
  buffer_load_dwordx4 v11, s[28:31], s65 offen offset:3072 nt lds
  s_nop 7
  v_cvt_pk_bf16_f32 v52, 0, v52
  v_cvt_pk_bf16_f32 v53, 0, v53
  v_cvt_pk_bf16_f32 v54, 0, v54
  v_cvt_pk_bf16_f32 v55, 0, v55
  v_mul_f32 v52, s72, v52
  v_mul_f32 v53, s72, v53
  v_mul_f32 v54, s72, v54
  v_mul_f32 v55, s72, v55
  v_max3_f32 v24, v24, v52, v53
  v_cvt_pk_bf16_f32 v88, v52, v53
  v_max3_f32 v24, v24, v54, v55
  v_cvt_pk_bf16_f32 v89, v54, v55
  s_xor_b32 s65, s64, 0x460000
  s_add_u32 m0, s66, 4096
  s_sub_i32 s77, s36, 79
  s_cmp_gt_i32 s14, 78
  s_cselect_b64 vcc, -1, 0
  s_waitcnt vmcnt(8)
  s_cbranch_vccnz L_b320
  s_waitcnt vmcnt(6)
  s_bitcmp0_b32 s77, 31
  s_cbranch_scc1 L_b320
  s_cmp_gt_i32 s80, 78
  s_cbranch_scc0 L_n320
  s_waitcnt vmcnt(4)
L_n320:
  s_waitcnt vmcnt(5)
L_b320:
  buffer_load_dwordx4 v10, s[28:31], s65 offen offset:0 nt lds
  ds_read_b128 a[132:135], v12 offset:20480
  ds_read_b128 a[136:139], v13 offset:20480
  ds_read_b128 a[140:143], v14 offset:20480
  ds_read_b128 a[144:147], v15 offset:20480
  s_waitcnt vmcnt(7)
  s_cbranch_vccnz L_b321
  s_waitcnt vmcnt(6)
  s_bitcmp0_b32 s77, 31
  s_cbranch_scc1 L_b321
  s_cmp_gt_i32 s80, 78
  s_cbranch_scc0 L_n321
  s_waitcnt vmcnt(4)
L_n321:
  s_waitcnt vmcnt(5)
L_b321:
  buffer_load_dwordx4 v11, s[28:31], s65 offen offset:1024 nt lds
  s_cmp_eq_u32 s15, 2
  s_cselect_b32 s18, s16, 0x400000
  v_or_b32 v8, 78, v9
  buffer_store_dword v8, v6, s[44:47], s18 offen
  s_waitcnt lgkmcnt(0)
  v_mfma_f32_16x16x32_bf16 v[52:55], a[132:135], a[16:19], 0
  v_mfma_f32_16x16x32_bf16 v[52:55], a[136:139], a[20:23], v[52:55]
  v_mfma_f32_16x16x32_bf16 v[52:55], a[140:143], a[24:27], v[52:55]
  v_mfma_f32_16x16x32_bf16 v[52:55], a[144:147], a[28:31], v[52:55]
  s_waitcnt vmcnt(8)
  s_cbranch_vccnz L_b322
  s_waitcnt vmcnt(7)
  s_bitcmp0_b32 s77, 31
  s_cbranch_scc1 L_b322
  s_cmp_gt_i32 s80, 78
  s_cbranch_scc0 L_n322
  s_waitcnt vmcnt(4)
L_n322:
  s_waitcnt vmcnt(6)
L_b322:
  buffer_load_dwordx4 v10, s[28:31], s65 offen offset:2048 nt lds
  buffer_load_dword v50, v7, s[44:47], 0 offen sc1
  s_nop 7
  v_cvt_pk_bf16_f32 v52, 0, v52
  v_cvt_pk_bf16_f32 v53, 0, v53
  v_cvt_pk_bf16_f32 v54, 0, v54
  v_cvt_pk_bf16_f32 v55, 0, v55
  v_mul_f32 v52, s72, v52
  v_mul_f32 v53, s72, v53
  v_mul_f32 v54, s72, v54
  v_mul_f32 v55, s72, v55
  v_max3_f32 v24, v24, v52, v53
  v_cvt_pk_bf16_f32 v90, v52, v53
  v_max3_f32 v24, v24, v54, v55
  v_cvt_pk_bf16_f32 v91, v54, v55
  s_waitcnt vmcnt(9)
  s_cbranch_vccnz L_b323
  s_waitcnt vmcnt(8)
  s_bitcmp0_b32 s77, 31
  s_cbranch_scc1 L_b323
  s_cmp_gt_i32 s80, 78
  s_cbranch_scc0 L_n323
  s_waitcnt vmcnt(5)
L_n323:
  s_waitcnt vmcnt(6)
L_b323:
  buffer_load_dwordx4 v11, s[28:31], s65 offen offset:3072 nt lds
  s_xor_b32 s65, s64, 0x464000
  s_add_u32 m0, s66, 8192
  s_sub_i32 s77, s36, 80
  s_cmp_gt_i32 s14, 79
  s_cselect_b64 vcc, -1, 0
  s_waitcnt vmcnt(9)
  s_cbranch_vccnz L_b324
  s_waitcnt vmcnt(7)
  s_bitcmp0_b32 s77, 31
  s_cbranch_scc1 L_b324
  s_cmp_gt_i32 s80, 79
  s_cbranch_scc0 L_n324
  s_waitcnt vmcnt(5)
L_n324:
  s_waitcnt vmcnt(6)
L_b324:
  buffer_load_dwordx4 v10, s[28:31], s65 offen offset:0 nt lds
  s_waitcnt vmcnt(8)
  s_cbranch_vccnz L_b325
  s_waitcnt vmcnt(7)
  s_bitcmp0_b32 s77, 31
  s_cbranch_scc1 L_b325
  s_cmp_gt_i32 s80, 79
  s_cbranch_scc0 L_n325
  s_waitcnt vmcnt(5)
L_n325:
  s_waitcnt vmcnt(6)
L_b325:
  buffer_load_dwordx4 v11, s[28:31], s65 offen offset:1024 nt lds
  s_cmp_eq_u32 s15, 3
  s_cselect_b32 s18, s16, 0x400000
  v_or_b32 v8, 79, v9
  buffer_store_dword v8, v6, s[44:47], s18 offen
  ds_read_b128 a[148:151], v12 offset:24576
  ds_read_b128 a[152:155], v13 offset:24576
  ds_read_b128 a[156:159], v14 offset:24576
  ds_read_b128 a[160:163], v15 offset:24576
  s_waitcnt vmcnt(9)
  s_cbranch_vccnz L_b326
  s_waitcnt vmcnt(8)
  s_bitcmp0_b32 s77, 31
  s_cbranch_scc1 L_b326
  s_cmp_gt_i32 s80, 79
  s_cbranch_scc0 L_n326
  s_waitcnt vmcnt(5)
L_n326:
  s_waitcnt vmcnt(7)
L_b326:
  buffer_load_dwordx4 v10, s[28:31], s65 offen offset:2048 nt lds
  s_waitcnt lgkmcnt(0)
  v_mfma_f32_16x16x32_bf16 v[52:55], a[148:151], a[16:19], 0
  v_mfma_f32_16x16x32_bf16 v[52:55], a[152:155], a[20:23], v[52:55]
  v_mfma_f32_16x16x32_bf16 v[52:55], a[156:159], a[24:27], v[52:55]
  v_mfma_f32_16x16x32_bf16 v[52:55], a[160:163], a[28:31], v[52:55]
  s_waitcnt vmcnt(9)
  s_cbranch_vccnz L_b327
  s_waitcnt vmcnt(8)
  s_bitcmp0_b32 s77, 31
  s_cbranch_scc1 L_b327
  s_cmp_gt_i32 s80, 79
  s_cbranch_scc0 L_n327
  s_waitcnt vmcnt(4)
L_n327:
  s_waitcnt vmcnt(6)
L_b327:
  buffer_load_dwordx4 v11, s[28:31], s65 offen offset:3072 nt lds
  s_nop 7
  v_cvt_pk_bf16_f32 v52, 0, v52
  v_cvt_pk_bf16_f32 v53, 0, v53
  v_cvt_pk_bf16_f32 v54, 0, v54
  v_cvt_pk_bf16_f32 v55, 0, v55
  v_mul_f32 v52, s72, v52
  v_mul_f32 v53, s72, v53
  v_mul_f32 v54, s72, v54
  v_mul_f32 v55, s72, v55
  v_max3_f32 v24, v24, v52, v53
  v_cvt_pk_bf16_f32 v92, v52, v53
  v_max3_f32 v24, v24, v54, v55
  v_cvt_pk_bf16_f32 v93, v54, v55
  s_xor_b32 s65, s64, 0x80000
  s_add_u32 m0, s66, 12288
  s_sub_i32 s77, s36, 81
  s_cmp_gt_i32 s14, 80
  s_cselect_b64 vcc, -1, 0
  s_waitcnt vmcnt(9)
  s_cbranch_vccnz L_b328
  s_waitcnt vmcnt(7)
  s_bitcmp0_b32 s77, 31
  s_cbranch_scc1 L_b328
  s_cmp_gt_i32 s80, 80
  s_cbranch_scc0 L_n328
  s_waitcnt vmcnt(4)
L_n328:
  s_waitcnt vmcnt(5)
L_b328:
  buffer_load_dwordx4 v10, s[28:31], s65 offen offset:0 nt lds
  s_waitcnt vmcnt(8)
  s_cbranch_vccnz L_b329
  s_waitcnt vmcnt(6)
  s_bitcmp0_b32 s77, 31
  s_cbranch_scc1 L_b329
  s_cmp_gt_i32 s80, 80
  s_cbranch_scc0 L_n329
  s_waitcnt vmcnt(4)
L_n329:
  s_waitcnt vmcnt(5)
L_b329:
  buffer_load_dwordx4 v11, s[28:31], s65 offen offset:1024 nt lds
  s_cmp_eq_u32 s15, 0
  s_cselect_b32 s18, s16, 0x400000
  v_or_b32 v8, 80, v9
  buffer_store_dword v8, v6, s[44:47], s18 offen
  ds_read_b128 a[164:167], v12 offset:0
  ds_read_b128 a[168:171], v13 offset:0
  ds_read_b128 a[172:175], v14 offset:0
  ds_read_b128 a[176:179], v15 offset:0
  s_waitcnt vmcnt(8)
  s_cbranch_vccnz L_b330
  s_waitcnt vmcnt(7)
  s_bitcmp0_b32 s77, 31
  s_cbranch_scc1 L_b330
  s_cmp_gt_i32 s80, 80
  s_cbranch_scc0 L_n330
  s_waitcnt vmcnt(4)
L_n330:
  s_waitcnt vmcnt(6)
L_b330:
  buffer_load_dwordx4 v10, s[28:31], s65 offen offset:2048 nt lds
  v_xor_b32 v50, s17, v50
  v_lshrrev_b32 v51, 8, v50
  v_readlane_b32 s100, v50, 35
  s_cmp_lt_u32 s100, 256
  s_cselect_b32 s100, s100, 128
  s_add_i32 s36, s100, -47
  s_sub_i32 s3, 122, s100
  s_ashr_i32 s3, s3, 2
  s_add_i32 s3, s3, 81
  v_cmp_eq_u32 s[82:83], 0, v51
  v_mov_b32 v51, 76
  s_nop 0
  v_cndmask_b32 v50, v51, v50, s[82:83]
  s_nop 1
  v_add_u32_dpp v50, v50, v50 row_ror:1 row_mask:0xf bank_mask:0xf
  s_nop 1
  v_add_u32_dpp v50, v50, v50 row_ror:2 row_mask:0xf bank_mask:0xf
  s_nop 1
  v_add_u32_dpp v50, v50, v50 row_ror:4 row_mask:0xf bank_mask:0xf
  s_nop 1
  v_add_u32_dpp v50, v50, v50 row_ror:8 row_mask:0xf bank_mask:0xf
  s_nop 0
  v_readlane_b32 s100, v50, 0
  v_readlane_b32 s101, v50, 16
  s_add_u32 s100, s100, s101
  s_sub_i32 s100, s100, 2435
  s_ashr_i32 s37, s100, 1
  s_add_i32 s101, s100, 32
  s_mul_i32 s101, s101, -20
  s_ashr_i32 s101, s101, 8
  s_min_i32 s101, s101, 4
  s_add_i32 s80, s101, 81
  s_max_i32 s80, s80, s3
  s_mul_i32 s100, s100, 24
  s_ashr_i32 s100, s100, 8
  s_min_i32 s100, s100, 8
  s_add_i32 s14, s100, 81
  s_waitcnt lgkmcnt(0)
  v_mfma_f32_16x16x32_bf16 v[52:55], a[164:167], a[16:19], 0
  v_mfma_f32_16x16x32_bf16 v[52:55], a[168:171], a[20:23], v[52:55]
  v_mfma_f32_16x16x32_bf16 v[52:55], a[172:175], a[24:27], v[52:55]
  v_mfma_f32_16x16x32_bf16 v[52:55], a[176:179], a[28:31], v[52:55]
  s_waitcnt vmcnt(8)
  s_cbranch_vccnz L_b331
  s_waitcnt vmcnt(7)
  s_bitcmp0_b32 s77, 31
  s_cbranch_scc1 L_b331
  s_cmp_gt_i32 s80, 80
  s_cbranch_scc0 L_n331
  s_waitcnt vmcnt(4)
L_n331:
  s_waitcnt vmcnt(5)
L_b331:
  buffer_load_dwordx4 v11, s[28:31], s65 offen offset:3072 nt lds
  s_nop 7
  v_cvt_pk_bf16_f32 v52, 0, v52
  v_cvt_pk_bf16_f32 v53, 0, v53
  v_cvt_pk_bf16_f32 v54, 0, v54
  v_cvt_pk_bf16_f32 v55, 0, v55
  v_mul_f32 v52, s72, v52
  v_mul_f32 v53, s72, v53
  v_mul_f32 v54, s72, v54
  v_mul_f32 v55, s72, v55
  v_max3_f32 v24, v24, v52, v53
  v_cvt_pk_bf16_f32 v94, v52, v53
  v_max3_f32 v24, v24, v54, v55
  v_cvt_pk_bf16_f32 v95, v54, v55
  s_xor_b32 s65, s64, 0x84000
  s_add_u32 m0, s66, 16384
  s_sub_i32 s77, s36, 82
  s_cmp_gt_i32 s14, 81
  s_cselect_b64 vcc, -1, 0
  s_waitcnt vmcnt(8)
  s_cbranch_vccnz L_b332
  s_waitcnt vmcnt(6)
  s_bitcmp0_b32 s77, 31
  s_cbranch_scc1 L_b332
  s_cmp_gt_i32 s80, 81
  s_cbranch_scc0 L_n332
  s_waitcnt vmcnt(4)
L_n332:
  s_waitcnt vmcnt(5)
L_b332:
  buffer_load_dwordx4 v10, s[28:31], s65 offen offset:0 nt lds
  ds_read_b128 a[180:183], v12 offset:4096
  ds_read_b128 a[184:187], v13 offset:4096
  ds_read_b128 a[188:191], v14 offset:4096
  ds_read_b128 a[192:195], v15 offset:4096
  s_waitcnt vmcnt(7)
  s_cbranch_vccnz L_b333
  s_waitcnt vmcnt(6)
  s_bitcmp0_b32 s77, 31
  s_cbranch_scc1 L_b333
  s_cmp_gt_i32 s80, 81
  s_cbranch_scc0 L_n333
  s_waitcnt vmcnt(4)
L_n333:
  s_waitcnt vmcnt(5)
L_b333:
  buffer_load_dwordx4 v11, s[28:31], s65 offen offset:1024 nt lds
  s_cmp_eq_u32 s15, 1
  s_cselect_b32 s18, s16, 0x400000
  v_or_b32 v8, 81, v9
  buffer_store_dword v8, v6, s[44:47], s18 offen
  s_waitcnt lgkmcnt(0)
  v_mfma_f32_16x16x32_bf16 v[52:55], a[180:183], a[16:19], 0
  v_mfma_f32_16x16x32_bf16 v[52:55], a[184:187], a[20:23], v[52:55]
  v_mfma_f32_16x16x32_bf16 v[52:55], a[188:191], a[24:27], v[52:55]
  v_mfma_f32_16x16x32_bf16 v[52:55], a[192:195], a[28:31], v[52:55]
  s_waitcnt vmcnt(8)
  s_cbranch_vccnz L_b334
  s_waitcnt vmcnt(7)
  s_bitcmp0_b32 s77, 31
  s_cbranch_scc1 L_b334
  s_cmp_gt_i32 s80, 81
  s_cbranch_scc0 L_n334
  s_waitcnt vmcnt(4)
L_n334:
  s_waitcnt vmcnt(6)
L_b334:
  buffer_load_dwordx4 v10, s[28:31], s65 offen offset:2048 nt lds
  s_nop 7
  v_cvt_pk_bf16_f32 v52, 0, v52
  v_cvt_pk_bf16_f32 v53, 0, v53
  v_cvt_pk_bf16_f32 v54, 0, v54
  v_cvt_pk_bf16_f32 v55, 0, v55
  v_mul_f32 v52, s72, v52
  v_mul_f32 v53, s72, v53
  v_mul_f32 v54, s72, v54
  v_mul_f32 v55, s72, v55
  v_max3_f32 v24, v24, v52, v53
  v_cvt_pk_bf16_f32 v96, v52, v53
  v_max3_f32 v24, v24, v54, v55
  v_cvt_pk_bf16_f32 v97, v54, v55
  s_waitcnt vmcnt(8)
  s_cbranch_vccnz L_b335
  s_waitcnt vmcnt(7)
  s_bitcmp0_b32 s77, 31
  s_cbranch_scc1 L_b335
  s_cmp_gt_i32 s80, 81
  s_cbranch_scc0 L_n335
  s_waitcnt vmcnt(4)
L_n335:
  s_waitcnt vmcnt(5)
L_b335:
  buffer_load_dwordx4 v11, s[28:31], s65 offen offset:3072 nt lds
  s_xor_b32 s65, s64, 0x480000
  s_add_u32 m0, s66, 20480
  s_sub_i32 s77, s36, 83
  s_cmp_gt_i32 s14, 82
  s_cselect_b64 vcc, -1, 0
  s_waitcnt vmcnt(8)
  s_cbranch_vccnz L_b336
  s_waitcnt vmcnt(6)
  s_bitcmp0_b32 s77, 31
  s_cbranch_scc1 L_b336
  s_cmp_gt_i32 s80, 82
  s_cbranch_scc0 L_n336
  s_waitcnt vmcnt(4)
L_n336:
  s_waitcnt vmcnt(5)
L_b336:
  buffer_load_dwordx4 v10, s[28:31], s65 offen offset:0 nt lds
  ds_read_b128 a[196:199], v12 offset:8192
  ds_read_b128 a[200:203], v13 offset:8192
  ds_read_b128 a[204:207], v14 offset:8192
  ds_read_b128 a[208:211], v15 offset:8192
  s_waitcnt vmcnt(7)
  s_cbranch_vccnz L_b337
  s_waitcnt vmcnt(6)
  s_bitcmp0_b32 s77, 31
  s_cbranch_scc1 L_b337
  s_cmp_gt_i32 s80, 82
  s_cbranch_scc0 L_n337
  s_waitcnt vmcnt(4)
L_n337:
  s_waitcnt vmcnt(5)
L_b337:
  buffer_load_dwordx4 v11, s[28:31], s65 offen offset:1024 nt lds
  s_cmp_eq_u32 s15, 2
  s_cselect_b32 s18, s16, 0x400000
  v_or_b32 v8, 82, v9
  buffer_store_dword v8, v6, s[44:47], s18 offen
  s_waitcnt lgkmcnt(0)
  v_mfma_f32_16x16x32_bf16 v[52:55], a[196:199], a[16:19], 0
  v_mfma_f32_16x16x32_bf16 v[52:55], a[200:203], a[20:23], v[52:55]
  v_mfma_f32_16x16x32_bf16 v[52:55], a[204:207], a[24:27], v[52:55]
  v_mfma_f32_16x16x32_bf16 v[52:55], a[208:211], a[28:31], v[52:55]
  s_waitcnt vmcnt(8)
  s_cbranch_vccnz L_b338
  s_waitcnt vmcnt(7)
  s_bitcmp0_b32 s77, 31
  s_cbranch_scc1 L_b338
  s_cmp_gt_i32 s80, 82
  s_cbranch_scc0 L_n338
  s_waitcnt vmcnt(4)
L_n338:
  s_waitcnt vmcnt(6)
L_b338:
  buffer_load_dwordx4 v10, s[28:31], s65 offen offset:2048 nt lds
  buffer_load_dword v50, v7, s[44:47], 0 offen sc1
  s_nop 7
  v_cvt_pk_bf16_f32 v52, 0, v52
  v_cvt_pk_bf16_f32 v53, 0, v53
  v_cvt_pk_bf16_f32 v54, 0, v54
  v_cvt_pk_bf16_f32 v55, 0, v55
  v_mul_f32 v52, s72, v52
  v_mul_f32 v53, s72, v53
  v_mul_f32 v54, s72, v54
  v_mul_f32 v55, s72, v55
  v_max3_f32 v24, v24, v52, v53
  v_cvt_pk_bf16_f32 v98, v52, v53
  v_max3_f32 v24, v24, v54, v55
  v_cvt_pk_bf16_f32 v99, v54, v55
  s_waitcnt vmcnt(9)
  s_cbranch_vccnz L_b339
  s_waitcnt vmcnt(8)
  s_bitcmp0_b32 s77, 31
  s_cbranch_scc1 L_b339
  s_cmp_gt_i32 s80, 82
  s_cbranch_scc0 L_n339
  s_waitcnt vmcnt(5)
L_n339:
  s_waitcnt vmcnt(6)
L_b339:
  buffer_load_dwordx4 v11, s[28:31], s65 offen offset:3072 nt lds
  s_xor_b32 s65, s64, 0x484000
  s_add_u32 m0, s66, 24576
  s_sub_i32 s77, s36, 84
  s_cmp_gt_i32 s14, 83
  s_cselect_b64 vcc, -1, 0
  s_waitcnt vmcnt(9)
  s_cbranch_vccnz L_b340
  s_waitcnt vmcnt(7)
  s_bitcmp0_b32 s77, 31
  s_cbranch_scc1 L_b340
  s_cmp_gt_i32 s80, 83
  s_cbranch_scc0 L_n340
  s_waitcnt vmcnt(5)
L_n340:
  s_waitcnt vmcnt(6)
L_b340:
  buffer_load_dwordx4 v10, s[28:31], s65 offen offset:0 nt lds
  s_waitcnt vmcnt(8)
  s_cbranch_vccnz L_b341
  s_waitcnt vmcnt(7)
  s_bitcmp0_b32 s77, 31
  s_cbranch_scc1 L_b341
  s_cmp_gt_i32 s80, 83
  s_cbranch_scc0 L_n341
  s_waitcnt vmcnt(5)
L_n341:
  s_waitcnt vmcnt(6)
L_b341:
  buffer_load_dwordx4 v11, s[28:31], s65 offen offset:1024 nt lds
  s_cmp_eq_u32 s15, 3
  s_cselect_b32 s18, s16, 0x400000
  v_or_b32 v8, 83, v9
  buffer_store_dword v8, v6, s[44:47], s18 offen
  ds_read_b128 a[132:135], v12 offset:12288
  ds_read_b128 a[136:139], v13 offset:12288
  ds_read_b128 a[140:143], v14 offset:12288
  ds_read_b128 a[144:147], v15 offset:12288
  s_waitcnt vmcnt(9)
  s_cbranch_vccnz L_b342
  s_waitcnt vmcnt(8)
  s_bitcmp0_b32 s77, 31
  s_cbranch_scc1 L_b342
  s_cmp_gt_i32 s80, 83
  s_cbranch_scc0 L_n342
  s_waitcnt vmcnt(5)
L_n342:
  s_waitcnt vmcnt(7)
L_b342:
  buffer_load_dwordx4 v10, s[28:31], s65 offen offset:2048 nt lds
  s_waitcnt lgkmcnt(0)
  v_mfma_f32_16x16x32_bf16 v[52:55], a[132:135], a[16:19], 0
  v_mfma_f32_16x16x32_bf16 v[52:55], a[136:139], a[20:23], v[52:55]
  v_mfma_f32_16x16x32_bf16 v[52:55], a[140:143], a[24:27], v[52:55]
  v_mfma_f32_16x16x32_bf16 v[52:55], a[144:147], a[28:31], v[52:55]
  s_waitcnt vmcnt(9)
  s_cbranch_vccnz L_b343
  s_waitcnt vmcnt(8)
  s_bitcmp0_b32 s77, 31
  s_cbranch_scc1 L_b343
  s_cmp_gt_i32 s80, 83
  s_cbranch_scc0 L_n343
  s_waitcnt vmcnt(4)
L_n343:
  s_waitcnt vmcnt(6)
L_b343:
  buffer_load_dwordx4 v11, s[28:31], s65 offen offset:3072 nt lds
  s_mov_b32 s18, 135168
  buffer_load_dword v184, v182, s[44:47], s18 offen sc1
  s_nop 7
  v_cvt_pk_bf16_f32 v52, 0, v52
  v_cvt_pk_bf16_f32 v53, 0, v53
  v_cvt_pk_bf16_f32 v54, 0, v54
  v_cvt_pk_bf16_f32 v55, 0, v55
  v_mul_f32 v52, s72, v52
  v_mul_f32 v53, s72, v53
  v_mul_f32 v54, s72, v54
  v_mul_f32 v55, s72, v55
  v_max3_f32 v24, v24, v52, v53
  v_cvt_pk_bf16_f32 v100, v52, v53
  v_max3_f32 v24, v24, v54, v55
  v_cvt_pk_bf16_f32 v101, v54, v55
  s_xor_b32 s65, s64, 0xa0000
  s_add_u32 m0, s66, 0
  s_sub_i32 s77, s36, 85
  s_cmp_gt_i32 s14, 84
  s_cselect_b64 vcc, -1, 0
  s_waitcnt vmcnt(10)
  s_cbranch_vccnz L_b344
  s_waitcnt vmcnt(8)
  s_bitcmp0_b32 s77, 31
  s_cbranch_scc1 L_b344
  s_cmp_gt_i32 s80, 84
  s_cbranch_scc0 L_n344
  s_waitcnt vmcnt(5)
L_n344:
  s_waitcnt vmcnt(6)
L_b344:
  buffer_load_dwordx4 v10, s[28:31], s65 offen offset:0 nt lds
  s_waitcnt vmcnt(9)
  s_cbranch_vccnz L_b345
  s_waitcnt vmcnt(7)
  s_bitcmp0_b32 s77, 31
  s_cbranch_scc1 L_b345
  s_cmp_gt_i32 s80, 84
  s_cbranch_scc0 L_n345
  s_waitcnt vmcnt(5)
L_n345:
  s_waitcnt vmcnt(6)
L_b345:
  buffer_load_dwordx4 v11, s[28:31], s65 offen offset:1024 nt lds
  s_cmp_eq_u32 s15, 0
  s_cselect_b32 s18, s16, 0x400000
  v_or_b32 v8, 84, v9
  buffer_store_dword v8, v6, s[44:47], s18 offen
  ds_read_b128 a[148:151], v12 offset:16384
  ds_read_b128 a[152:155], v13 offset:16384
  ds_read_b128 a[156:159], v14 offset:16384
  ds_read_b128 a[160:163], v15 offset:16384
  s_waitcnt vmcnt(9)
  s_cbranch_vccnz L_b346
  s_waitcnt vmcnt(8)
  s_bitcmp0_b32 s77, 31
  s_cbranch_scc1 L_b346
  s_cmp_gt_i32 s80, 84
  s_cbranch_scc0 L_n346
  s_waitcnt vmcnt(5)
L_n346:
  s_waitcnt vmcnt(7)
L_b346:
  buffer_load_dwordx4 v10, s[28:31], s65 offen offset:2048 nt lds
  v_xor_b32 v50, s17, v50
  v_lshrrev_b32 v51, 8, v50
  v_cmp_eq_u32 s[82:83], 0, v51
  v_mov_b32 v51, 80
  s_nop 0
  v_cndmask_b32 v50, v51, v50, s[82:83]
  s_nop 1
  v_add_u32_dpp v50, v50, v50 row_ror:1 row_mask:0xf bank_mask:0xf
  s_nop 1
  v_add_u32_dpp v50, v50, v50 row_ror:2 row_mask:0xf bank_mask:0xf
  s_nop 1
  v_add_u32_dpp v50, v50, v50 row_ror:4 row_mask:0xf bank_mask:0xf
  s_nop 1
  v_add_u32_dpp v50, v50, v50 row_ror:8 row_mask:0xf bank_mask:0xf
  s_nop 0
  v_readlane_b32 s100, v50, 0
  v_readlane_b32 s101, v50, 16
  s_add_u32 s100, s100, s101
  s_sub_i32 s100, s100, 2563
  s_ashr_i32 s37, s100, 1
  s_add_i32 s101, s100, 32
  s_mul_i32 s101, s101, -20
  s_ashr_i32 s101, s101, 8
  s_min_i32 s101, s101, 4
  s_add_i32 s80, s101, 85
  s_max_i32 s80, s80, s3
  s_mul_i32 s100, s100, 24
  s_ashr_i32 s100, s100, 8
  s_min_i32 s100, s100, 8
  s_add_i32 s14, s100, 85
  s_waitcnt lgkmcnt(0)
  v_mfma_f32_16x16x32_bf16 v[52:55], a[148:151], a[16:19], 0
  v_mfma_f32_16x16x32_bf16 v[52:55], a[152:155], a[20:23], v[52:55]
  v_mfma_f32_16x16x32_bf16 v[52:55], a[156:159], a[24:27], v[52:55]
  v_mfma_f32_16x16x32_bf16 v[52:55], a[160:163], a[28:31], v[52:55]
  s_waitcnt vmcnt(9)
  s_cbranch_vccnz L_b347
  s_waitcnt vmcnt(8)
  s_bitcmp0_b32 s77, 31
  s_cbranch_scc1 L_b347
  s_cmp_gt_i32 s80, 84
  s_cbranch_scc0 L_n347
  s_waitcnt vmcnt(5)
L_n347:
  s_waitcnt vmcnt(6)
L_b347:
  buffer_load_dwordx4 v11, s[28:31], s65 offen offset:3072 nt lds
  s_mov_b32 s18, 135168
  buffer_load_dword v185, v182, s[44:47], s18 offen sc1
  s_nop 7
  v_cvt_pk_bf16_f32 v52, 0, v52
  v_cvt_pk_bf16_f32 v53, 0, v53
  v_cvt_pk_bf16_f32 v54, 0, v54
  v_cvt_pk_bf16_f32 v55, 0, v55
  v_mul_f32 v52, s72, v52
  v_mul_f32 v53, s72, v53
  v_mul_f32 v54, s72, v54
  v_mul_f32 v55, s72, v55
  v_max3_f32 v24, v24, v52, v53
  v_cvt_pk_bf16_f32 v102, v52, v53
  v_max3_f32 v24, v24, v54, v55
  v_cvt_pk_bf16_f32 v103, v54, v55
  s_xor_b32 s65, s64, 0xa4000
  s_add_u32 m0, s66, 4096
  s_sub_i32 s77, s36, 86
  s_cmp_gt_i32 s14, 85
  s_cselect_b64 vcc, -1, 0
  s_waitcnt vmcnt(10)
  s_cbranch_vccnz L_b348
  s_waitcnt vmcnt(8)
  s_bitcmp0_b32 s77, 31
  s_cbranch_scc1 L_b348
  s_cmp_gt_i32 s80, 85
  s_cbranch_scc0 L_n348
  s_waitcnt vmcnt(5)
L_n348:
  s_waitcnt vmcnt(7)
L_b348:
  buffer_load_dwordx4 v10, s[28:31], s65 offen offset:0 nt lds
  s_waitcnt vmcnt(9)
  s_cbranch_vccnz L_b349
  s_waitcnt vmcnt(8)
  s_bitcmp0_b32 s77, 31
  s_cbranch_scc1 L_b349
  s_cmp_gt_i32 s80, 85
  s_cbranch_scc0 L_n349
  s_waitcnt vmcnt(5)
L_n349:
  s_waitcnt vmcnt(6)
L_b349:
  buffer_load_dwordx4 v11, s[28:31], s65 offen offset:1024 nt lds
  s_cmp_eq_u32 s15, 1
  s_cselect_b32 s18, s16, 0x400000
  v_or_b32 v8, 85, v9
  buffer_store_dword v8, v6, s[44:47], s18 offen
  ds_read_b128 a[164:167], v12 offset:20480
  ds_read_b128 a[168:171], v13 offset:20480
  ds_read_b128 a[172:175], v14 offset:20480
  ds_read_b128 a[176:179], v15 offset:20480
  s_waitcnt vmcnt(10)
  s_cbranch_vccnz L_b350
  s_waitcnt vmcnt(8)
  s_bitcmp0_b32 s77, 31
  s_cbranch_scc1 L_b350
  s_cmp_gt_i32 s80, 85
  s_cbranch_scc0 L_n350
  s_waitcnt vmcnt(5)
L_n350:
  s_waitcnt vmcnt(7)
L_b350:
  buffer_load_dwordx4 v10, s[28:31], s65 offen offset:2048 nt lds
  s_waitcnt lgkmcnt(0)
  v_mfma_f32_16x16x32_bf16 v[52:55], a[164:167], a[16:19], 0
  v_mfma_f32_16x16x32_bf16 v[52:55], a[168:171], a[20:23], v[52:55]
  v_mfma_f32_16x16x32_bf16 v[52:55], a[172:175], a[24:27], v[52:55]
  v_mfma_f32_16x16x32_bf16 v[52:55], a[176:179], a[28:31], v[52:55]
  s_waitcnt vmcnt(9)
  s_cbranch_vccnz L_b351
  s_waitcnt vmcnt(8)
  s_bitcmp0_b32 s77, 31
  s_cbranch_scc1 L_b351
  s_cmp_gt_i32 s80, 85
  s_cbranch_scc0 L_n351
  s_waitcnt vmcnt(5)
L_n351:
  s_waitcnt vmcnt(6)
L_b351:
  buffer_load_dwordx4 v11, s[28:31], s65 offen offset:3072 nt lds
  s_mov_b32 s18, 135168
  buffer_load_dword v186, v182, s[44:47], s18 offen sc1
  s_nop 7
  v_cvt_pk_bf16_f32 v52, 0, v52
  v_cvt_pk_bf16_f32 v53, 0, v53
  v_cvt_pk_bf16_f32 v54, 0, v54
  v_cvt_pk_bf16_f32 v55, 0, v55
  v_mul_f32 v52, s72, v52
  v_mul_f32 v53, s72, v53
  v_mul_f32 v54, s72, v54
  v_mul_f32 v55, s72, v55
  v_max3_f32 v24, v24, v52, v53
  v_cvt_pk_bf16_f32 v104, v52, v53
  v_max3_f32 v24, v24, v54, v55
  v_cvt_pk_bf16_f32 v105, v54, v55
  s_xor_b32 s65, s64, 0x4a0000
  s_add_u32 m0, s66, 8192
  s_sub_i32 s77, s36, 87
  s_cmp_gt_i32 s14, 86
  s_cselect_b64 vcc, -1, 0
  s_waitcnt vmcnt(10)
  s_cbranch_vccnz L_b352
  s_waitcnt vmcnt(8)
  s_bitcmp0_b32 s77, 31
  s_cbranch_scc1 L_b352
  s_cmp_gt_i32 s80, 86
  s_cbranch_scc0 L_n352
  s_waitcnt vmcnt(5)
L_n352:
  s_waitcnt vmcnt(7)
L_b352:
  buffer_load_dwordx4 v10, s[28:31], s65 offen offset:0 nt lds
  s_waitcnt vmcnt(9)
  s_cbranch_vccnz L_b353
  s_waitcnt vmcnt(8)
  s_bitcmp0_b32 s77, 31
  s_cbranch_scc1 L_b353
  s_cmp_gt_i32 s80, 86
  s_cbranch_scc0 L_n353
  s_waitcnt vmcnt(5)
L_n353:
  s_waitcnt vmcnt(6)
L_b353:
  buffer_load_dwordx4 v11, s[28:31], s65 offen offset:1024 nt lds
  s_cmp_eq_u32 s15, 2
  s_cselect_b32 s18, s16, 0x400000
  v_or_b32 v8, 86, v9
  buffer_store_dword v8, v6, s[44:47], s18 offen
  ds_read_b128 a[180:183], v12 offset:24576
  ds_read_b128 a[184:187], v13 offset:24576
  ds_read_b128 a[188:191], v14 offset:24576
  ds_read_b128 a[192:195], v15 offset:24576
  s_waitcnt vmcnt(10)
  s_cbranch_vccnz L_b354
  s_waitcnt vmcnt(8)
  s_bitcmp0_b32 s77, 31
  s_cbranch_scc1 L_b354
  s_cmp_gt_i32 s80, 86
  s_cbranch_scc0 L_n354
  s_waitcnt vmcnt(5)
L_n354:
  s_waitcnt vmcnt(7)
L_b354:
  buffer_load_dwordx4 v10, s[28:31], s65 offen offset:2048 nt lds
  buffer_load_dword v50, v7, s[44:47], 0 offen sc1
  s_bitcmp1_b32 s38, 30
  s_cbranch_scc1 L_gp4
  s_add_i32 s100, s37, 128
  s_max_i32 s100, s100, 0
  s_min_i32 s100, s100, 255
  s_mov_b32 s62, s100
  v_or_b32 v180, s100, v9
  s_add_u32 s18, s38, 135168
  buffer_store_dword v180, v6, s[44:47], s18 offen sc1
L_gp4:
  s_waitcnt lgkmcnt(0)
  v_mfma_f32_16x16x32_bf16 v[52:55], a[180:183], a[16:19], 0
  v_mfma_f32_16x16x32_bf16 v[52:55], a[184:187], a[20:23], v[52:55]
  v_mfma_f32_16x16x32_bf16 v[52:55], a[188:191], a[24:27], v[52:55]
  v_mfma_f32_16x16x32_bf16 v[52:55], a[192:195], a[28:31], v[52:55]
  s_waitcnt vmcnt(10)
  s_cbranch_vccnz L_b355
  s_waitcnt vmcnt(9)
  s_bitcmp0_b32 s77, 31
  s_cbranch_scc1 L_b355
  s_cmp_gt_i32 s80, 86
  s_cbranch_scc0 L_n355
  s_waitcnt vmcnt(6)
L_n355:
  s_waitcnt vmcnt(7)
L_b355:
  buffer_load_dwordx4 v11, s[28:31], s65 offen offset:3072 nt lds
  s_mov_b32 s18, 135168
  buffer_load_dword v187, v182, s[44:47], s18 offen sc1
  s_nop 7
  v_cvt_pk_bf16_f32 v52, 0, v52
  v_cvt_pk_bf16_f32 v53, 0, v53
  v_cvt_pk_bf16_f32 v54, 0, v54
  v_cvt_pk_bf16_f32 v55, 0, v55
  v_mul_f32 v52, s72, v52
  v_mul_f32 v53, s72, v53
  v_mul_f32 v54, s72, v54
  v_mul_f32 v55, s72, v55
  v_max3_f32 v24, v24, v52, v53
  v_cvt_pk_bf16_f32 v106, v52, v53
  v_max3_f32 v24, v24, v54, v55
  v_cvt_pk_bf16_f32 v107, v54, v55
  s_xor_b32 s65, s64, 0x4a4000
  s_add_u32 m0, s66, 12288
  s_sub_i32 s77, s36, 88
  s_cmp_gt_i32 s14, 87
  s_cselect_b64 vcc, -1, 0
  s_waitcnt vmcnt(11)
  s_cbranch_vccnz L_b356
  s_waitcnt vmcnt(9)
  s_bitcmp0_b32 s77, 31
  s_cbranch_scc1 L_b356
  s_cmp_gt_i32 s80, 87
  s_cbranch_scc0 L_n356
  s_waitcnt vmcnt(6)
L_n356:
  s_waitcnt vmcnt(8)
L_b356:
  buffer_load_dwordx4 v10, s[28:31], s65 offen offset:0 nt lds
  s_waitcnt vmcnt(10)
  s_cbranch_vccnz L_b357
  s_waitcnt vmcnt(9)
  s_bitcmp0_b32 s77, 31
  s_cbranch_scc1 L_b357
  s_cmp_gt_i32 s80, 87
  s_cbranch_scc0 L_n357
  s_waitcnt vmcnt(6)
L_n357:
  s_waitcnt vmcnt(7)
L_b357:
  buffer_load_dwordx4 v11, s[28:31], s65 offen offset:1024 nt lds
  s_cmp_eq_u32 s15, 3
  s_cselect_b32 s18, s16, 0x400000
  v_or_b32 v8, 87, v9
  buffer_store_dword v8, v6, s[44:47], s18 offen
  s_waitcnt vmcnt(11)
  s_cbranch_vccnz L_b358
  s_waitcnt vmcnt(9)
  s_bitcmp0_b32 s77, 31
  s_cbranch_scc1 L_b358
  s_cmp_gt_i32 s80, 87
  s_cbranch_scc0 L_n358
  s_waitcnt vmcnt(6)
L_n358:
  s_waitcnt vmcnt(8)
L_b358:
  buffer_load_dwordx4 v10, s[28:31], s65 offen offset:2048 nt lds
  s_waitcnt vmcnt(10)
  s_cbranch_vccnz L_b359
  s_waitcnt vmcnt(9)
  s_bitcmp0_b32 s77, 31
  s_cbranch_scc1 L_b359
  s_cmp_gt_i32 s80, 87
  s_cbranch_scc0 L_n359
  s_waitcnt vmcnt(5)
L_n359:
  s_waitcnt vmcnt(7)
L_b359:
  buffer_load_dwordx4 v11, s[28:31], s65 offen offset:3072 nt lds
  s_mov_b32 s18, 135168
  buffer_load_dword v188, v182, s[44:47], s18 offen sc1
  ds_read_b128 a[196:199], v12 offset:0
  ds_read_b128 a[200:203], v13 offset:0
  ds_read_b128 a[204:207], v14 offset:0
  ds_read_b128 a[208:211], v15 offset:0
  s_xor_b32 s65, s64, 0xc0000
  s_add_u32 m0, s66, 16384
  s_sub_i32 s77, s36, 89
  s_cmp_gt_i32 s14, 88
  s_cselect_b64 vcc, -1, 0
  s_waitcnt vmcnt(11)
  s_cbranch_vccnz L_b360
  s_waitcnt vmcnt(9)
  s_bitcmp0_b32 s77, 31
  s_cbranch_scc1 L_b360
  s_cmp_gt_i32 s80, 88
  s_cbranch_scc0 L_n360
  s_waitcnt vmcnt(5)
L_n360:
  s_waitcnt vmcnt(7)
L_b360:
  buffer_load_dwordx4 v10, s[28:31], s65 offen offset:0 nt lds
  s_waitcnt lgkmcnt(0)
  v_mfma_f32_16x16x32_bf16 v[52:55], a[196:199], a[16:19], 0
  v_mfma_f32_16x16x32_bf16 v[52:55], a[200:203], a[20:23], v[52:55]
  v_mfma_f32_16x16x32_bf16 v[52:55], a[204:207], a[24:27], v[52:55]
  v_mfma_f32_16x16x32_bf16 v[52:55], a[208:211], a[28:31], v[52:55]
  s_waitcnt vmcnt(10)
  s_cbranch_vccnz L_b361
  s_waitcnt vmcnt(8)
  s_bitcmp0_b32 s77, 31
  s_cbranch_scc1 L_b361
  s_cmp_gt_i32 s80, 88
  s_cbranch_scc0 L_n361
  s_waitcnt vmcnt(5)
L_n361:
  s_waitcnt vmcnt(6)
L_b361:
  buffer_load_dwordx4 v11, s[28:31], s65 offen offset:1024 nt lds
  s_cmp_eq_u32 s15, 0
  s_cselect_b32 s18, s16, 0x400000
  v_or_b32 v8, 88, v9
  buffer_store_dword v8, v6, s[44:47], s18 offen
  s_nop 7
  v_cvt_pk_bf16_f32 v52, 0, v52
  v_cvt_pk_bf16_f32 v53, 0, v53
  v_cvt_pk_bf16_f32 v54, 0, v54
  v_cvt_pk_bf16_f32 v55, 0, v55
  v_mul_f32 v52, s72, v52
  v_mul_f32 v53, s72, v53
  v_mul_f32 v54, s72, v54
  v_mul_f32 v55, s72, v55
  v_max3_f32 v24, v24, v52, v53
  v_cvt_pk_bf16_f32 v108, v52, v53
  v_max3_f32 v24, v24, v54, v55
  v_cvt_pk_bf16_f32 v109, v54, v55
  s_waitcnt vmcnt(10)
  s_cbranch_vccnz L_b362
  s_waitcnt vmcnt(8)
  s_bitcmp0_b32 s77, 31
  s_cbranch_scc1 L_b362
  s_cmp_gt_i32 s80, 88
  s_cbranch_scc0 L_n362
  s_waitcnt vmcnt(5)
L_n362:
  s_waitcnt vmcnt(7)
L_b362:
  buffer_load_dwordx4 v10, s[28:31], s65 offen offset:2048 nt lds
  v_xor_b32 v50, s17, v50
  v_lshrrev_b32 v51, 8, v50
  v_cmp_eq_u32 s[82:83], 0, v51
  v_mov_b32 v51, 84
  s_nop 0
  v_cndmask_b32 v50, v51, v50, s[82:83]
  s_nop 1
  v_add_u32_dpp v50, v50, v50 row_ror:1 row_mask:0xf bank_mask:0xf
  s_nop 1
  v_add_u32_dpp v50, v50, v50 row_ror:2 row_mask:0xf bank_mask:0xf
  s_nop 1
  v_add_u32_dpp v50, v50, v50 row_ror:4 row_mask:0xf bank_mask:0xf
  s_nop 1
  v_add_u32_dpp v50, v50, v50 row_ror:8 row_mask:0xf bank_mask:0xf
  s_nop 0
  v_readlane_b32 s100, v50, 0
  v_readlane_b32 s101, v50, 16
  s_add_u32 s100, s100, s101
  s_sub_i32 s100, s100, 2691
  s_ashr_i32 s37, s100, 1
  s_add_i32 s62, s37, 128
  s_add_i32 s101, s100, 32
  s_mul_i32 s101, s101, -20
  s_ashr_i32 s101, s101, 8
  s_min_i32 s101, s101, 4
  s_add_i32 s80, s101, 89
  s_max_i32 s80, s80, s3
  s_mul_i32 s100, s100, 24
  s_ashr_i32 s100, s100, 8
  s_min_i32 s100, s100, 8
  s_add_i32 s14, s100, 89
  ds_read_b128 a[132:135], v12 offset:4096
  ds_read_b128 a[136:139], v13 offset:4096
  ds_read_b128 a[140:143], v14 offset:4096
  ds_read_b128 a[144:147], v15 offset:4096
  s_waitcnt vmcnt(9)
  s_cbranch_vccnz L_b363
  s_waitcnt vmcnt(8)
  s_bitcmp0_b32 s77, 31
  s_cbranch_scc1 L_b363
  s_cmp_gt_i32 s80, 88
  s_cbranch_scc0 L_n363
  s_waitcnt vmcnt(5)
L_n363:
  s_waitcnt vmcnt(6)
L_b363:
  buffer_load_dwordx4 v11, s[28:31], s65 offen offset:3072 nt lds
  s_mov_b32 s18, 135168
  buffer_load_dword v189, v182, s[44:47], s18 offen sc1
  s_waitcnt lgkmcnt(0)
  v_mfma_f32_16x16x32_bf16 v[52:55], a[132:135], a[16:19], 0
  v_mfma_f32_16x16x32_bf16 v[52:55], a[136:139], a[20:23], v[52:55]
  v_mfma_f32_16x16x32_bf16 v[52:55], a[140:143], a[24:27], v[52:55]
  v_mfma_f32_16x16x32_bf16 v[52:55], a[144:147], a[28:31], v[52:55]
  s_xor_b32 s65, s64, 0xc4000
  s_add_u32 m0, s66, 20480
  s_sub_i32 s77, s36, 90
  s_cmp_gt_i32 s14, 89
  s_cselect_b64 vcc, -1, 0
  s_waitcnt vmcnt(10)
  s_cbranch_vccnz L_b364
  s_waitcnt vmcnt(8)
  s_bitcmp0_b32 s77, 31
  s_cbranch_scc1 L_b364
  s_cmp_gt_i32 s80, 89
  s_cbranch_scc0 L_n364
  s_waitcnt vmcnt(5)
L_n364:
  s_waitcnt vmcnt(7)
L_b364:
  buffer_load_dwordx4 v10, s[28:31], s65 offen offset:0 nt lds
  s_nop 7
  v_cvt_pk_bf16_f32 v52, 0, v52
  v_cvt_pk_bf16_f32 v53, 0, v53
  v_cvt_pk_bf16_f32 v54, 0, v54
  v_cvt_pk_bf16_f32 v55, 0, v55
  v_mul_f32 v52, s72, v52
  v_mul_f32 v53, s72, v53
  v_mul_f32 v54, s72, v54
  v_mul_f32 v55, s72, v55
  v_max3_f32 v24, v24, v52, v53
  v_cvt_pk_bf16_f32 v110, v52, v53
  v_max3_f32 v24, v24, v54, v55
  v_cvt_pk_bf16_f32 v111, v54, v55
  s_waitcnt vmcnt(9)
  s_cbranch_vccnz L_b365
  s_waitcnt vmcnt(8)
  s_bitcmp0_b32 s77, 31
  s_cbranch_scc1 L_b365
  s_cmp_gt_i32 s80, 89
  s_cbranch_scc0 L_n365
  s_waitcnt vmcnt(5)
L_n365:
  s_waitcnt vmcnt(6)
L_b365:
  buffer_load_dwordx4 v11, s[28:31], s65 offen offset:1024 nt lds
  s_cmp_eq_u32 s15, 1
  s_cselect_b32 s18, s16, 0x400000
  v_or_b32 v8, 89, v9
  buffer_store_dword v8, v6, s[44:47], s18 offen
  ds_read_b128 a[148:151], v12 offset:8192
  ds_read_b128 a[152:155], v13 offset:8192
  ds_read_b128 a[156:159], v14 offset:8192
  ds_read_b128 a[160:163], v15 offset:8192
  s_waitcnt vmcnt(10)
  s_cbranch_vccnz L_b366
  s_waitcnt vmcnt(8)
  s_bitcmp0_b32 s77, 31
  s_cbranch_scc1 L_b366
  s_cmp_gt_i32 s80, 89
  s_cbranch_scc0 L_n366
  s_waitcnt vmcnt(5)
L_n366:
  s_waitcnt vmcnt(7)
L_b366:
  buffer_load_dwordx4 v10, s[28:31], s65 offen offset:2048 nt lds
  s_waitcnt lgkmcnt(0)
  v_mfma_f32_16x16x32_bf16 v[52:55], a[148:151], a[16:19], 0
  v_mfma_f32_16x16x32_bf16 v[52:55], a[152:155], a[20:23], v[52:55]
  v_mfma_f32_16x16x32_bf16 v[52:55], a[156:159], a[24:27], v[52:55]
  v_mfma_f32_16x16x32_bf16 v[52:55], a[160:163], a[28:31], v[52:55]
  s_waitcnt vmcnt(9)
  s_cbranch_vccnz L_b367
  s_waitcnt vmcnt(8)
  s_bitcmp0_b32 s77, 31
  s_cbranch_scc1 L_b367
  s_cmp_gt_i32 s80, 89
  s_cbranch_scc0 L_n367
  s_waitcnt vmcnt(5)
L_n367:
  s_waitcnt vmcnt(6)
L_b367:
  buffer_load_dwordx4 v11, s[28:31], s65 offen offset:3072 nt lds
  s_mov_b32 s18, 135168
  buffer_load_dword v190, v182, s[44:47], s18 offen sc1
  s_nop 7
  v_cvt_pk_bf16_f32 v52, 0, v52
  v_cvt_pk_bf16_f32 v53, 0, v53
  v_cvt_pk_bf16_f32 v54, 0, v54
  v_cvt_pk_bf16_f32 v55, 0, v55
  v_mul_f32 v52, s72, v52
  v_mul_f32 v53, s72, v53
  v_mul_f32 v54, s72, v54
  v_mul_f32 v55, s72, v55
  v_max3_f32 v24, v24, v52, v53
  v_cvt_pk_bf16_f32 v112, v52, v53
  v_max3_f32 v24, v24, v54, v55
  v_cvt_pk_bf16_f32 v113, v54, v55
  s_xor_b32 s65, s64, 0x4c0000
  s_add_u32 m0, s66, 24576
  s_sub_i32 s77, s36, 91
  s_cmp_gt_i32 s14, 90
  s_cselect_b64 vcc, -1, 0
  s_waitcnt vmcnt(10)
  s_cbranch_vccnz L_b368
  s_waitcnt vmcnt(8)
  s_bitcmp0_b32 s77, 31
  s_cbranch_scc1 L_b368
  s_cmp_gt_i32 s80, 90
  s_cbranch_scc0 L_n368
  s_waitcnt vmcnt(5)
L_n368:
  s_waitcnt vmcnt(7)
L_b368:
  buffer_load_dwordx4 v10, s[28:31], s65 offen offset:0 nt lds
  s_waitcnt vmcnt(9)
  s_cbranch_vccnz L_b369
  s_waitcnt vmcnt(8)
  s_bitcmp0_b32 s77, 31
  s_cbranch_scc1 L_b369
  s_cmp_gt_i32 s80, 90
  s_cbranch_scc0 L_n369
  s_waitcnt vmcnt(5)
L_n369:
  s_waitcnt vmcnt(6)
L_b369:
  buffer_load_dwordx4 v11, s[28:31], s65 offen offset:1024 nt lds
  s_cmp_eq_u32 s15, 2
  s_cselect_b32 s18, s16, 0x400000
  v_or_b32 v8, 90, v9
  buffer_store_dword v8, v6, s[44:47], s18 offen
  ds_read_b128 a[164:167], v12 offset:12288
  ds_read_b128 a[168:171], v13 offset:12288
  ds_read_b128 a[172:175], v14 offset:12288
  ds_read_b128 a[176:179], v15 offset:12288
  s_waitcnt vmcnt(10)
  s_cbranch_vccnz L_b370
  s_waitcnt vmcnt(8)
  s_bitcmp0_b32 s77, 31
  s_cbranch_scc1 L_b370
  s_cmp_gt_i32 s80, 90
  s_cbranch_scc0 L_n370
  s_waitcnt vmcnt(5)
L_n370:
  s_waitcnt vmcnt(7)
L_b370:
  buffer_load_dwordx4 v10, s[28:31], s65 offen offset:2048 nt lds
  buffer_load_dword v50, v7, s[44:47], 0 offen sc1
  s_waitcnt lgkmcnt(0)
  v_mfma_f32_16x16x32_bf16 v[52:55], a[164:167], a[16:19], 0
  v_mfma_f32_16x16x32_bf16 v[52:55], a[168:171], a[20:23], v[52:55]
  v_mfma_f32_16x16x32_bf16 v[52:55], a[172:175], a[24:27], v[52:55]
  v_mfma_f32_16x16x32_bf16 v[52:55], a[176:179], a[28:31], v[52:55]
  s_waitcnt vmcnt(10)
  s_cbranch_vccnz L_b371
  s_waitcnt vmcnt(9)
  s_bitcmp0_b32 s77, 31
  s_cbranch_scc1 L_b371
  s_cmp_gt_i32 s80, 90
  s_cbranch_scc0 L_n371
  s_waitcnt vmcnt(6)
L_n371:
  s_waitcnt vmcnt(7)
L_b371:
  buffer_load_dwordx4 v11, s[28:31], s65 offen offset:3072 nt lds
  s_mov_b32 s18, 135168
  buffer_load_dword v191, v182, s[44:47], s18 offen sc1
  s_nop 7
  v_cvt_pk_bf16_f32 v52, 0, v52
  v_cvt_pk_bf16_f32 v53, 0, v53
  v_cvt_pk_bf16_f32 v54, 0, v54
  v_cvt_pk_bf16_f32 v55, 0, v55
  v_mul_f32 v52, s72, v52
  v_mul_f32 v53, s72, v53
  v_mul_f32 v54, s72, v54
  v_mul_f32 v55, s72, v55
  v_max3_f32 v24, v24, v52, v53
  v_cvt_pk_bf16_f32 v114, v52, v53
  v_max3_f32 v24, v24, v54, v55
  v_cvt_pk_bf16_f32 v115, v54, v55
  s_xor_b32 s65, s64, 0x4c4000
  s_add_u32 m0, s66, 0
  s_sub_i32 s77, s36, 92
  s_cmp_gt_i32 s14, 91
  s_cselect_b64 vcc, -1, 0
  s_waitcnt vmcnt(11)
  s_cbranch_vccnz L_b372
  s_waitcnt vmcnt(9)
  s_bitcmp0_b32 s77, 31
  s_cbranch_scc1 L_b372
  s_cmp_gt_i32 s80, 91
  s_cbranch_scc0 L_n372
  s_waitcnt vmcnt(6)
L_n372:
  s_waitcnt vmcnt(8)
L_b372:
  buffer_load_dwordx4 v10, s[28:31], s65 offen offset:0 nt lds
  s_waitcnt vmcnt(10)
  s_cbranch_vccnz L_b373
  s_waitcnt vmcnt(9)
  s_bitcmp0_b32 s77, 31
  s_cbranch_scc1 L_b373
  s_cmp_gt_i32 s80, 91
  s_cbranch_scc0 L_n373
  s_waitcnt vmcnt(6)
L_n373:
  s_waitcnt vmcnt(7)
L_b373:
  buffer_load_dwordx4 v11, s[28:31], s65 offen offset:1024 nt lds
  s_cmp_eq_u32 s15, 3
  s_cselect_b32 s18, s16, 0x400000
  v_or_b32 v8, 91, v9
  buffer_store_dword v8, v6, s[44:47], s18 offen
  s_waitcnt vmcnt(11)
  s_cbranch_vccnz L_b374
  s_waitcnt vmcnt(9)
  s_bitcmp0_b32 s77, 31
  s_cbranch_scc1 L_b374
  s_cmp_gt_i32 s80, 91
  s_cbranch_scc0 L_n374
  s_waitcnt vmcnt(6)
L_n374:
  s_waitcnt vmcnt(8)
L_b374:
  buffer_load_dwordx4 v10, s[28:31], s65 offen offset:2048 nt lds
  s_waitcnt vmcnt(10)
  s_cbranch_vccnz L_b375
  s_waitcnt vmcnt(9)
  s_bitcmp0_b32 s77, 31
  s_cbranch_scc1 L_b375
  s_cmp_gt_i32 s80, 91
  s_cbranch_scc0 L_n375
  s_waitcnt vmcnt(5)
L_n375:
  s_waitcnt vmcnt(7)
L_b375:
  buffer_load_dwordx4 v11, s[28:31], s65 offen offset:3072 nt lds
  ds_read_b128 a[180:183], v12 offset:16384
  ds_read_b128 a[184:187], v13 offset:16384
  ds_read_b128 a[188:191], v14 offset:16384
  ds_read_b128 a[192:195], v15 offset:16384
  s_xor_b32 s65, s64, 0xe0000
  s_add_u32 m0, s66, 4096
  s_sub_i32 s77, s36, 93
  s_cmp_gt_i32 s14, 92
  s_cselect_b64 vcc, -1, 0
  s_waitcnt vmcnt(10)
  s_cbranch_vccnz L_b376
  s_waitcnt vmcnt(8)
  s_bitcmp0_b32 s77, 31
  s_cbranch_scc1 L_b376
  s_cmp_gt_i32 s80, 92
  s_cbranch_scc0 L_n376
  s_waitcnt vmcnt(4)
L_n376:
  s_waitcnt vmcnt(6)
L_b376:
  buffer_load_dwordx4 v10, s[28:31], s65 offen offset:0 nt lds
  s_waitcnt lgkmcnt(0)
  v_mfma_f32_16x16x32_bf16 v[52:55], a[180:183], a[16:19], 0
  v_mfma_f32_16x16x32_bf16 v[52:55], a[184:187], a[20:23], v[52:55]
  v_mfma_f32_16x16x32_bf16 v[52:55], a[188:191], a[24:27], v[52:55]
  v_mfma_f32_16x16x32_bf16 v[52:55], a[192:195], a[28:31], v[52:55]
  s_waitcnt vmcnt(9)
  s_cbranch_vccnz L_b377
  s_waitcnt vmcnt(7)
  s_bitcmp0_b32 s77, 31
  s_cbranch_scc1 L_b377
  s_cmp_gt_i32 s80, 92
  s_cbranch_scc0 L_n377
  s_waitcnt vmcnt(4)
L_n377:
  s_waitcnt vmcnt(5)
L_b377:
  buffer_load_dwordx4 v11, s[28:31], s65 offen offset:1024 nt lds
  s_cmp_eq_u32 s15, 0
  s_cselect_b32 s18, s16, 0x400000
  v_or_b32 v8, 92, v9
  buffer_store_dword v8, v6, s[44:47], s18 offen
  s_nop 7
  v_cvt_pk_bf16_f32 v52, 0, v52
  v_cvt_pk_bf16_f32 v53, 0, v53
  v_cvt_pk_bf16_f32 v54, 0, v54
  v_cvt_pk_bf16_f32 v55, 0, v55
  v_mul_f32 v52, s72, v52
  v_mul_f32 v53, s72, v53
  v_mul_f32 v54, s72, v54
  v_mul_f32 v55, s72, v55
  v_max3_f32 v24, v24, v52, v53
  v_cvt_pk_bf16_f32 v116, v52, v53
  v_max3_f32 v24, v24, v54, v55
  v_cvt_pk_bf16_f32 v117, v54, v55
  s_waitcnt vmcnt(9)
  s_cbranch_vccnz L_b378
  s_waitcnt vmcnt(7)
  s_bitcmp0_b32 s77, 31
  s_cbranch_scc1 L_b378
  s_cmp_gt_i32 s80, 92
  s_cbranch_scc0 L_n378
  s_waitcnt vmcnt(4)
L_n378:
  s_waitcnt vmcnt(6)
L_b378:
  buffer_load_dwordx4 v10, s[28:31], s65 offen offset:2048 nt lds
  v_xor_b32 v50, s17, v50
  v_lshrrev_b32 v51, 8, v50
  v_cmp_eq_u32 s[82:83], 0, v51
  v_mov_b32 v51, 88
  s_nop 0
  v_cndmask_b32 v50, v51, v50, s[82:83]
  s_nop 1
  v_add_u32_dpp v50, v50, v50 row_ror:1 row_mask:0xf bank_mask:0xf
  s_nop 1
  v_add_u32_dpp v50, v50, v50 row_ror:2 row_mask:0xf bank_mask:0xf
  s_nop 1
  v_add_u32_dpp v50, v50, v50 row_ror:4 row_mask:0xf bank_mask:0xf
  s_nop 1
  v_add_u32_dpp v50, v50, v50 row_ror:8 row_mask:0xf bank_mask:0xf
  s_nop 0
  v_readlane_b32 s100, v50, 0
  v_readlane_b32 s101, v50, 16
  s_add_u32 s100, s100, s101
  s_sub_i32 s100, s100, 2819
  s_ashr_i32 s37, s100, 1
  s_add_i32 s101, s100, 32
  s_mul_i32 s101, s101, -20
  s_ashr_i32 s101, s101, 8
  s_min_i32 s101, s101, 4
  s_add_i32 s80, s101, 93
  s_max_i32 s80, s80, s3
  s_mul_i32 s100, s100, 24
  s_ashr_i32 s100, s100, 8
  s_min_i32 s100, s100, 8
  s_add_i32 s14, s100, 93
  ds_read_b128 a[196:199], v12 offset:20480
  ds_read_b128 a[200:203], v13 offset:20480
  ds_read_b128 a[204:207], v14 offset:20480
  ds_read_b128 a[208:211], v15 offset:20480
  s_waitcnt vmcnt(8)
  s_cbranch_vccnz L_b379
  s_waitcnt vmcnt(7)
  s_bitcmp0_b32 s77, 31
  s_cbranch_scc1 L_b379
  s_cmp_gt_i32 s80, 92
  s_cbranch_scc0 L_n379
  s_waitcnt vmcnt(4)
L_n379:
  s_waitcnt vmcnt(5)
L_b379:
  buffer_load_dwordx4 v11, s[28:31], s65 offen offset:3072 nt lds
  s_bitcmp1_b32 s38, 30
  s_cbranch_scc1 L_ge4
  v_xor_b32 v184, s17, v184
  v_xor_b32 v185, s17, v185
  v_xor_b32 v186, s17, v186
  v_xor_b32 v187, s17, v187
  v_xor_b32 v188, s17, v188
  v_xor_b32 v189, s17, v189
  v_xor_b32 v190, s17, v190
  v_xor_b32 v191, s17, v191
  v_min_u32 v180, 0x100, v191
  v_lshrrev_b32 v181, 1, v180
  v_and_b32 v181, 0x80, v181
  v_and_b32 v180, 0xff, v180
  v_add_u32 v180, v180, v181
  v_lshrrev_b32 v184, 8, v184
  v_min_u32 v184, 1, v184
  v_lshlrev_b32 v184, 4, v184
  v_sub_u32 v180, v180, v184
  v_lshrrev_b32 v185, 8, v185
  v_min_u32 v185, 1, v185
  v_lshlrev_b32 v185, 4, v185
  v_sub_u32 v180, v180, v185
  v_lshrrev_b32 v186, 8, v186
  v_min_u32 v186, 1, v186
  v_lshlrev_b32 v186, 4, v186
  v_sub_u32 v180, v180, v186
  v_lshrrev_b32 v187, 8, v187
  v_min_u32 v187, 1, v187
  v_lshlrev_b32 v187, 4, v187
  v_sub_u32 v180, v180, v187
  v_lshrrev_b32 v188, 8, v188
  v_min_u32 v188, 1, v188
  v_lshlrev_b32 v188, 4, v188
  v_sub_u32 v180, v180, v188
  v_lshrrev_b32 v189, 8, v189
  v_min_u32 v189, 1, v189
  v_lshlrev_b32 v189, 4, v189
  v_sub_u32 v180, v180, v189
  v_lshrrev_b32 v190, 8, v190
  v_min_u32 v190, 1, v190
  v_lshlrev_b32 v190, 4, v190
  v_sub_u32 v180, v180, v190
  v_lshrrev_b32 v191, 8, v191
  v_min_u32 v191, 1, v191
  v_lshlrev_b32 v191, 4, v191
  v_sub_u32 v180, v180, v191
  s_and_b32 s101, s2, 7
  s_sub_i32 s100, s62, 64
  s_mov_b32 m0, s101
  v_writelane_b32 v180, s100, m0
  s_add_u32 m0, s66, 4096
  s_nop 1
  v_add_u32_dpp v180, v180, v180 quad_perm:[1,0,3,2] row_mask:0xf bank_mask:0xf
  s_nop 1
  v_add_u32_dpp v180, v180, v180 quad_perm:[2,3,0,1] row_mask:0xf bank_mask:0xf
  s_nop 1
  v_add_u32_dpp v180, v180, v180 row_half_mirror row_mask:0xf bank_mask:0xf
  s_nop 0
  v_readlane_b32 s101, v180, 0
  s_lshl_b32 s100, s100, 3
  s_sub_i32 s100, s101, s100
  s_add_i32 s100, s100, -32
  s_mul_i32 s100, s100, 96
  s_add_i32 s100, s100, 512
  s_ashr_i32 s100, s100, 10
  s_max_i32 s100, s100, -16
  s_min_i32 s100, s100, 16
  s_add_i32 s100, s100, 128
  v_or_b32 v180, s100, v9
  buffer_store_dword v180, v6, s[44:47], s39 offen offset:16
L_ge4:
  s_waitcnt lgkmcnt(0)
  v_mfma_f32_16x16x32_bf16 v[52:55], a[196:199], a[16:19], 0
  v_mfma_f32_16x16x32_bf16 v[52:55], a[200:203], a[20:23], v[52:55]
  v_mfma_f32_16x16x32_bf16 v[52:55], a[204:207], a[24:27], v[52:55]
  v_mfma_f32_16x16x32_bf16 v[52:55], a[208:211], a[28:31], v[52:55]
  s_xor_b32 s65, s64, 0xe4000
  s_add_u32 m0, s66, 8192
  s_sub_i32 s77, s36, 94
  s_cmp_gt_i32 s14, 93
  s_cselect_b64 vcc, -1, 0
  s_waitcnt vmcnt(8)
  s_cbranch_vccnz L_b380
  s_waitcnt vmcnt(6)
  s_bitcmp0_b32 s77, 31
  s_cbranch_scc1 L_b380
  s_cmp_gt_i32 s80, 93
  s_cbranch_scc0 L_n380
  s_waitcnt vmcnt(4)
L_n380:
  s_waitcnt vmcnt(5)
L_b380:
  buffer_load_dwordx4 v10, s[28:31], s65 offen offset:0 nt lds
  s_nop 7
  v_cvt_pk_bf16_f32 v52, 0, v52
  v_cvt_pk_bf16_f32 v53, 0, v53
  v_cvt_pk_bf16_f32 v54, 0, v54
  v_cvt_pk_bf16_f32 v55, 0, v55
  v_mul_f32 v52, s72, v52
  v_mul_f32 v53, s72, v53
  v_mul_f32 v54, s72, v54
  v_mul_f32 v55, s72, v55
  v_max3_f32 v24, v24, v52, v53
  v_cvt_pk_bf16_f32 v118, v52, v53
  v_max3_f32 v24, v24, v54, v55
  v_cvt_pk_bf16_f32 v119, v54, v55
  s_waitcnt vmcnt(7)
  s_cbranch_vccnz L_b381
  s_waitcnt vmcnt(6)
  s_bitcmp0_b32 s77, 31
  s_cbranch_scc1 L_b381
  s_cmp_gt_i32 s80, 93
  s_cbranch_scc0 L_n381
  s_waitcnt vmcnt(4)
L_n381:
  s_waitcnt vmcnt(5)
L_b381:
  buffer_load_dwordx4 v11, s[28:31], s65 offen offset:1024 nt lds
  s_cmp_eq_u32 s15, 1
  s_cselect_b32 s18, s16, 0x400000
  v_or_b32 v8, 93, v9
  buffer_store_dword v8, v6, s[44:47], s18 offen
  ds_read_b128 a[132:135], v12 offset:24576
  ds_read_b128 a[136:139], v13 offset:24576
  ds_read_b128 a[140:143], v14 offset:24576
  ds_read_b128 a[144:147], v15 offset:24576
  s_waitcnt vmcnt(8)
  s_cbranch_vccnz L_b382
  s_waitcnt vmcnt(7)
  s_bitcmp0_b32 s77, 31
  s_cbranch_scc1 L_b382
  s_cmp_gt_i32 s80, 93
  s_cbranch_scc0 L_n382
  s_waitcnt vmcnt(4)
L_n382:
  s_waitcnt vmcnt(6)
L_b382:
  buffer_load_dwordx4 v10, s[28:31], s65 offen offset:2048 nt lds
  s_waitcnt lgkmcnt(0)
  v_mfma_f32_16x16x32_bf16 v[52:55], a[132:135], a[16:19], 0
  v_mfma_f32_16x16x32_bf16 v[52:55], a[136:139], a[20:23], v[52:55]
  v_mfma_f32_16x16x32_bf16 v[52:55], a[140:143], a[24:27], v[52:55]
  v_mfma_f32_16x16x32_bf16 v[52:55], a[144:147], a[28:31], v[52:55]
  s_waitcnt vmcnt(8)
  s_cbranch_vccnz L_b383
  s_waitcnt vmcnt(7)
  s_bitcmp0_b32 s77, 31
  s_cbranch_scc1 L_b383
  s_cmp_gt_i32 s80, 93
  s_cbranch_scc0 L_n383
  s_waitcnt vmcnt(4)
L_n383:
  s_waitcnt vmcnt(5)
L_b383:
  buffer_load_dwordx4 v11, s[28:31], s65 offen offset:3072 nt lds
  s_nop 7
  v_cvt_pk_bf16_f32 v52, 0, v52
  v_cvt_pk_bf16_f32 v53, 0, v53
  v_cvt_pk_bf16_f32 v54, 0, v54
  v_cvt_pk_bf16_f32 v55, 0, v55
  v_mul_f32 v52, s72, v52
  v_mul_f32 v53, s72, v53
  v_mul_f32 v54, s72, v54
  v_mul_f32 v55, s72, v55
  v_max3_f32 v24, v24, v52, v53
  v_cvt_pk_bf16_f32 v120, v52, v53
  v_max3_f32 v24, v24, v54, v55
  v_cvt_pk_bf16_f32 v121, v54, v55
  s_xor_b32 s65, s64, 0x4e0000
  s_add_u32 m0, s66, 12288
  s_sub_i32 s77, s36, 95
  s_cmp_gt_i32 s14, 94
  s_cselect_b64 vcc, -1, 0
  s_waitcnt vmcnt(8)
  s_cbranch_vccnz L_b384
  s_waitcnt vmcnt(6)
  s_bitcmp0_b32 s77, 31
  s_cbranch_scc1 L_b384
  s_cmp_gt_i32 s80, 94
  s_cbranch_scc0 L_n384
  s_waitcnt vmcnt(4)
L_n384:
  s_waitcnt vmcnt(5)
L_b384:
  buffer_load_dwordx4 v10, s[28:31], s65 offen offset:0 nt lds
  ds_read_b128 a[148:151], v12 offset:0
  ds_read_b128 a[152:155], v13 offset:0
  ds_read_b128 a[156:159], v14 offset:0
  ds_read_b128 a[160:163], v15 offset:0
  s_waitcnt vmcnt(7)
  s_cbranch_vccnz L_b385
  s_waitcnt vmcnt(6)
  s_bitcmp0_b32 s77, 31
  s_cbranch_scc1 L_b385
  s_cmp_gt_i32 s80, 94
  s_cbranch_scc0 L_n385
  s_waitcnt vmcnt(4)
L_n385:
  s_waitcnt vmcnt(5)
L_b385:
  buffer_load_dwordx4 v11, s[28:31], s65 offen offset:1024 nt lds
  s_cmp_eq_u32 s15, 2
  s_cselect_b32 s18, s16, 0x400000
  v_or_b32 v8, 94, v9
  buffer_store_dword v8, v6, s[44:47], s18 offen
  s_waitcnt lgkmcnt(0)
  v_mfma_f32_16x16x32_bf16 v[52:55], a[148:151], a[16:19], 0
  v_mfma_f32_16x16x32_bf16 v[52:55], a[152:155], a[20:23], v[52:55]
  v_mfma_f32_16x16x32_bf16 v[52:55], a[156:159], a[24:27], v[52:55]
  v_mfma_f32_16x16x32_bf16 v[52:55], a[160:163], a[28:31], v[52:55]
  s_waitcnt vmcnt(8)
  s_cbranch_vccnz L_b386
  s_waitcnt vmcnt(7)
  s_bitcmp0_b32 s77, 31
  s_cbranch_scc1 L_b386
  s_cmp_gt_i32 s80, 94
  s_cbranch_scc0 L_n386
  s_waitcnt vmcnt(4)
L_n386:
  s_waitcnt vmcnt(6)
L_b386:
  buffer_load_dwordx4 v10, s[28:31], s65 offen offset:2048 nt lds
  buffer_load_dword v50, v7, s[44:47], 0 offen sc1
  s_nop 7
  v_cvt_pk_bf16_f32 v52, 0, v52
  v_cvt_pk_bf16_f32 v53, 0, v53
  v_cvt_pk_bf16_f32 v54, 0, v54
  v_cvt_pk_bf16_f32 v55, 0, v55
  v_mul_f32 v52, s72, v52
  v_mul_f32 v53, s72, v53
  v_mul_f32 v54, s72, v54
  v_mul_f32 v55, s72, v55
  v_max3_f32 v24, v24, v52, v53
  v_cvt_pk_bf16_f32 v122, v52, v53
  v_max3_f32 v24, v24, v54, v55
  v_cvt_pk_bf16_f32 v123, v54, v55
  s_waitcnt vmcnt(9)
  s_cbranch_vccnz L_b387
  s_waitcnt vmcnt(8)
  s_bitcmp0_b32 s77, 31
  s_cbranch_scc1 L_b387
  s_cmp_gt_i32 s80, 94
  s_cbranch_scc0 L_n387
  s_waitcnt vmcnt(5)
L_n387:
  s_waitcnt vmcnt(6)
L_b387:
  buffer_load_dwordx4 v11, s[28:31], s65 offen offset:3072 nt lds
  s_xor_b32 s65, s64, 0x4e4000
  s_add_u32 m0, s66, 16384
  s_sub_i32 s77, s36, 96
  s_cmp_gt_i32 s14, 95
  s_cselect_b64 vcc, -1, 0
  s_waitcnt vmcnt(9)
  s_cbranch_vccnz L_b388
  s_waitcnt vmcnt(7)
  s_bitcmp0_b32 s77, 31
  s_cbranch_scc1 L_b388
  s_cmp_gt_i32 s80, 95
  s_cbranch_scc0 L_n388
  s_waitcnt vmcnt(5)
L_n388:
  s_waitcnt vmcnt(6)
L_b388:
  buffer_load_dwordx4 v10, s[28:31], s65 offen offset:0 nt lds
  s_waitcnt vmcnt(8)
  s_cbranch_vccnz L_b389
  s_waitcnt vmcnt(7)
  s_bitcmp0_b32 s77, 31
  s_cbranch_scc1 L_b389
  s_cmp_gt_i32 s80, 95
  s_cbranch_scc0 L_n389
  s_waitcnt vmcnt(5)
L_n389:
  s_waitcnt vmcnt(6)
L_b389:
  buffer_load_dwordx4 v11, s[28:31], s65 offen offset:1024 nt lds
  s_cmp_eq_u32 s15, 3
  s_cselect_b32 s18, s16, 0x400000
  v_or_b32 v8, 95, v9
  buffer_store_dword v8, v6, s[44:47], s18 offen
  ds_read_b128 a[164:167], v12 offset:4096
  ds_read_b128 a[168:171], v13 offset:4096
  ds_read_b128 a[172:175], v14 offset:4096
  ds_read_b128 a[176:179], v15 offset:4096
  s_waitcnt vmcnt(9)
  s_cbranch_vccnz L_b390
  s_waitcnt vmcnt(8)
  s_bitcmp0_b32 s77, 31
  s_cbranch_scc1 L_b390
  s_cmp_gt_i32 s80, 95
  s_cbranch_scc0 L_n390
  s_waitcnt vmcnt(5)
L_n390:
  s_waitcnt vmcnt(7)
L_b390:
  buffer_load_dwordx4 v10, s[28:31], s65 offen offset:2048 nt lds
  s_waitcnt lgkmcnt(0)
  v_mfma_f32_16x16x32_bf16 v[52:55], a[164:167], a[16:19], 0
  v_mfma_f32_16x16x32_bf16 v[52:55], a[168:171], a[20:23], v[52:55]
  v_mfma_f32_16x16x32_bf16 v[52:55], a[172:175], a[24:27], v[52:55]
  v_mfma_f32_16x16x32_bf16 v[52:55], a[176:179], a[28:31], v[52:55]
  s_waitcnt vmcnt(9)
  s_cbranch_vccnz L_b391
  s_waitcnt vmcnt(8)
  s_bitcmp0_b32 s77, 31
  s_cbranch_scc1 L_b391
  s_cmp_gt_i32 s80, 95
  s_cbranch_scc0 L_n391
  s_waitcnt vmcnt(4)
L_n391:
  s_waitcnt vmcnt(6)
L_b391:
  buffer_load_dwordx4 v11, s[28:31], s65 offen offset:3072 nt lds
  s_nop 7
  v_cvt_pk_bf16_f32 v52, 0, v52
  v_cvt_pk_bf16_f32 v53, 0, v53
  v_cvt_pk_bf16_f32 v54, 0, v54
  v_cvt_pk_bf16_f32 v55, 0, v55
  v_mul_f32 v52, s72, v52
  v_mul_f32 v53, s72, v53
  v_mul_f32 v54, s72, v54
  v_mul_f32 v55, s72, v55
  v_max3_f32 v24, v24, v52, v53
  v_cvt_pk_bf16_f32 v124, v52, v53
  v_max3_f32 v24, v24, v54, v55
  v_cvt_pk_bf16_f32 v125, v54, v55
  s_xor_b32 s65, s64, 0x0
  s_add_u32 m0, s66, 20480
  s_sub_i32 s77, s36, 97
  s_cmp_gt_i32 s14, 96
  s_cselect_b64 vcc, -1, 0
  s_waitcnt vmcnt(9)
  s_cbranch_vccnz L_b392
  s_waitcnt vmcnt(7)
  s_bitcmp0_b32 s77, 31
  s_cbranch_scc1 L_b392
  s_cmp_gt_i32 s80, 96
  s_cbranch_scc0 L_n392
  s_waitcnt vmcnt(4)
L_n392:
  s_waitcnt vmcnt(5)
L_b392:
  buffer_load_dwordx4 v10, s[32:35], s65 offen offset:0 nt lds
  s_waitcnt vmcnt(8)
  s_cbranch_vccnz L_b393
  s_waitcnt vmcnt(6)
  s_bitcmp0_b32 s77, 31
  s_cbranch_scc1 L_b393
  s_cmp_gt_i32 s80, 96
  s_cbranch_scc0 L_n393
  s_waitcnt vmcnt(4)
L_n393:
  s_waitcnt vmcnt(5)
L_b393:
  buffer_load_dwordx4 v11, s[32:35], s65 offen offset:1024 nt lds
  s_cmp_eq_u32 s15, 0
  s_cselect_b32 s18, s16, 0x400000
  v_or_b32 v8, 96, v9
  buffer_store_dword v8, v6, s[44:47], s18 offen
  ds_read_b128 a[180:183], v12 offset:8192
  ds_read_b128 a[184:187], v13 offset:8192
  ds_read_b128 a[188:191], v14 offset:8192
  ds_read_b128 a[192:195], v15 offset:8192
  s_waitcnt vmcnt(8)
  s_cbranch_vccnz L_b394
  s_waitcnt vmcnt(7)
  s_bitcmp0_b32 s77, 31
  s_cbranch_scc1 L_b394
  s_cmp_gt_i32 s80, 96
  s_cbranch_scc0 L_n394
  s_waitcnt vmcnt(4)
L_n394:
  s_waitcnt vmcnt(6)
L_b394:
  buffer_load_dwordx4 v10, s[32:35], s65 offen offset:2048 nt lds
  v_xor_b32 v50, s17, v50
  v_lshrrev_b32 v51, 8, v50
  v_readlane_b32 s100, v50, 36
  s_cmp_lt_u32 s100, 256
  s_cselect_b32 s100, s100, 128
  s_add_i32 s36, s100, -31
  s_sub_i32 s3, 122, s100
  s_ashr_i32 s3, s3, 2
  s_add_i32 s3, s3, 97
  v_cmp_eq_u32 s[82:83], 0, v51
  v_mov_b32 v51, 92
  s_nop 0
  v_cndmask_b32 v50, v51, v50, s[82:83]
  s_nop 1
  v_add_u32_dpp v50, v50, v50 row_ror:1 row_mask:0xf bank_mask:0xf
  s_nop 1
  v_add_u32_dpp v50, v50, v50 row_ror:2 row_mask:0xf bank_mask:0xf
  s_nop 1
  v_add_u32_dpp v50, v50, v50 row_ror:4 row_mask:0xf bank_mask:0xf
  s_nop 1
  v_add_u32_dpp v50, v50, v50 row_ror:8 row_mask:0xf bank_mask:0xf
  s_nop 0
  v_readlane_b32 s100, v50, 0
  v_readlane_b32 s101, v50, 16
  s_add_u32 s100, s100, s101
  s_sub_i32 s100, s100, 2947
  s_ashr_i32 s37, s100, 1
  s_add_i32 s101, s100, 32
  s_mul_i32 s101, s101, -20
  s_ashr_i32 s101, s101, 8
  s_min_i32 s101, s101, 4
  s_add_i32 s80, s101, 97
  s_max_i32 s80, s80, s3
  s_mul_i32 s100, s100, 24
  s_ashr_i32 s100, s100, 8
  s_min_i32 s100, s100, 8
  s_add_i32 s14, s100, 97
  s_waitcnt lgkmcnt(0)
  v_mfma_f32_16x16x32_bf16 v[52:55], a[180:183], a[16:19], 0
  v_mfma_f32_16x16x32_bf16 v[52:55], a[184:187], a[20:23], v[52:55]
  v_mfma_f32_16x16x32_bf16 v[52:55], a[188:191], a[24:27], v[52:55]
  v_mfma_f32_16x16x32_bf16 v[52:55], a[192:195], a[28:31], v[52:55]
  s_waitcnt vmcnt(8)
  s_cbranch_vccnz L_b395
  s_waitcnt vmcnt(7)
  s_bitcmp0_b32 s77, 31
  s_cbranch_scc1 L_b395
  s_cmp_gt_i32 s80, 96
  s_cbranch_scc0 L_n395
  s_waitcnt vmcnt(4)
L_n395:
  s_waitcnt vmcnt(5)
L_b395:
  buffer_load_dwordx4 v11, s[32:35], s65 offen offset:3072 nt lds
  s_nop 7
  v_cvt_pk_bf16_f32 v52, 0, v52
  v_cvt_pk_bf16_f32 v53, 0, v53
  v_cvt_pk_bf16_f32 v54, 0, v54
  v_cvt_pk_bf16_f32 v55, 0, v55
  v_mul_f32 v52, s72, v52
  v_mul_f32 v53, s72, v53
  v_mul_f32 v54, s72, v54
  v_mul_f32 v55, s72, v55
  v_max3_f32 v24, v24, v52, v53
  v_cvt_pk_bf16_f32 v126, v52, v53
  v_max3_f32 v24, v24, v54, v55
  v_cvt_pk_bf16_f32 v127, v54, v55
  s_xor_b32 s65, s64, 0x4000
  s_add_u32 m0, s66, 24576
  s_sub_i32 s77, s36, 98
  s_cmp_gt_i32 s14, 97
  s_cselect_b64 vcc, -1, 0
  s_waitcnt vmcnt(8)
  s_cbranch_vccnz L_b396
  s_waitcnt vmcnt(6)
  s_bitcmp0_b32 s77, 31
  s_cbranch_scc1 L_b396
  s_cmp_gt_i32 s80, 97
  s_cbranch_scc0 L_n396
  s_waitcnt vmcnt(4)
L_n396:
  s_waitcnt vmcnt(5)
L_b396:
  buffer_load_dwordx4 v10, s[32:35], s65 offen offset:0 nt lds
  ds_read_b128 a[196:199], v12 offset:12288
  ds_read_b128 a[200:203], v13 offset:12288
  ds_read_b128 a[204:207], v14 offset:12288
  ds_read_b128 a[208:211], v15 offset:12288
  s_waitcnt vmcnt(7)
  s_cbranch_vccnz L_b397
  s_waitcnt vmcnt(6)
  s_bitcmp0_b32 s77, 31
  s_cbranch_scc1 L_b397
  s_cmp_gt_i32 s80, 97
  s_cbranch_scc0 L_n397
  s_waitcnt vmcnt(4)
L_n397:
  s_waitcnt vmcnt(5)
L_b397:
  buffer_load_dwordx4 v11, s[32:35], s65 offen offset:1024 nt lds
  s_cmp_eq_u32 s15, 1
  s_cselect_b32 s18, s16, 0x400000
  v_or_b32 v8, 97, v9
  buffer_store_dword v8, v6, s[44:47], s18 offen
  s_waitcnt lgkmcnt(0)
  v_mfma_f32_16x16x32_bf16 v[52:55], a[196:199], a[16:19], 0
  v_mfma_f32_16x16x32_bf16 v[52:55], a[200:203], a[20:23], v[52:55]
  v_mfma_f32_16x16x32_bf16 v[52:55], a[204:207], a[24:27], v[52:55]
  v_mfma_f32_16x16x32_bf16 v[52:55], a[208:211], a[28:31], v[52:55]
  s_waitcnt vmcnt(8)
  s_cbranch_vccnz L_b398
  s_waitcnt vmcnt(7)
  s_bitcmp0_b32 s77, 31
  s_cbranch_scc1 L_b398
  s_cmp_gt_i32 s80, 97
  s_cbranch_scc0 L_n398
  s_waitcnt vmcnt(4)
L_n398:
  s_waitcnt vmcnt(6)
L_b398:
  buffer_load_dwordx4 v10, s[32:35], s65 offen offset:2048 nt lds
  s_nop 7
  v_cvt_pk_bf16_f32 v52, 0, v52
  v_cvt_pk_bf16_f32 v53, 0, v53
  v_cvt_pk_bf16_f32 v54, 0, v54
  v_cvt_pk_bf16_f32 v55, 0, v55
  v_mul_f32 v52, s72, v52
  v_mul_f32 v53, s72, v53
  v_mul_f32 v54, s72, v54
  v_mul_f32 v55, s72, v55
  v_max3_f32 v24, v24, v52, v53
  v_cvt_pk_bf16_f32 v128, v52, v53
  v_max3_f32 v24, v24, v54, v55
  v_cvt_pk_bf16_f32 v129, v54, v55
  s_waitcnt vmcnt(8)
  s_cbranch_vccnz L_b399
  s_waitcnt vmcnt(7)
  s_bitcmp0_b32 s77, 31
  s_cbranch_scc1 L_b399
  s_cmp_gt_i32 s80, 97
  s_cbranch_scc0 L_n399
  s_waitcnt vmcnt(4)
L_n399:
  s_waitcnt vmcnt(5)
L_b399:
  buffer_load_dwordx4 v11, s[32:35], s65 offen offset:3072 nt lds
  s_xor_b32 s65, s64, 0x400000
  s_add_u32 m0, s66, 0
  s_sub_i32 s77, s36, 99
  s_cmp_gt_i32 s14, 98
  s_cselect_b64 vcc, -1, 0
  s_waitcnt vmcnt(8)
  s_cbranch_vccnz L_b400
  s_waitcnt vmcnt(6)
  s_bitcmp0_b32 s77, 31
  s_cbranch_scc1 L_b400
  s_cmp_gt_i32 s80, 98
  s_cbranch_scc0 L_n400
  s_waitcnt vmcnt(4)
L_n400:
  s_waitcnt vmcnt(5)
L_b400:
  buffer_load_dwordx4 v10, s[32:35], s65 offen offset:0 nt lds
  ds_read_b128 a[132:135], v12 offset:16384
  ds_read_b128 a[136:139], v13 offset:16384
  ds_read_b128 a[140:143], v14 offset:16384
  ds_read_b128 a[144:147], v15 offset:16384
  s_waitcnt vmcnt(7)
  s_cbranch_vccnz L_b401
  s_waitcnt vmcnt(6)
  s_bitcmp0_b32 s77, 31
  s_cbranch_scc1 L_b401
  s_cmp_gt_i32 s80, 98
  s_cbranch_scc0 L_n401
  s_waitcnt vmcnt(4)
L_n401:
  s_waitcnt vmcnt(5)
L_b401:
  buffer_load_dwordx4 v11, s[32:35], s65 offen offset:1024 nt lds
  s_cmp_eq_u32 s15, 2
  s_cselect_b32 s18, s16, 0x400000
  v_or_b32 v8, 98, v9
  buffer_store_dword v8, v6, s[44:47], s18 offen
  s_waitcnt lgkmcnt(0)
  v_mfma_f32_16x16x32_bf16 v[52:55], a[132:135], a[16:19], 0
  v_mfma_f32_16x16x32_bf16 v[52:55], a[136:139], a[20:23], v[52:55]
  v_mfma_f32_16x16x32_bf16 v[52:55], a[140:143], a[24:27], v[52:55]
  v_mfma_f32_16x16x32_bf16 v[52:55], a[144:147], a[28:31], v[52:55]
  s_waitcnt vmcnt(8)
  s_cbranch_vccnz L_b402
  s_waitcnt vmcnt(7)
  s_bitcmp0_b32 s77, 31
  s_cbranch_scc1 L_b402
  s_cmp_gt_i32 s80, 98
  s_cbranch_scc0 L_n402
  s_waitcnt vmcnt(4)
L_n402:
  s_waitcnt vmcnt(6)
L_b402:
  buffer_load_dwordx4 v10, s[32:35], s65 offen offset:2048 nt lds
  buffer_load_dword v50, v7, s[44:47], 0 offen sc1
  s_nop 7
  v_cvt_pk_bf16_f32 v52, 0, v52
  v_cvt_pk_bf16_f32 v53, 0, v53
  v_cvt_pk_bf16_f32 v54, 0, v54
  v_cvt_pk_bf16_f32 v55, 0, v55
  v_mul_f32 v52, s72, v52
  v_mul_f32 v53, s72, v53
  v_mul_f32 v54, s72, v54
  v_mul_f32 v55, s72, v55
  v_max3_f32 v24, v24, v52, v53
  v_cvt_pk_bf16_f32 v130, v52, v53
  v_max3_f32 v24, v24, v54, v55
  v_cvt_pk_bf16_f32 v131, v54, v55
  s_waitcnt vmcnt(9)
  s_cbranch_vccnz L_b403
  s_waitcnt vmcnt(8)
  s_bitcmp0_b32 s77, 31
  s_cbranch_scc1 L_b403
  s_cmp_gt_i32 s80, 98
  s_cbranch_scc0 L_n403
  s_waitcnt vmcnt(5)
L_n403:
  s_waitcnt vmcnt(6)
L_b403:
  buffer_load_dwordx4 v11, s[32:35], s65 offen offset:3072 nt lds
  v_mov_b32 v28, v24
  s_nop 1
  v_permlane32_swap_b32 v24, v28
  v_max_f32 v24, v24, v28
  v_mov_b32 v28, v24
  s_nop 1
  v_permlane16_swap_b32 v24, v28
  v_max_f32 v24, v24, v28
  v_cvt_pk_bf16_f32 v25, 0, v24
  v_mul_f32 v26, 0xbfb8aa3b, v25
  s_xor_b32 s65, s64, 0x404000
  s_add_u32 m0, s66, 4096
  s_sub_i32 s77, s36, 100
  s_cmp_gt_i32 s14, 99
  s_cselect_b64 vcc, -1, 0
  s_waitcnt vmcnt(9)
  s_cbranch_vccnz L_b404
  s_waitcnt vmcnt(7)
  s_bitcmp0_b32 s77, 31
  s_cbranch_scc1 L_b404
  s_cmp_gt_i32 s80, 99
  s_cbranch_scc0 L_n404
  s_waitcnt vmcnt(5)
L_n404:
  s_waitcnt vmcnt(6)
L_b404:
  buffer_load_dwordx4 v10, s[32:35], s65 offen offset:0 nt lds
  v_lshlrev_b32 v52, 16, v68
  v_and_b32 v53, 0xffff0000, v68
  v_lshlrev_b32 v54, 16, v69
  v_and_b32 v55, 0xffff0000, v69
  v_fma_f32 v52, v52, s71, v26
  v_fma_f32 v53, v53, s71, v26
  v_fma_f32 v54, v54, s71, v26
  v_fma_f32 v55, v55, s71, v26
  v_exp_f32 v52, v52
  v_exp_f32 v53, v53
  v_exp_f32 v54, v54
  v_exp_f32 v55, v55
  v_cvt_pk_bf16_f32 v68, v52, v53
  v_cvt_pk_bf16_f32 v69, v54, v55
  s_waitcnt vmcnt(8)
  s_cbranch_vccnz L_b405
  s_waitcnt vmcnt(7)
  s_bitcmp0_b32 s77, 31
  s_cbranch_scc1 L_b405
  s_cmp_gt_i32 s80, 99
  s_cbranch_scc0 L_n405
  s_waitcnt vmcnt(5)
L_n405:
  s_waitcnt vmcnt(6)
L_b405:
  buffer_load_dwordx4 v11, s[32:35], s65 offen offset:1024 nt lds
  s_cmp_eq_u32 s15, 3
  s_cselect_b32 s18, s16, 0x400000
  v_or_b32 v8, 99, v9
  buffer_store_dword v8, v6, s[44:47], s18 offen
  v_lshlrev_b32 v52, 16, v70
  v_and_b32 v53, 0xffff0000, v70
  v_lshlrev_b32 v54, 16, v71
  v_and_b32 v55, 0xffff0000, v71
  v_fma_f32 v52, v52, s71, v26
  v_fma_f32 v53, v53, s71, v26
  v_fma_f32 v54, v54, s71, v26
  v_fma_f32 v55, v55, s71, v26
  v_exp_f32 v52, v52
  v_exp_f32 v53, v53
  v_exp_f32 v54, v54
  v_exp_f32 v55, v55
  v_cvt_pk_bf16_f32 v70, v52, v53
  v_cvt_pk_bf16_f32 v71, v54, v55
  s_nop 1
  v_mfma_f32_16x16x32_bf16 a[128:131], v[56:59], v[68:71], 0
  ds_read_b64_tr_b16 a[32:33], v16 offset:20480
  ds_read_b64_tr_b16 a[36:37], v17 offset:20480
  ds_read_b64_tr_b16 a[40:41], v18 offset:20480
  ds_read_b64_tr_b16 a[44:45], v19 offset:20480
  ds_read_b64_tr_b16 a[48:49], v20 offset:20480
  ds_read_b64_tr_b16 a[52:53], v21 offset:20480
  ds_read_b64_tr_b16 a[56:57], v22 offset:20480
  ds_read_b64_tr_b16 a[60:61], v23 offset:20480
  s_waitcnt vmcnt(9)
  s_cbranch_vccnz L_b406
  s_waitcnt vmcnt(8)
  s_bitcmp0_b32 s77, 31
  s_cbranch_scc1 L_b406
  s_cmp_gt_i32 s80, 99
  s_cbranch_scc0 L_n406
  s_waitcnt vmcnt(5)
L_n406:
  s_waitcnt vmcnt(7)
L_b406:
  buffer_load_dwordx4 v10, s[32:35], s65 offen offset:2048 nt lds
  v_lshlrev_b32 v52, 16, v72
  v_and_b32 v53, 0xffff0000, v72
  v_lshlrev_b32 v54, 16, v73
  v_and_b32 v55, 0xffff0000, v73
  v_fma_f32 v52, v52, s71, v26
  v_fma_f32 v53, v53, s71, v26
  v_fma_f32 v54, v54, s71, v26
  v_fma_f32 v55, v55, s71, v26
  v_exp_f32 v52, v52
  v_exp_f32 v53, v53
  v_exp_f32 v54, v54
  v_exp_f32 v55, v55
  v_cvt_pk_bf16_f32 v72, v52, v53
  v_cvt_pk_bf16_f32 v73, v54, v55
  s_waitcnt vmcnt(9)
  s_cbranch_vccnz L_b407
  s_waitcnt vmcnt(8)
  s_bitcmp0_b32 s77, 31
  s_cbranch_scc1 L_b407
  s_cmp_gt_i32 s80, 99
  s_cbranch_scc0 L_n407
  s_waitcnt vmcnt(4)
L_n407:
  s_waitcnt vmcnt(6)
L_b407:
  buffer_load_dwordx4 v11, s[32:35], s65 offen offset:3072 nt lds
  s_mov_b32 s18, 168960
  buffer_load_dword v184, v182, s[44:47], s18 offen sc1
  v_lshlrev_b32 v52, 16, v74
  v_and_b32 v53, 0xffff0000, v74
  v_lshlrev_b32 v54, 16, v75
  v_and_b32 v55, 0xffff0000, v75
  v_fma_f32 v52, v52, s71, v26
  v_fma_f32 v53, v53, s71, v26
  v_fma_f32 v54, v54, s71, v26
  v_fma_f32 v55, v55, s71, v26
  v_exp_f32 v52, v52
  v_exp_f32 v53, v53
  v_exp_f32 v54, v54
  v_exp_f32 v55, v55
  v_cvt_pk_bf16_f32 v74, v52, v53
  v_cvt_pk_bf16_f32 v75, v54, v55
  s_nop 1
  v_mfma_f32_16x16x32_bf16 a[128:131], v[56:59], v[72:75], a[128:131]
  s_xor_b32 s65, s64, 0x20000
  s_add_u32 m0, s66, 8192
  s_sub_i32 s77, s36, 101
  s_cmp_gt_i32 s14, 100
  s_cselect_b64 vcc, -1, 0
  s_waitcnt vmcnt(10)
  s_cbranch_vccnz L_b408
  s_waitcnt vmcnt(8)
  s_bitcmp0_b32 s77, 31
  s_cbranch_scc1 L_b408
  s_cmp_gt_i32 s80, 100
  s_cbranch_scc0 L_n408
  s_waitcnt vmcnt(5)
L_n408:
  s_waitcnt vmcnt(6)
L_b408:
  buffer_load_dwordx4 v10, s[32:35], s65 offen offset:0 nt lds
  v_lshlrev_b32 v52, 16, v76
  v_and_b32 v53, 0xffff0000, v76
  v_lshlrev_b32 v54, 16, v77
  v_and_b32 v55, 0xffff0000, v77
  v_fma_f32 v52, v52, s71, v26
  v_fma_f32 v53, v53, s71, v26
  v_fma_f32 v54, v54, s71, v26
  v_fma_f32 v55, v55, s71, v26
  v_exp_f32 v52, v52
  v_exp_f32 v53, v53
  v_exp_f32 v54, v54
  v_exp_f32 v55, v55
  v_cvt_pk_bf16_f32 v76, v52, v53
  v_cvt_pk_bf16_f32 v77, v54, v55
  s_waitcnt vmcnt(9)
  s_cbranch_vccnz L_b409
  s_waitcnt vmcnt(7)
  s_bitcmp0_b32 s77, 31
  s_cbranch_scc1 L_b409
  s_cmp_gt_i32 s80, 100
  s_cbranch_scc0 L_n409
  s_waitcnt vmcnt(5)
L_n409:
  s_waitcnt vmcnt(6)
L_b409:
  buffer_load_dwordx4 v11, s[32:35], s65 offen offset:1024 nt lds
  s_cmp_eq_u32 s15, 0
  s_cselect_b32 s18, s16, 0x400000
  v_or_b32 v8, 100, v9
  buffer_store_dword v8, v6, s[44:47], s18 offen
  v_lshlrev_b32 v52, 16, v78
  v_and_b32 v53, 0xffff0000, v78
  v_lshlrev_b32 v54, 16, v79
  v_and_b32 v55, 0xffff0000, v79
  v_fma_f32 v52, v52, s71, v26
  v_fma_f32 v53, v53, s71, v26
  v_fma_f32 v54, v54, s71, v26
  v_fma_f32 v55, v55, s71, v26
  v_exp_f32 v52, v52
  v_exp_f32 v53, v53
  v_exp_f32 v54, v54
  v_exp_f32 v55, v55
  v_cvt_pk_bf16_f32 v78, v52, v53
  v_cvt_pk_bf16_f32 v79, v54, v55
  s_nop 1
  v_mfma_f32_16x16x32_bf16 a[128:131], v[56:59], v[76:79], a[128:131]
  ds_read_b64_tr_b16 a[34:35], v16 offset:24576
  ds_read_b64_tr_b16 a[38:39], v17 offset:24576
  ds_read_b64_tr_b16 a[42:43], v18 offset:24576
  ds_read_b64_tr_b16 a[46:47], v19 offset:24576
  ds_read_b64_tr_b16 a[50:51], v20 offset:24576
  ds_read_b64_tr_b16 a[54:55], v21 offset:24576
  ds_read_b64_tr_b16 a[58:59], v22 offset:24576
  ds_read_b64_tr_b16 a[62:63], v23 offset:24576
  s_waitcnt vmcnt(9)
  s_cbranch_vccnz L_b410
  s_waitcnt vmcnt(8)
  s_bitcmp0_b32 s77, 31
  s_cbranch_scc1 L_b410
  s_cmp_gt_i32 s80, 100
  s_cbranch_scc0 L_n410
  s_waitcnt vmcnt(5)
L_n410:
  s_waitcnt vmcnt(7)
L_b410:
  buffer_load_dwordx4 v10, s[32:35], s65 offen offset:2048 nt lds
  v_xor_b32 v50, s17, v50
  v_lshrrev_b32 v51, 8, v50
  v_cmp_eq_u32 s[82:83], 0, v51
  v_mov_b32 v51, 96
  s_nop 0
  v_cndmask_b32 v50, v51, v50, s[82:83]
  s_nop 1
  v_add_u32_dpp v50, v50, v50 row_ror:1 row_mask:0xf bank_mask:0xf
  s_nop 1
  v_add_u32_dpp v50, v50, v50 row_ror:2 row_mask:0xf bank_mask:0xf
  s_nop 1
  v_add_u32_dpp v50, v50, v50 row_ror:4 row_mask:0xf bank_mask:0xf
  s_nop 1
  v_add_u32_dpp v50, v50, v50 row_ror:8 row_mask:0xf bank_mask:0xf
  s_nop 0
  v_readlane_b32 s100, v50, 0
  v_readlane_b32 s101, v50, 16
  s_add_u32 s100, s100, s101
  s_sub_i32 s100, s100, 3075
  s_ashr_i32 s37, s100, 1
  s_add_i32 s101, s100, 32
  s_mul_i32 s101, s101, -20
  s_ashr_i32 s101, s101, 8
  s_min_i32 s101, s101, 4
  s_add_i32 s80, s101, 101
  s_max_i32 s80, s80, s3
  s_mul_i32 s100, s100, 24
  s_ashr_i32 s100, s100, 8
  s_min_i32 s100, s100, 8
  s_add_i32 s14, s100, 101
  v_lshlrev_b32 v52, 16, v80
  v_and_b32 v53, 0xffff0000, v80
  v_lshlrev_b32 v54, 16, v81
  v_and_b32 v55, 0xffff0000, v81
  v_fma_f32 v52, v52, s71, v26
  v_fma_f32 v53, v53, s71, v26
  v_fma_f32 v54, v54, s71, v26
  v_fma_f32 v55, v55, s71, v26
  v_exp_f32 v52, v52
  v_exp_f32 v53, v53
  v_exp_f32 v54, v54
  v_exp_f32 v55, v55
  v_cvt_pk_bf16_f32 v80, v52, v53
  v_cvt_pk_bf16_f32 v81, v54, v55
  s_waitcnt lgkmcnt(0)
  v_mfma_f32_16x16x32_bf16 a[96:99], a[32:35], v[68:71], 0
  v_mfma_f32_16x16x32_bf16 a[100:103], a[36:39], v[68:71], 0
  v_mfma_f32_16x16x32_bf16 a[104:107], a[40:43], v[68:71], 0
  v_mfma_f32_16x16x32_bf16 a[108:111], a[44:47], v[68:71], 0
  s_waitcnt vmcnt(9)
  s_cbranch_vccnz L_b411
  s_waitcnt vmcnt(8)
  s_bitcmp0_b32 s77, 31
  s_cbranch_scc1 L_b411
  s_cmp_gt_i32 s80, 100
  s_cbranch_scc0 L_n411
  s_waitcnt vmcnt(5)
L_n411:
  s_waitcnt vmcnt(6)
L_b411:
  buffer_load_dwordx4 v11, s[32:35], s65 offen offset:3072 nt lds
  s_mov_b32 s18, 168960
  buffer_load_dword v185, v182, s[44:47], s18 offen sc1
  v_lshlrev_b32 v52, 16, v82
  v_and_b32 v53, 0xffff0000, v82
  v_lshlrev_b32 v54, 16, v83
  v_and_b32 v55, 0xffff0000, v83
  v_fma_f32 v52, v52, s71, v26
  v_fma_f32 v53, v53, s71, v26
  v_fma_f32 v54, v54, s71, v26
  v_fma_f32 v55, v55, s71, v26
  v_exp_f32 v52, v52
  v_exp_f32 v53, v53
  v_exp_f32 v54, v54
  v_exp_f32 v55, v55
  v_cvt_pk_bf16_f32 v82, v52, v53
  v_cvt_pk_bf16_f32 v83, v54, v55
  s_nop 1
  v_mfma_f32_16x16x32_bf16 a[128:131], v[56:59], v[80:83], a[128:131]
  v_mfma_f32_16x16x32_bf16 a[112:115], a[48:51], v[68:71], 0
  v_mfma_f32_16x16x32_bf16 a[116:119], a[52:55], v[68:71], 0
  v_mfma_f32_16x16x32_bf16 a[120:123], a[56:59], v[68:71], 0
  v_mfma_f32_16x16x32_bf16 a[124:127], a[60:63], v[68:71], 0
  s_xor_b32 s65, s64, 0x24000
  s_add_u32 m0, s66, 12288
  s_sub_i32 s77, s36, 102
  s_cmp_gt_i32 s14, 101
  s_cselect_b64 vcc, -1, 0
  s_waitcnt vmcnt(10)
  s_cbranch_vccnz L_b412
  s_waitcnt vmcnt(8)
  s_bitcmp0_b32 s77, 31
  s_cbranch_scc1 L_b412
  s_cmp_gt_i32 s80, 101
  s_cbranch_scc0 L_n412
  s_waitcnt vmcnt(5)
L_n412:
  s_waitcnt vmcnt(7)
L_b412:
  buffer_load_dwordx4 v10, s[32:35], s65 offen offset:0 nt lds
  v_lshlrev_b32 v52, 16, v84
  v_and_b32 v53, 0xffff0000, v84
  v_lshlrev_b32 v54, 16, v85
  v_and_b32 v55, 0xffff0000, v85
  v_fma_f32 v52, v52, s71, v26
  v_fma_f32 v53, v53, s71, v26
  v_fma_f32 v54, v54, s71, v26
  v_fma_f32 v55, v55, s71, v26
  v_exp_f32 v52, v52
  v_exp_f32 v53, v53
  v_exp_f32 v54, v54
  v_exp_f32 v55, v55
  v_cvt_pk_bf16_f32 v84, v52, v53
  v_cvt_pk_bf16_f32 v85, v54, v55
  s_waitcnt vmcnt(9)
  s_cbranch_vccnz L_b413
  s_waitcnt vmcnt(8)
  s_bitcmp0_b32 s77, 31
  s_cbranch_scc1 L_b413
  s_cmp_gt_i32 s80, 101
  s_cbranch_scc0 L_n413
  s_waitcnt vmcnt(5)
L_n413:
  s_waitcnt vmcnt(6)
L_b413:
  buffer_load_dwordx4 v11, s[32:35], s65 offen offset:1024 nt lds
  s_cmp_eq_u32 s15, 1
  s_cselect_b32 s18, s16, 0x400000
  v_or_b32 v8, 101, v9
  buffer_store_dword v8, v6, s[44:47], s18 offen
  v_lshlrev_b32 v52, 16, v86
  v_and_b32 v53, 0xffff0000, v86
  v_lshlrev_b32 v54, 16, v87
  v_and_b32 v55, 0xffff0000, v87
  v_fma_f32 v52, v52, s71, v26
  v_fma_f32 v53, v53, s71, v26
  v_fma_f32 v54, v54, s71, v26
  v_fma_f32 v55, v55, s71, v26
  v_exp_f32 v52, v52
  v_exp_f32 v53, v53
  v_exp_f32 v54, v54
  v_exp_f32 v55, v55
  v_cvt_pk_bf16_f32 v86, v52, v53
  v_cvt_pk_bf16_f32 v87, v54, v55
  s_nop 1
  v_mfma_f32_16x16x32_bf16 a[128:131], v[56:59], v[84:87], a[128:131]
  ds_read_b64_tr_b16 a[32:33], v16 offset:0
  ds_read_b64_tr_b16 a[36:37], v17 offset:0
  ds_read_b64_tr_b16 a[40:41], v18 offset:0
  ds_read_b64_tr_b16 a[44:45], v19 offset:0
  ds_read_b64_tr_b16 a[48:49], v20 offset:0
  ds_read_b64_tr_b16 a[52:53], v21 offset:0
  ds_read_b64_tr_b16 a[56:57], v22 offset:0
  ds_read_b64_tr_b16 a[60:61], v23 offset:0
  s_waitcnt vmcnt(10)
  s_cbranch_vccnz L_b414
  s_waitcnt vmcnt(8)
  s_bitcmp0_b32 s77, 31
  s_cbranch_scc1 L_b414
  s_cmp_gt_i32 s80, 101
  s_cbranch_scc0 L_n414
  s_waitcnt vmcnt(5)
L_n414:
  s_waitcnt vmcnt(7)
L_b414:
  buffer_load_dwordx4 v10, s[32:35], s65 offen offset:2048 nt lds
  v_lshlrev_b32 v52, 16, v88
  v_and_b32 v53, 0xffff0000, v88
  v_lshlrev_b32 v54, 16, v89
  v_and_b32 v55, 0xffff0000, v89
  v_fma_f32 v52, v52, s71, v26
  v_fma_f32 v53, v53, s71, v26
  v_fma_f32 v54, v54, s71, v26
  v_fma_f32 v55, v55, s71, v26
  v_exp_f32 v52, v52
  v_exp_f32 v53, v53
  v_exp_f32 v54, v54
  v_exp_f32 v55, v55
  v_cvt_pk_bf16_f32 v88, v52, v53
  v_cvt_pk_bf16_f32 v89, v54, v55
  s_waitcnt vmcnt(9)
  s_cbranch_vccnz L_b415
  s_waitcnt vmcnt(8)
  s_bitcmp0_b32 s77, 31
  s_cbranch_scc1 L_b415
  s_cmp_gt_i32 s80, 101
  s_cbranch_scc0 L_n415
  s_waitcnt vmcnt(5)
L_n415:
  s_waitcnt vmcnt(6)
L_b415:
  buffer_load_dwordx4 v11, s[32:35], s65 offen offset:3072 nt lds
  s_mov_b32 s18, 168960
  buffer_load_dword v186, v182, s[44:47], s18 offen sc1
  v_lshlrev_b32 v52, 16, v90
  v_and_b32 v53, 0xffff0000, v90
  v_lshlrev_b32 v54, 16, v91
  v_and_b32 v55, 0xffff0000, v91
  v_fma_f32 v52, v52, s71, v26
  v_fma_f32 v53, v53, s71, v26
  v_fma_f32 v54, v54, s71, v26
  v_fma_f32 v55, v55, s71, v26
  v_exp_f32 v52, v52
  v_exp_f32 v53, v53
  v_exp_f32 v54, v54
  v_exp_f32 v55, v55
  v_cvt_pk_bf16_f32 v90, v52, v53
  v_cvt_pk_bf16_f32 v91, v54, v55
  s_nop 1
  v_mfma_f32_16x16x32_bf16 a[128:131], v[56:59], v[88:91], a[128:131]
  s_xor_b32 s65, s64, 0x420000
  s_add_u32 m0, s66, 16384
  s_sub_i32 s77, s36, 103
  s_cmp_gt_i32 s14, 102
  s_cselect_b64 vcc, -1, 0
  s_waitcnt vmcnt(10)
  s_cbranch_vccnz L_b416
  s_waitcnt vmcnt(8)
  s_bitcmp0_b32 s77, 31
  s_cbranch_scc1 L_b416
  s_cmp_gt_i32 s80, 102
  s_cbranch_scc0 L_n416
  s_waitcnt vmcnt(5)
L_n416:
  s_waitcnt vmcnt(7)
L_b416:
  buffer_load_dwordx4 v10, s[32:35], s65 offen offset:0 nt lds
  v_lshlrev_b32 v52, 16, v92
  v_and_b32 v53, 0xffff0000, v92
  v_lshlrev_b32 v54, 16, v93
  v_and_b32 v55, 0xffff0000, v93
  v_fma_f32 v52, v52, s71, v26
  v_fma_f32 v53, v53, s71, v26
  v_fma_f32 v54, v54, s71, v26
  v_fma_f32 v55, v55, s71, v26
  v_exp_f32 v52, v52
  v_exp_f32 v53, v53
  v_exp_f32 v54, v54
  v_exp_f32 v55, v55
  v_cvt_pk_bf16_f32 v92, v52, v53
  v_cvt_pk_bf16_f32 v93, v54, v55
  s_waitcnt vmcnt(9)
  s_cbranch_vccnz L_b417
  s_waitcnt vmcnt(8)
  s_bitcmp0_b32 s77, 31
  s_cbranch_scc1 L_b417
  s_cmp_gt_i32 s80, 102
  s_cbranch_scc0 L_n417
  s_waitcnt vmcnt(5)
L_n417:
  s_waitcnt vmcnt(6)
L_b417:
  buffer_load_dwordx4 v11, s[32:35], s65 offen offset:1024 nt lds
  s_cmp_eq_u32 s15, 2
  s_cselect_b32 s18, s16, 0x400000
  v_or_b32 v8, 102, v9
  buffer_store_dword v8, v6, s[44:47], s18 offen
  v_lshlrev_b32 v52, 16, v94
  v_and_b32 v53, 0xffff0000, v94
  v_lshlrev_b32 v54, 16, v95
  v_and_b32 v55, 0xffff0000, v95
  v_fma_f32 v52, v52, s71, v26
  v_fma_f32 v53, v53, s71, v26
  v_fma_f32 v54, v54, s71, v26
  v_fma_f32 v55, v55, s71, v26
  v_exp_f32 v52, v52
  v_exp_f32 v53, v53
  v_exp_f32 v54, v54
  v_exp_f32 v55, v55
  v_cvt_pk_bf16_f32 v94, v52, v53
  v_cvt_pk_bf16_f32 v95, v54, v55
  s_nop 1
  v_mfma_f32_16x16x32_bf16 a[128:131], v[56:59], v[92:95], a[128:131]
  ds_read_b64_tr_b16 a[34:35], v16 offset:4096
  ds_read_b64_tr_b16 a[38:39], v17 offset:4096
  ds_read_b64_tr_b16 a[42:43], v18 offset:4096
  ds_read_b64_tr_b16 a[46:47], v19 offset:4096
  ds_read_b64_tr_b16 a[50:51], v20 offset:4096
  ds_read_b64_tr_b16 a[54:55], v21 offset:4096
  ds_read_b64_tr_b16 a[58:59], v22 offset:4096
  ds_read_b64_tr_b16 a[62:63], v23 offset:4096
  s_waitcnt vmcnt(10)
  s_cbranch_vccnz L_b418
  s_waitcnt vmcnt(8)
  s_bitcmp0_b32 s77, 31
  s_cbranch_scc1 L_b418
  s_cmp_gt_i32 s80, 102
  s_cbranch_scc0 L_n418
  s_waitcnt vmcnt(5)
L_n418:
  s_waitcnt vmcnt(7)
L_b418:
  buffer_load_dwordx4 v10, s[32:35], s65 offen offset:2048 nt lds
  buffer_load_dword v50, v7, s[44:47], 0 offen sc1
  s_bitcmp1_b32 s38, 30
  s_cbranch_scc1 L_gp5
  s_add_i32 s100, s37, 128
  s_max_i32 s100, s100, 0
  s_min_i32 s100, s100, 255
  s_mov_b32 s62, s100
  v_or_b32 v180, s100, v9
  s_add_u32 s18, s38, 168960
  buffer_store_dword v180, v6, s[44:47], s18 offen sc1
L_gp5:
  v_lshlrev_b32 v52, 16, v96
  v_and_b32 v53, 0xffff0000, v96
  v_lshlrev_b32 v54, 16, v97
  v_and_b32 v55, 0xffff0000, v97
  v_fma_f32 v52, v52, s71, v26
  v_fma_f32 v53, v53, s71, v26
  v_fma_f32 v54, v54, s71, v26
  v_fma_f32 v55, v55, s71, v26
  v_exp_f32 v52, v52
  v_exp_f32 v53, v53
  v_exp_f32 v54, v54
  v_exp_f32 v55, v55
  v_cvt_pk_bf16_f32 v96, v52, v53
  v_cvt_pk_bf16_f32 v97, v54, v55
  s_waitcnt lgkmcnt(0)
  v_mfma_f32_16x16x32_bf16 a[96:99], a[32:35], v[72:75], a[96:99]
  v_mfma_f32_16x16x32_bf16 a[100:103], a[36:39], v[72:75], a[100:103]
  v_mfma_f32_16x16x32_bf16 a[104:107], a[40:43], v[72:75], a[104:107]
  v_mfma_f32_16x16x32_bf16 a[108:111], a[44:47], v[72:75], a[108:111]
  s_waitcnt vmcnt(10)
  s_cbranch_vccnz L_b419
  s_waitcnt vmcnt(9)
  s_bitcmp0_b32 s77, 31
  s_cbranch_scc1 L_b419
  s_cmp_gt_i32 s80, 102
  s_cbranch_scc0 L_n419
  s_waitcnt vmcnt(6)
L_n419:
  s_waitcnt vmcnt(7)
L_b419:
  buffer_load_dwordx4 v11, s[32:35], s65 offen offset:3072 nt lds
  s_mov_b32 s18, 168960
  buffer_load_dword v187, v182, s[44:47], s18 offen sc1
  v_lshlrev_b32 v52, 16, v98
  v_and_b32 v53, 0xffff0000, v98
  v_lshlrev_b32 v54, 16, v99
  v_and_b32 v55, 0xffff0000, v99
  v_fma_f32 v52, v52, s71, v26
  v_fma_f32 v53, v53, s71, v26
  v_fma_f32 v54, v54, s71, v26
  v_fma_f32 v55, v55, s71, v26
  v_exp_f32 v52, v52
  v_exp_f32 v53, v53
  v_exp_f32 v54, v54
  v_exp_f32 v55, v55
  v_cvt_pk_bf16_f32 v98, v52, v53
  v_cvt_pk_bf16_f32 v99, v54, v55
  s_nop 1
  v_mfma_f32_16x16x32_bf16 a[128:131], v[56:59], v[96:99], a[128:131]
  v_mfma_f32_16x16x32_bf16 a[112:115], a[48:51], v[72:75], a[112:115]
  v_mfma_f32_16x16x32_bf16 a[116:119], a[52:55], v[72:75], a[116:119]
  v_mfma_f32_16x16x32_bf16 a[120:123], a[56:59], v[72:75], a[120:123]
  v_mfma_f32_16x16x32_bf16 a[124:127], a[60:63], v[72:75], a[124:127]
  s_xor_b32 s65, s64, 0x424000
  s_add_u32 m0, s66, 20480
  s_sub_i32 s77, s36, 104
  s_cmp_gt_i32 s14, 103
  s_cselect_b64 vcc, -1, 0
  s_waitcnt vmcnt(11)
  s_cbranch_vccnz L_b420
  s_waitcnt vmcnt(9)
  s_bitcmp0_b32 s77, 31
  s_cbranch_scc1 L_b420
  s_cmp_gt_i32 s80, 103
  s_cbranch_scc0 L_n420
  s_waitcnt vmcnt(6)
L_n420:
  s_waitcnt vmcnt(8)
L_b420:
  buffer_load_dwordx4 v10, s[32:35], s65 offen offset:0 nt lds
  v_lshlrev_b32 v52, 16, v100
  v_and_b32 v53, 0xffff0000, v100
  v_lshlrev_b32 v54, 16, v101
  v_and_b32 v55, 0xffff0000, v101
  v_fma_f32 v52, v52, s71, v26
  v_fma_f32 v53, v53, s71, v26
  v_fma_f32 v54, v54, s71, v26
  v_fma_f32 v55, v55, s71, v26
  v_exp_f32 v52, v52
  v_exp_f32 v53, v53
  v_exp_f32 v54, v54
  v_exp_f32 v55, v55
  v_cvt_pk_bf16_f32 v100, v52, v53
  v_cvt_pk_bf16_f32 v101, v54, v55
  s_waitcnt vmcnt(10)
  s_cbranch_vccnz L_b421
  s_waitcnt vmcnt(9)
  s_bitcmp0_b32 s77, 31
  s_cbranch_scc1 L_b421
  s_cmp_gt_i32 s80, 103
  s_cbranch_scc0 L_n421
  s_waitcnt vmcnt(6)
L_n421:
  s_waitcnt vmcnt(7)
L_b421:
  buffer_load_dwordx4 v11, s[32:35], s65 offen offset:1024 nt lds
  s_cmp_eq_u32 s15, 3
  s_cselect_b32 s18, s16, 0x400000
  v_or_b32 v8, 103, v9
  buffer_store_dword v8, v6, s[44:47], s18 offen
  v_lshlrev_b32 v52, 16, v102
  v_and_b32 v53, 0xffff0000, v102
  v_lshlrev_b32 v54, 16, v103
  v_and_b32 v55, 0xffff0000, v103
  v_fma_f32 v52, v52, s71, v26
  v_fma_f32 v53, v53, s71, v26
  v_fma_f32 v54, v54, s71, v26
  v_fma_f32 v55, v55, s71, v26
  v_exp_f32 v52, v52
  v_exp_f32 v53, v53
  v_exp_f32 v54, v54
  v_exp_f32 v55, v55
  v_cvt_pk_bf16_f32 v102, v52, v53
  v_cvt_pk_bf16_f32 v103, v54, v55
  s_nop 1
  v_mfma_f32_16x16x32_bf16 a[128:131], v[56:59], v[100:103], a[128:131]
  s_waitcnt vmcnt(11)
  s_cbranch_vccnz L_b422
  s_waitcnt vmcnt(9)
  s_bitcmp0_b32 s77, 31
  s_cbranch_scc1 L_b422
  s_cmp_gt_i32 s80, 103
  s_cbranch_scc0 L_n422
  s_waitcnt vmcnt(6)
L_n422:
  s_waitcnt vmcnt(8)
L_b422:
  buffer_load_dwordx4 v10, s[32:35], s65 offen offset:2048 nt lds
  v_lshlrev_b32 v52, 16, v104
  v_and_b32 v53, 0xffff0000, v104
  v_lshlrev_b32 v54, 16, v105
  v_and_b32 v55, 0xffff0000, v105
  v_fma_f32 v52, v52, s71, v26
  v_fma_f32 v53, v53, s71, v26
  v_fma_f32 v54, v54, s71, v26
  v_fma_f32 v55, v55, s71, v26
  v_exp_f32 v52, v52
  v_exp_f32 v53, v53
  v_exp_f32 v54, v54
  v_exp_f32 v55, v55
  v_cvt_pk_bf16_f32 v104, v52, v53
  v_cvt_pk_bf16_f32 v105, v54, v55
  s_waitcnt vmcnt(10)
  s_cbranch_vccnz L_b423
  s_waitcnt vmcnt(9)
  s_bitcmp0_b32 s77, 31
  s_cbranch_scc1 L_b423
  s_cmp_gt_i32 s80, 103
  s_cbranch_scc0 L_n423
  s_waitcnt vmcnt(5)
L_n423:
  s_waitcnt vmcnt(7)
L_b423:
  buffer_load_dwordx4 v11, s[32:35], s65 offen offset:3072 nt lds
  s_mov_b32 s18, 168960
  buffer_load_dword v188, v182, s[44:47], s18 offen sc1
  v_lshlrev_b32 v52, 16, v106
  v_and_b32 v53, 0xffff0000, v106
  v_lshlrev_b32 v54, 16, v107
  v_and_b32 v55, 0xffff0000, v107
  v_fma_f32 v52, v52, s71, v26
  v_fma_f32 v53, v53, s71, v26
  v_fma_f32 v54, v54, s71, v26
  v_fma_f32 v55, v55, s71, v26
  v_exp_f32 v52, v52
  v_exp_f32 v53, v53
  v_exp_f32 v54, v54
  v_exp_f32 v55, v55
  v_cvt_pk_bf16_f32 v106, v52, v53
  v_cvt_pk_bf16_f32 v107, v54, v55
  s_nop 1
  v_mfma_f32_16x16x32_bf16 a[128:131], v[56:59], v[104:107], a[128:131]
  ds_read_b64_tr_b16 a[32:33], v16 offset:8192
  ds_read_b64_tr_b16 a[36:37], v17 offset:8192
  ds_read_b64_tr_b16 a[40:41], v18 offset:8192
  ds_read_b64_tr_b16 a[44:45], v19 offset:8192
  ds_read_b64_tr_b16 a[48:49], v20 offset:8192
  ds_read_b64_tr_b16 a[52:53], v21 offset:8192
  ds_read_b64_tr_b16 a[56:57], v22 offset:8192
  ds_read_b64_tr_b16 a[60:61], v23 offset:8192
  s_xor_b32 s65, s64, 0x40000
  s_add_u32 m0, s66, 24576
  s_sub_i32 s77, s36, 105
  s_cmp_gt_i32 s14, 104
  s_cselect_b64 vcc, -1, 0
  s_waitcnt vmcnt(11)
  s_cbranch_vccnz L_b424
  s_waitcnt vmcnt(9)
  s_bitcmp0_b32 s77, 31
  s_cbranch_scc1 L_b424
  s_cmp_gt_i32 s80, 104
  s_cbranch_scc0 L_n424
  s_waitcnt vmcnt(5)
L_n424:
  s_waitcnt vmcnt(7)
L_b424:
  buffer_load_dwordx4 v10, s[32:35], s65 offen offset:0 nt lds
  v_lshlrev_b32 v52, 16, v108
  v_and_b32 v53, 0xffff0000, v108
  v_lshlrev_b32 v54, 16, v109
  v_and_b32 v55, 0xffff0000, v109
  v_fma_f32 v52, v52, s71, v26
  v_fma_f32 v53, v53, s71, v26
  v_fma_f32 v54, v54, s71, v26
  v_fma_f32 v55, v55, s71, v26
  v_exp_f32 v52, v52
  v_exp_f32 v53, v53
  v_exp_f32 v54, v54
  v_exp_f32 v55, v55
  v_cvt_pk_bf16_f32 v108, v52, v53
  v_cvt_pk_bf16_f32 v109, v54, v55
  s_waitcnt vmcnt(10)
  s_cbranch_vccnz L_b425
  s_waitcnt vmcnt(8)
  s_bitcmp0_b32 s77, 31
  s_cbranch_scc1 L_b425
  s_cmp_gt_i32 s80, 104
  s_cbranch_scc0 L_n425
  s_waitcnt vmcnt(5)
L_n425:
  s_waitcnt vmcnt(6)
L_b425:
  buffer_load_dwordx4 v11, s[32:35], s65 offen offset:1024 nt lds
  s_cmp_eq_u32 s15, 0
  s_cselect_b32 s18, s16, 0x400000
  v_or_b32 v8, 104, v9
  buffer_store_dword v8, v6, s[44:47], s18 offen
  v_lshlrev_b32 v52, 16, v110
  v_and_b32 v53, 0xffff0000, v110
  v_lshlrev_b32 v54, 16, v111
  v_and_b32 v55, 0xffff0000, v111
  v_fma_f32 v52, v52, s71, v26
  v_fma_f32 v53, v53, s71, v26
  v_fma_f32 v54, v54, s71, v26
  v_fma_f32 v55, v55, s71, v26
  v_exp_f32 v52, v52
  v_exp_f32 v53, v53
  v_exp_f32 v54, v54
  v_exp_f32 v55, v55
  v_cvt_pk_bf16_f32 v110, v52, v53
  v_cvt_pk_bf16_f32 v111, v54, v55
  s_nop 1
  v_mfma_f32_16x16x32_bf16 a[128:131], v[56:59], v[108:111], a[128:131]
  s_waitcnt vmcnt(10)
  s_cbranch_vccnz L_b426
  s_waitcnt vmcnt(8)
  s_bitcmp0_b32 s77, 31
  s_cbranch_scc1 L_b426
  s_cmp_gt_i32 s80, 104
  s_cbranch_scc0 L_n426
  s_waitcnt vmcnt(5)
L_n426:
  s_waitcnt vmcnt(7)
L_b426:
  buffer_load_dwordx4 v10, s[32:35], s65 offen offset:2048 nt lds
  v_xor_b32 v50, s17, v50
  v_lshrrev_b32 v51, 8, v50
  v_cmp_eq_u32 s[82:83], 0, v51
  v_mov_b32 v51, 100
  s_nop 0
  v_cndmask_b32 v50, v51, v50, s[82:83]
  s_nop 1
  v_add_u32_dpp v50, v50, v50 row_ror:1 row_mask:0xf bank_mask:0xf
  s_nop 1
  v_add_u32_dpp v50, v50, v50 row_ror:2 row_mask:0xf bank_mask:0xf
  s_nop 1
  v_add_u32_dpp v50, v50, v50 row_ror:4 row_mask:0xf bank_mask:0xf
  s_nop 1
  v_add_u32_dpp v50, v50, v50 row_ror:8 row_mask:0xf bank_mask:0xf
  s_nop 0
  v_readlane_b32 s100, v50, 0
  v_readlane_b32 s101, v50, 16
  s_add_u32 s100, s100, s101
  s_sub_i32 s100, s100, 3203
  s_ashr_i32 s37, s100, 1
  s_add_i32 s62, s37, 128
  s_add_i32 s101, s100, 32
  s_mul_i32 s101, s101, -20
  s_ashr_i32 s101, s101, 8
  s_min_i32 s101, s101, 4
  s_add_i32 s80, s101, 105
  s_max_i32 s80, s80, s3
  s_mul_i32 s100, s100, 24
  s_ashr_i32 s100, s100, 8
  s_min_i32 s100, s100, 8
  s_add_i32 s14, s100, 105
  v_lshlrev_b32 v52, 16, v112
  v_and_b32 v53, 0xffff0000, v112
  v_lshlrev_b32 v54, 16, v113
  v_and_b32 v55, 0xffff0000, v113
  v_fma_f32 v52, v52, s71, v26
  v_fma_f32 v53, v53, s71, v26
  v_fma_f32 v54, v54, s71, v26
  v_fma_f32 v55, v55, s71, v26
  v_exp_f32 v52, v52
  v_exp_f32 v53, v53
  v_exp_f32 v54, v54
  v_exp_f32 v55, v55
  v_cvt_pk_bf16_f32 v112, v52, v53
  v_cvt_pk_bf16_f32 v113, v54, v55
  ds_read_b64_tr_b16 a[34:35], v16 offset:12288
  ds_read_b64_tr_b16 a[38:39], v17 offset:12288
  ds_read_b64_tr_b16 a[42:43], v18 offset:12288
  ds_read_b64_tr_b16 a[46:47], v19 offset:12288
  ds_read_b64_tr_b16 a[50:51], v20 offset:12288
  ds_read_b64_tr_b16 a[54:55], v21 offset:12288
  ds_read_b64_tr_b16 a[58:59], v22 offset:12288
  ds_read_b64_tr_b16 a[62:63], v23 offset:12288
  s_waitcnt vmcnt(9)
  s_cbranch_vccnz L_b427
  s_waitcnt vmcnt(8)
  s_bitcmp0_b32 s77, 31
  s_cbranch_scc1 L_b427
  s_cmp_gt_i32 s80, 104
  s_cbranch_scc0 L_n427
  s_waitcnt vmcnt(5)
L_n427:
  s_waitcnt vmcnt(6)
L_b427:
  buffer_load_dwordx4 v11, s[32:35], s65 offen offset:3072 nt lds
  s_mov_b32 s18, 168960
  buffer_load_dword v189, v182, s[44:47], s18 offen sc1
  v_lshlrev_b32 v52, 16, v114
  v_and_b32 v53, 0xffff0000, v114
  v_lshlrev_b32 v54, 16, v115
  v_and_b32 v55, 0xffff0000, v115
  v_fma_f32 v52, v52, s71, v26
  v_fma_f32 v53, v53, s71, v26
  v_fma_f32 v54, v54, s71, v26
  v_fma_f32 v55, v55, s71, v26
  v_exp_f32 v52, v52
  v_exp_f32 v53, v53
  v_exp_f32 v54, v54
  v_exp_f32 v55, v55
  v_cvt_pk_bf16_f32 v114, v52, v53
  v_cvt_pk_bf16_f32 v115, v54, v55
  s_nop 1
  v_mfma_f32_16x16x32_bf16 a[128:131], v[56:59], v[112:115], a[128:131]
  s_waitcnt lgkmcnt(0)
  v_mfma_f32_16x16x32_bf16 a[96:99], a[32:35], v[76:79], a[96:99]
  v_mfma_f32_16x16x32_bf16 a[100:103], a[36:39], v[76:79], a[100:103]
  v_mfma_f32_16x16x32_bf16 a[104:107], a[40:43], v[76:79], a[104:107]
  v_mfma_f32_16x16x32_bf16 a[108:111], a[44:47], v[76:79], a[108:111]
  s_xor_b32 s65, s64, 0x44000
  s_add_u32 m0, s66, 0
  s_sub_i32 s77, s36, 106
  s_cmp_gt_i32 s14, 105
  s_cselect_b64 vcc, -1, 0
  s_waitcnt vmcnt(10)
  s_cbranch_vccnz L_b428
  s_waitcnt vmcnt(8)
  s_bitcmp0_b32 s77, 31
  s_cbranch_scc1 L_b428
  s_cmp_gt_i32 s80, 105
  s_cbranch_scc0 L_n428
  s_waitcnt vmcnt(5)
L_n428:
  s_waitcnt vmcnt(7)
L_b428:
  buffer_load_dwordx4 v10, s[32:35], s65 offen offset:0 nt lds
  v_lshlrev_b32 v52, 16, v116
  v_and_b32 v53, 0xffff0000, v116
  v_lshlrev_b32 v54, 16, v117
  v_and_b32 v55, 0xffff0000, v117
  v_fma_f32 v52, v52, s71, v26
  v_fma_f32 v53, v53, s71, v26
  v_fma_f32 v54, v54, s71, v26
  v_fma_f32 v55, v55, s71, v26
  v_exp_f32 v52, v52
  v_exp_f32 v53, v53
  v_exp_f32 v54, v54
  v_exp_f32 v55, v55
  v_cvt_pk_bf16_f32 v116, v52, v53
  v_cvt_pk_bf16_f32 v117, v54, v55
  v_mfma_f32_16x16x32_bf16 a[112:115], a[48:51], v[76:79], a[112:115]
  v_mfma_f32_16x16x32_bf16 a[116:119], a[52:55], v[76:79], a[116:119]
  v_mfma_f32_16x16x32_bf16 a[120:123], a[56:59], v[76:79], a[120:123]
  v_mfma_f32_16x16x32_bf16 a[124:127], a[60:63], v[76:79], a[124:127]
  s_waitcnt vmcnt(9)
  s_cbranch_vccnz L_b429
  s_waitcnt vmcnt(8)
  s_bitcmp0_b32 s77, 31
  s_cbranch_scc1 L_b429
  s_cmp_gt_i32 s80, 105
  s_cbranch_scc0 L_n429
  s_waitcnt vmcnt(5)
L_n429:
  s_waitcnt vmcnt(6)
L_b429:
  buffer_load_dwordx4 v11, s[32:35], s65 offen offset:1024 nt lds
  s_cmp_eq_u32 s15, 1
  s_cselect_b32 s18, s16, 0x400000
  v_or_b32 v8, 105, v9
  buffer_store_dword v8, v6, s[44:47], s18 offen
  v_lshlrev_b32 v52, 16, v118
  v_and_b32 v53, 0xffff0000, v118
  v_lshlrev_b32 v54, 16, v119
  v_and_b32 v55, 0xffff0000, v119
  v_fma_f32 v52, v52, s71, v26
  v_fma_f32 v53, v53, s71, v26
  v_fma_f32 v54, v54, s71, v26
  v_fma_f32 v55, v55, s71, v26
  v_exp_f32 v52, v52
  v_exp_f32 v53, v53
  v_exp_f32 v54, v54
  v_exp_f32 v55, v55
  v_cvt_pk_bf16_f32 v118, v52, v53
  v_cvt_pk_bf16_f32 v119, v54, v55
  s_nop 1
  v_mfma_f32_16x16x32_bf16 a[128:131], v[56:59], v[116:119], a[128:131]
  ds_read_b64_tr_b16 a[32:33], v16 offset:16384
  ds_read_b64_tr_b16 a[36:37], v17 offset:16384
  ds_read_b64_tr_b16 a[40:41], v18 offset:16384
  ds_read_b64_tr_b16 a[44:45], v19 offset:16384
  ds_read_b64_tr_b16 a[48:49], v20 offset:16384
  ds_read_b64_tr_b16 a[52:53], v21 offset:16384
  ds_read_b64_tr_b16 a[56:57], v22 offset:16384
  ds_read_b64_tr_b16 a[60:61], v23 offset:16384
  s_waitcnt vmcnt(10)
  s_cbranch_vccnz L_b430
  s_waitcnt vmcnt(8)
  s_bitcmp0_b32 s77, 31
  s_cbranch_scc1 L_b430
  s_cmp_gt_i32 s80, 105
  s_cbranch_scc0 L_n430
  s_waitcnt vmcnt(5)
L_n430:
  s_waitcnt vmcnt(7)
L_b430:
  buffer_load_dwordx4 v10, s[32:35], s65 offen offset:2048 nt lds
  v_lshlrev_b32 v52, 16, v120
  v_and_b32 v53, 0xffff0000, v120
  v_lshlrev_b32 v54, 16, v121
  v_and_b32 v55, 0xffff0000, v121
  v_fma_f32 v52, v52, s71, v26
  v_fma_f32 v53, v53, s71, v26
  v_fma_f32 v54, v54, s71, v26
  v_fma_f32 v55, v55, s71, v26
  v_exp_f32 v52, v52
  v_exp_f32 v53, v53
  v_exp_f32 v54, v54
  v_exp_f32 v55, v55
  v_cvt_pk_bf16_f32 v120, v52, v53
  v_cvt_pk_bf16_f32 v121, v54, v55
  s_waitcnt vmcnt(9)
  s_cbranch_vccnz L_b431
  s_waitcnt vmcnt(8)
  s_bitcmp0_b32 s77, 31
  s_cbranch_scc1 L_b431
  s_cmp_gt_i32 s80, 105
  s_cbranch_scc0 L_n431
  s_waitcnt vmcnt(5)
L_n431:
  s_waitcnt vmcnt(6)
L_b431:
  buffer_load_dwordx4 v11, s[32:35], s65 offen offset:3072 nt lds
  s_mov_b32 s18, 168960
  buffer_load_dword v190, v182, s[44:47], s18 offen sc1
  v_lshlrev_b32 v52, 16, v122
  v_and_b32 v53, 0xffff0000, v122
  v_lshlrev_b32 v54, 16, v123
  v_and_b32 v55, 0xffff0000, v123
  v_fma_f32 v52, v52, s71, v26
  v_fma_f32 v53, v53, s71, v26
  v_fma_f32 v54, v54, s71, v26
  v_fma_f32 v55, v55, s71, v26
  v_exp_f32 v52, v52
  v_exp_f32 v53, v53
  v_exp_f32 v54, v54
  v_exp_f32 v55, v55
  v_cvt_pk_bf16_f32 v122, v52, v53
  v_cvt_pk_bf16_f32 v123, v54, v55
  s_nop 1
  v_mfma_f32_16x16x32_bf16 a[128:131], v[56:59], v[120:123], a[128:131]
  s_xor_b32 s65, s64, 0x440000
  s_add_u32 m0, s66, 4096
  s_sub_i32 s77, s36, 107
  s_cmp_gt_i32 s14, 106
  s_cselect_b64 vcc, -1, 0
  s_waitcnt vmcnt(10)
  s_cbranch_vccnz L_b432
  s_waitcnt vmcnt(8)
  s_bitcmp0_b32 s77, 31
  s_cbranch_scc1 L_b432
  s_cmp_gt_i32 s80, 106
  s_cbranch_scc0 L_n432
  s_waitcnt vmcnt(5)
L_n432:
  s_waitcnt vmcnt(7)
L_b432:
  buffer_load_dwordx4 v10, s[32:35], s65 offen offset:0 nt lds
  v_lshlrev_b32 v52, 16, v124
  v_and_b32 v53, 0xffff0000, v124
  v_lshlrev_b32 v54, 16, v125
  v_and_b32 v55, 0xffff0000, v125
  v_fma_f32 v52, v52, s71, v26
  v_fma_f32 v53, v53, s71, v26
  v_fma_f32 v54, v54, s71, v26
  v_fma_f32 v55, v55, s71, v26
  v_exp_f32 v52, v52
  v_exp_f32 v53, v53
  v_exp_f32 v54, v54
  v_exp_f32 v55, v55
  v_cvt_pk_bf16_f32 v124, v52, v53
  v_cvt_pk_bf16_f32 v125, v54, v55
  s_waitcnt vmcnt(9)
  s_cbranch_vccnz L_b433
  s_waitcnt vmcnt(8)
  s_bitcmp0_b32 s77, 31
  s_cbranch_scc1 L_b433
  s_cmp_gt_i32 s80, 106
  s_cbranch_scc0 L_n433
  s_waitcnt vmcnt(5)
L_n433:
  s_waitcnt vmcnt(6)
L_b433:
  buffer_load_dwordx4 v11, s[32:35], s65 offen offset:1024 nt lds
  s_cmp_eq_u32 s15, 2
  s_cselect_b32 s18, s16, 0x400000
  v_or_b32 v8, 106, v9
  buffer_store_dword v8, v6, s[44:47], s18 offen
  v_lshlrev_b32 v52, 16, v126
  v_and_b32 v53, 0xffff0000, v126
  v_lshlrev_b32 v54, 16, v127
  v_and_b32 v55, 0xffff0000, v127
  v_fma_f32 v52, v52, s71, v26
  v_fma_f32 v53, v53, s71, v26
  v_fma_f32 v54, v54, s71, v26
  v_fma_f32 v55, v55, s71, v26
  v_exp_f32 v52, v52
  v_exp_f32 v53, v53
  v_exp_f32 v54, v54
  v_exp_f32 v55, v55
  v_cvt_pk_bf16_f32 v126, v52, v53
  v_cvt_pk_bf16_f32 v127, v54, v55
  s_nop 1
  v_mfma_f32_16x16x32_bf16 a[128:131], v[56:59], v[124:127], a[128:131]
  ds_read_b64_tr_b16 a[34:35], v16 offset:20480
  ds_read_b64_tr_b16 a[38:39], v17 offset:20480
  ds_read_b64_tr_b16 a[42:43], v18 offset:20480
  ds_read_b64_tr_b16 a[46:47], v19 offset:20480
  ds_read_b64_tr_b16 a[50:51], v20 offset:20480
  ds_read_b64_tr_b16 a[54:55], v21 offset:20480
  ds_read_b64_tr_b16 a[58:59], v22 offset:20480
  ds_read_b64_tr_b16 a[62:63], v23 offset:20480
  s_waitcnt vmcnt(10)
  s_cbranch_vccnz L_b434
  s_waitcnt vmcnt(8)
  s_bitcmp0_b32 s77, 31
  s_cbranch_scc1 L_b434
  s_cmp_gt_i32 s80, 106
  s_cbranch_scc0 L_n434
  s_waitcnt vmcnt(5)
L_n434:
  s_waitcnt vmcnt(7)
L_b434:
  buffer_load_dwordx4 v10, s[32:35], s65 offen offset:2048 nt lds
  buffer_load_dword v50, v7, s[44:47], 0 offen sc1
  v_lshlrev_b32 v52, 16, v128
  v_and_b32 v53, 0xffff0000, v128
  v_lshlrev_b32 v54, 16, v129
  v_and_b32 v55, 0xffff0000, v129
  v_fma_f32 v52, v52, s71, v26
  v_fma_f32 v53, v53, s71, v26
  v_fma_f32 v54, v54, s71, v26
  v_fma_f32 v55, v55, s71, v26
  v_exp_f32 v52, v52
  v_exp_f32 v53, v53
  v_exp_f32 v54, v54
  v_exp_f32 v55, v55
  v_cvt_pk_bf16_f32 v128, v52, v53
  v_cvt_pk_bf16_f32 v129, v54, v55
  s_waitcnt lgkmcnt(0)
  v_mfma_f32_16x16x32_bf16 a[96:99], a[32:35], v[80:83], a[96:99]
  v_mfma_f32_16x16x32_bf16 a[100:103], a[36:39], v[80:83], a[100:103]
  v_mfma_f32_16x16x32_bf16 a[104:107], a[40:43], v[80:83], a[104:107]
  v_mfma_f32_16x16x32_bf16 a[108:111], a[44:47], v[80:83], a[108:111]
  s_waitcnt vmcnt(10)
  s_cbranch_vccnz L_b435
  s_waitcnt vmcnt(9)
  s_bitcmp0_b32 s77, 31
  s_cbranch_scc1 L_b435
  s_cmp_gt_i32 s80, 106
  s_cbranch_scc0 L_n435
  s_waitcnt vmcnt(6)
L_n435:
  s_waitcnt vmcnt(7)
L_b435:
  buffer_load_dwordx4 v11, s[32:35], s65 offen offset:3072 nt lds
  s_mov_b32 s18, 168960
  buffer_load_dword v191, v182, s[44:47], s18 offen sc1
  v_lshlrev_b32 v52, 16, v130
  v_and_b32 v53, 0xffff0000, v130
  v_lshlrev_b32 v54, 16, v131
  v_and_b32 v55, 0xffff0000, v131
  v_fma_f32 v52, v52, s71, v26
  v_fma_f32 v53, v53, s71, v26
  v_fma_f32 v54, v54, s71, v26
  v_fma_f32 v55, v55, s71, v26
  v_exp_f32 v52, v52
  v_exp_f32 v53, v53
  v_exp_f32 v54, v54
  v_exp_f32 v55, v55
  v_cvt_pk_bf16_f32 v130, v52, v53
  v_cvt_pk_bf16_f32 v131, v54, v55
  s_nop 1
  v_mfma_f32_16x16x32_bf16 a[128:131], v[56:59], v[128:131], a[128:131]
  v_mfma_f32_16x16x32_bf16 a[112:115], a[48:51], v[80:83], a[112:115]
  v_mfma_f32_16x16x32_bf16 a[116:119], a[52:55], v[80:83], a[116:119]
  v_mfma_f32_16x16x32_bf16 a[120:123], a[56:59], v[80:83], a[120:123]
  v_mfma_f32_16x16x32_bf16 a[124:127], a[60:63], v[80:83], a[124:127]
  s_xor_b32 s65, s64, 0x444000
  s_add_u32 m0, s66, 8192
  s_sub_i32 s77, s36, 108
  s_cmp_gt_i32 s14, 107
  s_cselect_b64 vcc, -1, 0
  s_waitcnt vmcnt(11)
  s_cbranch_vccnz L_b436
  s_waitcnt vmcnt(9)
  s_bitcmp0_b32 s77, 31
  s_cbranch_scc1 L_b436
  s_cmp_gt_i32 s80, 107
  s_cbranch_scc0 L_n436
  s_waitcnt vmcnt(6)
L_n436:
  s_waitcnt vmcnt(8)
L_b436:
  buffer_load_dwordx4 v10, s[32:35], s65 offen offset:0 nt lds
  s_nop 5
  s_mov_b32 exec_lo, 0x000f000f
  s_mov_b32 exec_hi, 0x000f000f
  ds_write_b32 v37, v25 offset:64
  ds_write_b32 v37, a128 offset:192
  s_mov_b64 exec, -1
  s_waitcnt lgkmcnt(0)
  ds_write_b32 v33, v56 offset:16
  s_waitcnt vmcnt(10)
  s_cbranch_vccnz L_b437
  s_waitcnt vmcnt(9)
  s_bitcmp0_b32 s77, 31
  s_cbranch_scc1 L_b437
  s_cmp_gt_i32 s80, 107
  s_cbranch_scc0 L_n437
  s_waitcnt vmcnt(6)
L_n437:
  s_waitcnt vmcnt(7)
L_b437:
  buffer_load_dwordx4 v11, s[32:35], s65 offen offset:1024 nt lds
  s_cmp_eq_u32 s15, 3
  s_cselect_b32 s18, s16, 0x400000
  v_or_b32 v8, 107, v9
  buffer_store_dword v8, v6, s[44:47], s18 offen
  s_waitcnt vmcnt(11)
  s_cbranch_vccnz L_b438
  s_waitcnt vmcnt(9)
  s_bitcmp0_b32 s77, 31
  s_cbranch_scc1 L_b438
  s_cmp_gt_i32 s80, 107
  s_cbranch_scc0 L_n438
  s_waitcnt vmcnt(6)
L_n438:
  s_waitcnt vmcnt(8)
L_b438:
  buffer_load_dwordx4 v10, s[32:35], s65 offen offset:2048 nt lds
  s_waitcnt vmcnt(10)
  s_cbranch_vccnz L_b439
  s_waitcnt vmcnt(9)
  s_bitcmp0_b32 s77, 31
  s_cbranch_scc1 L_b439
  s_cmp_gt_i32 s80, 107
  s_cbranch_scc0 L_n439
  s_waitcnt vmcnt(5)
L_n439:
  s_waitcnt vmcnt(7)
L_b439:
  buffer_load_dwordx4 v11, s[32:35], s65 offen offset:3072 nt lds
  ds_read_b64_tr_b16 a[32:33], v16 offset:24576
  ds_read_b64_tr_b16 a[36:37], v17 offset:24576
  ds_read_b64_tr_b16 a[40:41], v18 offset:24576
  ds_read_b64_tr_b16 a[44:45], v19 offset:24576
  ds_read_b64_tr_b16 a[48:49], v20 offset:24576
  ds_read_b64_tr_b16 a[52:53], v21 offset:24576
  ds_read_b64_tr_b16 a[56:57], v22 offset:24576
  ds_read_b64_tr_b16 a[60:61], v23 offset:24576
  s_xor_b32 s65, s64, 0x60000
  s_add_u32 m0, s66, 12288
  s_sub_i32 s77, s36, 109
  s_cmp_gt_i32 s14, 108
  s_cselect_b64 vcc, -1, 0
  s_waitcnt vmcnt(10)
  s_cbranch_vccnz L_b440
  s_waitcnt vmcnt(8)
  s_bitcmp0_b32 s77, 31
  s_cbranch_scc1 L_b440
  s_cmp_gt_i32 s80, 108
  s_cbranch_scc0 L_n440
  s_waitcnt vmcnt(4)
L_n440:
  s_waitcnt vmcnt(6)
L_b440:
  buffer_load_dwordx4 v10, s[32:35], s65 offen offset:0 nt lds
  s_waitcnt vmcnt(9)
  s_cbranch_vccnz L_b441
  s_waitcnt vmcnt(7)
  s_bitcmp0_b32 s77, 31
  s_cbranch_scc1 L_b441
  s_cmp_gt_i32 s80, 108
  s_cbranch_scc0 L_n441
  s_waitcnt vmcnt(4)
L_n441:
  s_waitcnt vmcnt(5)
L_b441:
  buffer_load_dwordx4 v11, s[32:35], s65 offen offset:1024 nt lds
  s_cmp_eq_u32 s15, 0
  s_cselect_b32 s18, s16, 0x400000
  v_or_b32 v8, 108, v9
  buffer_store_dword v8, v6, s[44:47], s18 offen
  ds_read_b64_tr_b16 a[34:35], v16 offset:0
  ds_read_b64_tr_b16 a[38:39], v17 offset:0
  ds_read_b64_tr_b16 a[42:43], v18 offset:0
  ds_read_b64_tr_b16 a[46:47], v19 offset:0
  ds_read_b64_tr_b16 a[50:51], v20 offset:0
  ds_read_b64_tr_b16 a[54:55], v21 offset:0
  ds_read_b64_tr_b16 a[58:59], v22 offset:0
  ds_read_b64_tr_b16 a[62:63], v23 offset:0
  s_waitcnt vmcnt(9)
  s_cbranch_vccnz L_b442
  s_waitcnt vmcnt(7)
  s_bitcmp0_b32 s77, 31
  s_cbranch_scc1 L_b442
  s_cmp_gt_i32 s80, 108
  s_cbranch_scc0 L_n442
  s_waitcnt vmcnt(4)
L_n442:
  s_waitcnt vmcnt(6)
L_b442:
  buffer_load_dwordx4 v10, s[32:35], s65 offen offset:2048 nt lds
  v_xor_b32 v50, s17, v50
  v_lshrrev_b32 v51, 8, v50
  v_cmp_eq_u32 s[82:83], 0, v51
  v_mov_b32 v51, 104
  s_nop 0
  v_cndmask_b32 v50, v51, v50, s[82:83]
  s_nop 1
  v_add_u32_dpp v50, v50, v50 row_ror:1 row_mask:0xf bank_mask:0xf
  s_nop 1
  v_add_u32_dpp v50, v50, v50 row_ror:2 row_mask:0xf bank_mask:0xf
  s_nop 1
  v_add_u32_dpp v50, v50, v50 row_ror:4 row_mask:0xf bank_mask:0xf
  s_nop 1
  v_add_u32_dpp v50, v50, v50 row_ror:8 row_mask:0xf bank_mask:0xf
  s_nop 0
  v_readlane_b32 s100, v50, 0
  v_readlane_b32 s101, v50, 16
  s_add_u32 s100, s100, s101
  s_sub_i32 s100, s100, 3331
  s_ashr_i32 s37, s100, 1
  s_add_i32 s101, s100, 32
  s_mul_i32 s101, s101, -20
  s_ashr_i32 s101, s101, 8
  s_min_i32 s101, s101, 4
  s_add_i32 s80, s101, 109
  s_max_i32 s80, s80, s3
  s_mul_i32 s100, s100, 24
  s_ashr_i32 s100, s100, 8
  s_min_i32 s100, s100, 8
  s_add_i32 s14, s100, 109
  s_waitcnt lgkmcnt(0)
  v_mfma_f32_16x16x32_bf16 a[96:99], a[32:35], v[84:87], a[96:99]
  v_mfma_f32_16x16x32_bf16 a[100:103], a[36:39], v[84:87], a[100:103]
  v_mfma_f32_16x16x32_bf16 a[104:107], a[40:43], v[84:87], a[104:107]
  v_mfma_f32_16x16x32_bf16 a[108:111], a[44:47], v[84:87], a[108:111]
  s_waitcnt vmcnt(8)
  s_cbranch_vccnz L_b443
  s_waitcnt vmcnt(7)
  s_bitcmp0_b32 s77, 31
  s_cbranch_scc1 L_b443
  s_cmp_gt_i32 s80, 108
  s_cbranch_scc0 L_n443
  s_waitcnt vmcnt(4)
L_n443:
  s_waitcnt vmcnt(5)
L_b443:
  buffer_load_dwordx4 v11, s[32:35], s65 offen offset:3072 nt lds
  s_bitcmp1_b32 s38, 30
  s_cbranch_scc1 L_ge5
  v_xor_b32 v184, s17, v184
  v_xor_b32 v185, s17, v185
  v_xor_b32 v186, s17, v186
  v_xor_b32 v187, s17, v187
  v_xor_b32 v188, s17, v188
  v_xor_b32 v189, s17, v189
  v_xor_b32 v190, s17, v190
  v_xor_b32 v191, s17, v191
  v_min_u32 v180, 0x100, v191
  v_lshrrev_b32 v181, 1, v180
  v_and_b32 v181, 0x80, v181
  v_and_b32 v180, 0xff, v180
  v_add_u32 v180, v180, v181
  v_lshrrev_b32 v184, 8, v184
  v_min_u32 v184, 1, v184
  v_lshlrev_b32 v184, 4, v184
  v_sub_u32 v180, v180, v184
  v_lshrrev_b32 v185, 8, v185
  v_min_u32 v185, 1, v185
  v_lshlrev_b32 v185, 4, v185
  v_sub_u32 v180, v180, v185
  v_lshrrev_b32 v186, 8, v186
  v_min_u32 v186, 1, v186
  v_lshlrev_b32 v186, 4, v186
  v_sub_u32 v180, v180, v186
  v_lshrrev_b32 v187, 8, v187
  v_min_u32 v187, 1, v187
  v_lshlrev_b32 v187, 4, v187
  v_sub_u32 v180, v180, v187
  v_lshrrev_b32 v188, 8, v188
  v_min_u32 v188, 1, v188
  v_lshlrev_b32 v188, 4, v188
  v_sub_u32 v180, v180, v188
  v_lshrrev_b32 v189, 8, v189
  v_min_u32 v189, 1, v189
  v_lshlrev_b32 v189, 4, v189
  v_sub_u32 v180, v180, v189
  v_lshrrev_b32 v190, 8, v190
  v_min_u32 v190, 1, v190
  v_lshlrev_b32 v190, 4, v190
  v_sub_u32 v180, v180, v190
  v_lshrrev_b32 v191, 8, v191
  v_min_u32 v191, 1, v191
  v_lshlrev_b32 v191, 4, v191
  v_sub_u32 v180, v180, v191
  s_and_b32 s101, s2, 7
  s_sub_i32 s100, s62, 64
  s_mov_b32 m0, s101
  v_writelane_b32 v180, s100, m0
  s_add_u32 m0, s66, 12288
  s_nop 1
  v_add_u32_dpp v180, v180, v180 quad_perm:[1,0,3,2] row_mask:0xf bank_mask:0xf
  s_nop 1
  v_add_u32_dpp v180, v180, v180 quad_perm:[2,3,0,1] row_mask:0xf bank_mask:0xf
  s_nop 1
  v_add_u32_dpp v180, v180, v180 row_half_mirror row_mask:0xf bank_mask:0xf
  s_nop 0
  v_readlane_b32 s101, v180, 0
  s_lshl_b32 s100, s100, 3
  s_sub_i32 s100, s101, s100
  s_add_i32 s100, s100, -32
  s_mul_i32 s100, s100, 96
  s_add_i32 s100, s100, 512
  s_ashr_i32 s100, s100, 10
  s_max_i32 s100, s100, -16
  s_min_i32 s100, s100, 16
  s_add_i32 s100, s100, 128
  v_or_b32 v180, s100, v9
  buffer_store_dword v180, v6, s[44:47], s39 offen offset:20
L_ge5:
  v_mfma_f32_16x16x32_bf16 a[112:115], a[48:51], v[84:87], a[112:115]
  v_mfma_f32_16x16x32_bf16 a[116:119], a[52:55], v[84:87], a[116:119]
  v_mfma_f32_16x16x32_bf16 a[120:123], a[56:59], v[84:87], a[120:123]
  v_mfma_f32_16x16x32_bf16 a[124:127], a[60:63], v[84:87], a[124:127]
  s_xor_b32 s65, s64, 0x64000
  s_add_u32 m0, s66, 16384
  s_sub_i32 s77, s36, 110
  s_cmp_gt_i32 s14, 109
  s_cselect_b64 vcc, -1, 0
  s_waitcnt vmcnt(8)
  s_cbranch_vccnz L_b444
  s_waitcnt vmcnt(6)
  s_bitcmp0_b32 s77, 31
  s_cbranch_scc1 L_b444
  s_cmp_gt_i32 s80, 109
  s_cbranch_scc0 L_n444
  s_waitcnt vmcnt(4)
L_n444:
  s_waitcnt vmcnt(5)
L_b444:
  buffer_load_dwordx4 v10, s[32:35], s65 offen offset:0 nt lds
  ds_read_b64_tr_b16 a[32:33], v16 offset:4096
  ds_read_b64_tr_b16 a[36:37], v17 offset:4096
  ds_read_b64_tr_b16 a[40:41], v18 offset:4096
  ds_read_b64_tr_b16 a[44:45], v19 offset:4096
  ds_read_b64_tr_b16 a[48:49], v20 offset:4096
  ds_read_b64_tr_b16 a[52:53], v21 offset:4096
  ds_read_b64_tr_b16 a[56:57], v22 offset:4096
  ds_read_b64_tr_b16 a[60:61], v23 offset:4096
  s_waitcnt vmcnt(7)
  s_cbranch_vccnz L_b445
  s_waitcnt vmcnt(6)
  s_bitcmp0_b32 s77, 31
  s_cbranch_scc1 L_b445
  s_cmp_gt_i32 s80, 109
  s_cbranch_scc0 L_n445
  s_waitcnt vmcnt(4)
L_n445:
  s_waitcnt vmcnt(5)
L_b445:
  buffer_load_dwordx4 v11, s[32:35], s65 offen offset:1024 nt lds
  s_cmp_eq_u32 s15, 1
  s_cselect_b32 s18, s16, 0x400000
  v_or_b32 v8, 109, v9
  buffer_store_dword v8, v6, s[44:47], s18 offen
L_lflag:
  ds_read_b128 v[140:143], v34 offset:16
  s_sub_u32 s79, s79, 1
  s_cbranch_scc1 L_end
  s_waitcnt lgkmcnt(0)
  v_and_b32 v140, v140, v141
  v_and_b32 v142, v142, v143
  v_and_b32 v140, v140, v142
  v_cmp_eq_u32 vcc, 0, v140
  s_cbranch_vccnz L_lflag
  ds_read_b128 v[140:143], v41
  ds_read_b128 v[144:147], v41 offset:128
  s_waitcnt vmcnt(8)
  s_cbranch_vccnz L_b446
  s_waitcnt vmcnt(7)
  s_bitcmp0_b32 s77, 31
  s_cbranch_scc1 L_b446
  s_cmp_gt_i32 s80, 109
  s_cbranch_scc0 L_n446
  s_waitcnt vmcnt(4)
L_n446:
  s_waitcnt vmcnt(6)
L_b446:
  buffer_load_dwordx4 v10, s[32:35], s65 offen offset:2048 nt lds
  s_waitcnt lgkmcnt(0)
  v_max3_f32 v132, v140, v141, v142
  v_max_f32 v132, v132, v143
  v_mul_f32 v133, s71, v132
  v_fma_f32 v140, v140, s71, -v133
  v_fma_f32 v141, v141, s71, -v133
  v_fma_f32 v142, v142, s71, -v133
  v_fma_f32 v143, v143, s71, -v133
  v_exp_f32 v140, v140
  v_exp_f32 v141, v141
  v_exp_f32 v142, v142
  v_exp_f32 v143, v143
  v_mul_f32 v134, v140, v144
  v_fmac_f32 v134, v141, v145
  v_fmac_f32 v134, v142, v146
  v_fmac_f32 v134, v143, v147
  s_waitcnt vmcnt(8)
  s_cbranch_vccnz L_b447
  s_waitcnt vmcnt(7)
  s_bitcmp0_b32 s77, 31
  s_cbranch_scc1 L_b447
  s_cmp_gt_i32 s80, 109
  s_cbranch_scc0 L_n447
  s_waitcnt vmcnt(4)
L_n447:
  s_waitcnt vmcnt(5)
L_b447:
  buffer_load_dwordx4 v11, s[32:35], s65 offen offset:3072 nt lds
  v_rcp_f32 v132, v134
  v_log_f32 v134, v134
  v_mov_b32 v135, s68
  v_add_f32 v134, v133, v134
  v_mul_f32 v132, v132, v27
  v_mul_f32 v176, v140, v132
  v_mul_f32 v177, v141, v132
  v_mul_f32 v178, v142, v132
  v_mul_f32 v179, v143, v132
  v_lshlrev_b32 v136, 3, v1
  s_cmp_eq_u32 s60, 0
  s_cbranch_scc0 L_nolam
  s_mov_b64 exec, 0xff
  buffer_store_dwordx2 v[134:135], v136, s[44:47], s9 offen sc1
  s_mov_b64 exec, -1
L_nolam:
  s_xor_b32 s65, s64, 0x460000
  s_add_u32 m0, s66, 20480
  s_sub_i32 s77, s36, 111
  s_cmp_gt_i32 s14, 110
  s_cselect_b64 vcc, -1, 0
  s_waitcnt vmcnt(8)
  s_cbranch_vccnz L_b448
  s_waitcnt vmcnt(6)
  s_bitcmp0_b32 s77, 31
  s_cbranch_scc1 L_b448
  s_cmp_gt_i32 s80, 110
  s_cbranch_scc0 L_n448
  s_waitcnt vmcnt(4)
L_n448:
  s_waitcnt vmcnt(5)
L_b448:
  buffer_load_dwordx4 v10, s[32:35], s65 offen offset:0 nt lds
  ds_read_b64_tr_b16 a[34:35], v16 offset:8192
  ds_read_b64_tr_b16 a[38:39], v17 offset:8192
  ds_read_b64_tr_b16 a[42:43], v18 offset:8192
  ds_read_b64_tr_b16 a[46:47], v19 offset:8192
  ds_read_b64_tr_b16 a[50:51], v20 offset:8192
  ds_read_b64_tr_b16 a[54:55], v21 offset:8192
  ds_read_b64_tr_b16 a[58:59], v22 offset:8192
  ds_read_b64_tr_b16 a[62:63], v23 offset:8192
  s_waitcnt vmcnt(7)
  s_cbranch_vccnz L_b449
  s_waitcnt vmcnt(6)
  s_bitcmp0_b32 s77, 31
  s_cbranch_scc1 L_b449
  s_cmp_gt_i32 s80, 110
  s_cbranch_scc0 L_n449
  s_waitcnt vmcnt(4)
L_n449:
  s_waitcnt vmcnt(5)
L_b449:
  buffer_load_dwordx4 v11, s[32:35], s65 offen offset:1024 nt lds
  s_cmp_eq_u32 s15, 2
  s_cselect_b32 s18, s16, 0x400000
  v_or_b32 v8, 110, v9
  buffer_store_dword v8, v6, s[44:47], s18 offen
  s_waitcnt lgkmcnt(0)
  v_mfma_f32_16x16x32_bf16 a[96:99], a[32:35], v[88:91], a[96:99]
  v_mfma_f32_16x16x32_bf16 a[100:103], a[36:39], v[88:91], a[100:103]
  v_mfma_f32_16x16x32_bf16 a[104:107], a[40:43], v[88:91], a[104:107]
  v_mfma_f32_16x16x32_bf16 a[108:111], a[44:47], v[88:91], a[108:111]
  s_waitcnt vmcnt(8)
  s_cbranch_vccnz L_b450
  s_waitcnt vmcnt(7)
  s_bitcmp0_b32 s77, 31
  s_cbranch_scc1 L_b450
  s_cmp_gt_i32 s80, 110
  s_cbranch_scc0 L_n450
  s_waitcnt vmcnt(4)
L_n450:
  s_waitcnt vmcnt(6)
L_b450:
  buffer_load_dwordx4 v10, s[32:35], s65 offen offset:2048 nt lds
  buffer_load_dword v50, v7, s[44:47], 0 offen sc1
  v_mfma_f32_16x16x32_bf16 a[112:115], a[48:51], v[88:91], a[112:115]
  v_mfma_f32_16x16x32_bf16 a[116:119], a[52:55], v[88:91], a[116:119]
  v_mfma_f32_16x16x32_bf16 a[120:123], a[56:59], v[88:91], a[120:123]
  v_mfma_f32_16x16x32_bf16 a[124:127], a[60:63], v[88:91], a[124:127]
  s_waitcnt vmcnt(9)
  s_cbranch_vccnz L_b451
  s_waitcnt vmcnt(8)
  s_bitcmp0_b32 s77, 31
  s_cbranch_scc1 L_b451
  s_cmp_gt_i32 s80, 110
  s_cbranch_scc0 L_n451
  s_waitcnt vmcnt(5)
L_n451:
  s_waitcnt vmcnt(6)
L_b451:
  buffer_load_dwordx4 v11, s[32:35], s65 offen offset:3072 nt lds
  s_xor_b32 s65, s64, 0x464000
  s_add_u32 m0, s66, 24576
  s_sub_i32 s77, s36, 112
  s_cmp_gt_i32 s14, 111
  s_cselect_b64 vcc, -1, 0
  s_waitcnt vmcnt(9)
  s_cbranch_vccnz L_b452
  s_waitcnt vmcnt(7)
  s_bitcmp0_b32 s77, 31
  s_cbranch_scc1 L_b452
  s_cmp_gt_i32 s80, 111
  s_cbranch_scc0 L_n452
  s_waitcnt vmcnt(5)
L_n452:
  s_waitcnt vmcnt(6)
L_b452:
  buffer_load_dwordx4 v10, s[32:35], s65 offen offset:0 nt lds
  s_waitcnt vmcnt(8)
  s_cbranch_vccnz L_b453
  s_waitcnt vmcnt(7)
  s_bitcmp0_b32 s77, 31
  s_cbranch_scc1 L_b453
  s_cmp_gt_i32 s80, 111
  s_cbranch_scc0 L_n453
  s_waitcnt vmcnt(5)
L_n453:
  s_waitcnt vmcnt(6)
L_b453:
  buffer_load_dwordx4 v11, s[32:35], s65 offen offset:1024 nt lds
  s_cmp_eq_u32 s15, 3
  s_cselect_b32 s18, s16, 0x400000
  v_or_b32 v8, 111, v9
  buffer_store_dword v8, v6, s[44:47], s18 offen
  ds_read_b64_tr_b16 a[32:33], v16 offset:12288
  ds_read_b64_tr_b16 a[36:37], v17 offset:12288
  ds_read_b64_tr_b16 a[40:41], v18 offset:12288
  ds_read_b64_tr_b16 a[44:45], v19 offset:12288
  ds_read_b64_tr_b16 a[48:49], v20 offset:12288
  ds_read_b64_tr_b16 a[52:53], v21 offset:12288
  ds_read_b64_tr_b16 a[56:57], v22 offset:12288
  ds_read_b64_tr_b16 a[60:61], v23 offset:12288
  s_waitcnt vmcnt(9)
  s_cbranch_vccnz L_b454
  s_waitcnt vmcnt(8)
  s_bitcmp0_b32 s77, 31
  s_cbranch_scc1 L_b454
  s_cmp_gt_i32 s80, 111
  s_cbranch_scc0 L_n454
  s_waitcnt vmcnt(5)
L_n454:
  s_waitcnt vmcnt(7)
L_b454:
  buffer_load_dwordx4 v10, s[32:35], s65 offen offset:2048 nt lds
  s_waitcnt vmcnt(9)
  s_cbranch_vccnz L_b455
  s_waitcnt vmcnt(8)
  s_bitcmp0_b32 s77, 31
  s_cbranch_scc1 L_b455
  s_cmp_gt_i32 s80, 111
  s_cbranch_scc0 L_n455
  s_waitcnt vmcnt(4)
L_n455:
  s_waitcnt vmcnt(6)
L_b455:
  buffer_load_dwordx4 v11, s[32:35], s65 offen offset:3072 nt lds
  s_xor_b32 s65, s64, 0x80000
  s_add_u32 m0, s66, 0
  s_sub_i32 s77, s36, 113
  s_cmp_gt_i32 s14, 112
  s_cselect_b64 vcc, -1, 0
  s_waitcnt vmcnt(9)
  s_cbranch_vccnz L_b456
  s_waitcnt vmcnt(7)
  s_bitcmp0_b32 s77, 31
  s_cbranch_scc1 L_b456
  s_cmp_gt_i32 s80, 112
  s_cbranch_scc0 L_n456
  s_waitcnt vmcnt(4)
L_n456:
  s_waitcnt vmcnt(5)
L_b456:
  buffer_load_dwordx4 v10, s[32:35], s65 offen offset:0 nt lds
  s_waitcnt vmcnt(8)
  s_cbranch_vccnz L_b457
  s_waitcnt vmcnt(6)
  s_bitcmp0_b32 s77, 31
  s_cbranch_scc1 L_b457
  s_cmp_gt_i32 s80, 112
  s_cbranch_scc0 L_n457
  s_waitcnt vmcnt(4)
L_n457:
  s_waitcnt vmcnt(5)
L_b457:
  buffer_load_dwordx4 v11, s[32:35], s65 offen offset:1024 nt lds
  s_cmp_eq_u32 s15, 0
  s_cselect_b32 s18, s16, 0x400000
  v_or_b32 v8, 112, v9
  buffer_store_dword v8, v6, s[44:47], s18 offen
  ds_read_b64_tr_b16 a[34:35], v16 offset:16384
  ds_read_b64_tr_b16 a[38:39], v17 offset:16384
  ds_read_b64_tr_b16 a[42:43], v18 offset:16384
  ds_read_b64_tr_b16 a[46:47], v19 offset:16384
  ds_read_b64_tr_b16 a[50:51], v20 offset:16384
  ds_read_b64_tr_b16 a[54:55], v21 offset:16384
  ds_read_b64_tr_b16 a[58:59], v22 offset:16384
  ds_read_b64_tr_b16 a[62:63], v23 offset:16384
  s_waitcnt vmcnt(8)
  s_cbranch_vccnz L_b458
  s_waitcnt vmcnt(7)
  s_bitcmp0_b32 s77, 31
  s_cbranch_scc1 L_b458
  s_cmp_gt_i32 s80, 112
  s_cbranch_scc0 L_n458
  s_waitcnt vmcnt(4)
L_n458:
  s_waitcnt vmcnt(6)
L_b458:
  buffer_load_dwordx4 v10, s[32:35], s65 offen offset:2048 nt lds
  v_xor_b32 v50, s17, v50
  v_lshrrev_b32 v51, 8, v50
  v_readlane_b32 s100, v50, 37
  s_cmp_lt_u32 s100, 256
  s_cselect_b32 s100, s100, 128
  s_add_i32 s36, s100, -15
  s_sub_i32 s3, 122, s100
  s_ashr_i32 s3, s3, 2
  s_add_i32 s3, s3, 113
  v_cmp_eq_u32 s[82:83], 0, v51
  v_mov_b32 v51, 108
  s_nop 0
  v_cndmask_b32 v50, v51, v50, s[82:83]
  s_nop 1
  v_add_u32_dpp v50, v50, v50 row_ror:1 row_mask:0xf bank_mask:0xf
  s_nop 1
  v_add_u32_dpp v50, v50, v50 row_ror:2 row_mask:0xf bank_mask:0xf
  s_nop 1
  v_add_u32_dpp v50, v50, v50 row_ror:4 row_mask:0xf bank_mask:0xf
  s_nop 1
  v_add_u32_dpp v50, v50, v50 row_ror:8 row_mask:0xf bank_mask:0xf
  s_nop 0
  v_readlane_b32 s100, v50, 0
  v_readlane_b32 s101, v50, 16
  s_add_u32 s100, s100, s101
  s_sub_i32 s100, s100, 3459
  s_ashr_i32 s37, s100, 1
  s_add_i32 s101, s100, 32
  s_mul_i32 s101, s101, -20
  s_ashr_i32 s101, s101, 8
  s_min_i32 s101, s101, 4
  s_add_i32 s80, s101, 113
  s_max_i32 s80, s80, s3
  s_mul_i32 s100, s100, 24
  s_ashr_i32 s100, s100, 8
  s_min_i32 s100, s100, 8
  s_add_i32 s14, s100, 113
  s_waitcnt lgkmcnt(0)
  v_mfma_f32_16x16x32_bf16 a[96:99], a[32:35], v[92:95], a[96:99]
  v_mfma_f32_16x16x32_bf16 a[100:103], a[36:39], v[92:95], a[100:103]
  v_mfma_f32_16x16x32_bf16 a[104:107], a[40:43], v[92:95], a[104:107]
  v_mfma_f32_16x16x32_bf16 a[108:111], a[44:47], v[92:95], a[108:111]
  s_waitcnt vmcnt(8)
  s_cbranch_vccnz L_b459
  s_waitcnt vmcnt(7)
  s_bitcmp0_b32 s77, 31
  s_cbranch_scc1 L_b459
  s_cmp_gt_i32 s80, 112
  s_cbranch_scc0 L_n459
  s_waitcnt vmcnt(4)
L_n459:
  s_waitcnt vmcnt(5)
L_b459:
  buffer_load_dwordx4 v11, s[32:35], s65 offen offset:3072 nt lds
  v_mfma_f32_16x16x32_bf16 a[112:115], a[48:51], v[92:95], a[112:115]
  v_mfma_f32_16x16x32_bf16 a[116:119], a[52:55], v[92:95], a[116:119]
  v_mfma_f32_16x16x32_bf16 a[120:123], a[56:59], v[92:95], a[120:123]
  v_mfma_f32_16x16x32_bf16 a[124:127], a[60:63], v[92:95], a[124:127]
  s_xor_b32 s65, s64, 0x84000
  s_add_u32 m0, s66, 4096
  s_sub_i32 s77, s36, 114
  s_cmp_gt_i32 s14, 113
  s_cselect_b64 vcc, -1, 0
  s_waitcnt vmcnt(8)
  s_cbranch_vccnz L_b460
  s_waitcnt vmcnt(6)
  s_bitcmp0_b32 s77, 31
  s_cbranch_scc1 L_b460
  s_cmp_gt_i32 s80, 113
  s_cbranch_scc0 L_n460
  s_waitcnt vmcnt(4)
L_n460:
  s_waitcnt vmcnt(5)
L_b460:
  buffer_load_dwordx4 v10, s[32:35], s65 offen offset:0 nt lds
  ds_read_b64_tr_b16 a[32:33], v16 offset:20480
  ds_read_b64_tr_b16 a[36:37], v17 offset:20480
  ds_read_b64_tr_b16 a[40:41], v18 offset:20480
  ds_read_b64_tr_b16 a[44:45], v19 offset:20480
  ds_read_b64_tr_b16 a[48:49], v20 offset:20480
  ds_read_b64_tr_b16 a[52:53], v21 offset:20480
  ds_read_b64_tr_b16 a[56:57], v22 offset:20480
  ds_read_b64_tr_b16 a[60:61], v23 offset:20480
  s_waitcnt vmcnt(7)
  s_cbranch_vccnz L_b461
  s_waitcnt vmcnt(6)
  s_bitcmp0_b32 s77, 31
  s_cbranch_scc1 L_b461
  s_cmp_gt_i32 s80, 113
  s_cbranch_scc0 L_n461
  s_waitcnt vmcnt(4)
L_n461:
  s_waitcnt vmcnt(5)
L_b461:
  buffer_load_dwordx4 v11, s[32:35], s65 offen offset:1024 nt lds
  s_cmp_eq_u32 s15, 1
  s_cselect_b32 s18, s16, 0x400000
  v_or_b32 v8, 113, v9
  buffer_store_dword v8, v6, s[44:47], s18 offen
  s_waitcnt vmcnt(8)
  s_cbranch_vccnz L_b462
  s_waitcnt vmcnt(7)
  s_bitcmp0_b32 s77, 31
  s_cbranch_scc1 L_b462
  s_cmp_gt_i32 s80, 113
  s_cbranch_scc0 L_n462
  s_waitcnt vmcnt(4)
L_n462:
  s_waitcnt vmcnt(6)
L_b462:
  buffer_load_dwordx4 v10, s[32:35], s65 offen offset:2048 nt lds
  s_waitcnt vmcnt(8)
  s_cbranch_vccnz L_b463
  s_waitcnt vmcnt(7)
  s_bitcmp0_b32 s77, 31
  s_cbranch_scc1 L_b463
  s_cmp_gt_i32 s80, 113
  s_cbranch_scc0 L_n463
  s_waitcnt vmcnt(4)
L_n463:
  s_waitcnt vmcnt(5)
L_b463:
  buffer_load_dwordx4 v11, s[32:35], s65 offen offset:3072 nt lds
  s_xor_b32 s65, s64, 0x480000
  s_add_u32 m0, s66, 8192
  s_sub_i32 s77, s36, 115
  s_cmp_gt_i32 s14, 114
  s_cselect_b64 vcc, -1, 0
  s_waitcnt vmcnt(8)
  s_cbranch_vccnz L_b464
  s_waitcnt vmcnt(6)
  s_bitcmp0_b32 s77, 31
  s_cbranch_scc1 L_b464
  s_cmp_gt_i32 s80, 114
  s_cbranch_scc0 L_n464
  s_waitcnt vmcnt(4)
L_n464:
  s_waitcnt vmcnt(5)
L_b464:
  buffer_load_dwordx4 v10, s[32:35], s65 offen offset:0 nt lds
  ds_read_b64_tr_b16 a[34:35], v16 offset:24576
  ds_read_b64_tr_b16 a[38:39], v17 offset:24576
  ds_read_b64_tr_b16 a[42:43], v18 offset:24576
  ds_read_b64_tr_b16 a[46:47], v19 offset:24576
  ds_read_b64_tr_b16 a[50:51], v20 offset:24576
  ds_read_b64_tr_b16 a[54:55], v21 offset:24576
  ds_read_b64_tr_b16 a[58:59], v22 offset:24576
  ds_read_b64_tr_b16 a[62:63], v23 offset:24576
  s_waitcnt vmcnt(7)
  s_cbranch_vccnz L_b465
  s_waitcnt vmcnt(6)
  s_bitcmp0_b32 s77, 31
  s_cbranch_scc1 L_b465
  s_cmp_gt_i32 s80, 114
  s_cbranch_scc0 L_n465
  s_waitcnt vmcnt(4)
L_n465:
  s_waitcnt vmcnt(5)
L_b465:
  buffer_load_dwordx4 v11, s[32:35], s65 offen offset:1024 nt lds
  s_cmp_eq_u32 s15, 2
  s_cselect_b32 s18, s16, 0x400000
  v_or_b32 v8, 114, v9
  buffer_store_dword v8, v6, s[44:47], s18 offen
  s_waitcnt lgkmcnt(0)
  v_mfma_f32_16x16x32_bf16 a[96:99], a[32:35], v[96:99], a[96:99]
  v_mfma_f32_16x16x32_bf16 a[100:103], a[36:39], v[96:99], a[100:103]
  v_mfma_f32_16x16x32_bf16 a[104:107], a[40:43], v[96:99], a[104:107]
  v_mfma_f32_16x16x32_bf16 a[108:111], a[44:47], v[96:99], a[108:111]
  s_waitcnt vmcnt(8)
  s_cbranch_vccnz L_b466
  s_waitcnt vmcnt(7)
  s_bitcmp0_b32 s77, 31
  s_cbranch_scc1 L_b466
  s_cmp_gt_i32 s80, 114
  s_cbranch_scc0 L_n466
  s_waitcnt vmcnt(4)
L_n466:
  s_waitcnt vmcnt(6)
L_b466:
  buffer_load_dwordx4 v10, s[32:35], s65 offen offset:2048 nt lds
  buffer_load_dword v50, v7, s[44:47], 0 offen sc1
  v_mfma_f32_16x16x32_bf16 a[112:115], a[48:51], v[96:99], a[112:115]
  v_mfma_f32_16x16x32_bf16 a[116:119], a[52:55], v[96:99], a[116:119]
  v_mfma_f32_16x16x32_bf16 a[120:123], a[56:59], v[96:99], a[120:123]
  v_mfma_f32_16x16x32_bf16 a[124:127], a[60:63], v[96:99], a[124:127]
  s_waitcnt vmcnt(9)
  s_cbranch_vccnz L_b467
  s_waitcnt vmcnt(8)
  s_bitcmp0_b32 s77, 31
  s_cbranch_scc1 L_b467
  s_cmp_gt_i32 s80, 114
  s_cbranch_scc0 L_n467
  s_waitcnt vmcnt(5)
L_n467:
  s_waitcnt vmcnt(6)
L_b467:
  buffer_load_dwordx4 v11, s[32:35], s65 offen offset:3072 nt lds
  s_xor_b32 s65, s64, 0x484000
  s_add_u32 m0, s66, 12288
  s_sub_i32 s77, s36, 116
  s_cmp_gt_i32 s14, 115
  s_cselect_b64 vcc, -1, 0
  s_waitcnt vmcnt(9)
  s_cbranch_vccnz L_b468
  s_waitcnt vmcnt(7)
  s_bitcmp0_b32 s77, 31
  s_cbranch_scc1 L_b468
  s_cmp_gt_i32 s80, 115
  s_cbranch_scc0 L_n468
  s_waitcnt vmcnt(5)
L_n468:
  s_waitcnt vmcnt(6)
L_b468:
  buffer_load_dwordx4 v10, s[32:35], s65 offen offset:0 nt lds
  s_waitcnt vmcnt(8)
  s_cbranch_vccnz L_b469
  s_waitcnt vmcnt(7)
  s_bitcmp0_b32 s77, 31
  s_cbranch_scc1 L_b469
  s_cmp_gt_i32 s80, 115
  s_cbranch_scc0 L_n469
  s_waitcnt vmcnt(5)
L_n469:
  s_waitcnt vmcnt(6)
L_b469:
  buffer_load_dwordx4 v11, s[32:35], s65 offen offset:1024 nt lds
  s_cmp_eq_u32 s15, 3
  s_cselect_b32 s18, s16, 0x400000
  v_or_b32 v8, 115, v9
  buffer_store_dword v8, v6, s[44:47], s18 offen
  ds_read_b64_tr_b16 a[32:33], v16 offset:0
  ds_read_b64_tr_b16 a[36:37], v17 offset:0
  ds_read_b64_tr_b16 a[40:41], v18 offset:0
  ds_read_b64_tr_b16 a[44:45], v19 offset:0
  ds_read_b64_tr_b16 a[48:49], v20 offset:0
  ds_read_b64_tr_b16 a[52:53], v21 offset:0
  ds_read_b64_tr_b16 a[56:57], v22 offset:0
  ds_read_b64_tr_b16 a[60:61], v23 offset:0
  s_waitcnt vmcnt(9)
  s_cbranch_vccnz L_b470
  s_waitcnt vmcnt(8)
  s_bitcmp0_b32 s77, 31
  s_cbranch_scc1 L_b470
  s_cmp_gt_i32 s80, 115
  s_cbranch_scc0 L_n470
  s_waitcnt vmcnt(5)
L_n470:
  s_waitcnt vmcnt(7)
L_b470:
  buffer_load_dwordx4 v10, s[32:35], s65 offen offset:2048 nt lds
  s_waitcnt vmcnt(9)
  s_cbranch_vccnz L_b471
  s_waitcnt vmcnt(8)
  s_bitcmp0_b32 s77, 31
  s_cbranch_scc1 L_b471
  s_cmp_gt_i32 s80, 115
  s_cbranch_scc0 L_n471
  s_waitcnt vmcnt(4)
L_n471:
  s_waitcnt vmcnt(6)
L_b471:
  buffer_load_dwordx4 v11, s[32:35], s65 offen offset:3072 nt lds
  s_xor_b32 s65, s64, 0xa0000
  s_add_u32 m0, s66, 16384
  s_sub_i32 s77, s36, 117
  s_cmp_gt_i32 s14, 116
  s_cselect_b64 vcc, -1, 0
  s_waitcnt vmcnt(9)
  s_cbranch_vccnz L_b472
  s_waitcnt vmcnt(7)
  s_bitcmp0_b32 s77, 31
  s_cbranch_scc1 L_b472
  s_cmp_gt_i32 s80, 116
  s_cbranch_scc0 L_n472
  s_waitcnt vmcnt(4)
L_n472:
  s_waitcnt vmcnt(5)
L_b472:
  buffer_load_dwordx4 v10, s[32:35], s65 offen offset:0 nt lds
  s_waitcnt vmcnt(8)
  s_cbranch_vccnz L_b473
  s_waitcnt vmcnt(6)
  s_bitcmp0_b32 s77, 31
  s_cbranch_scc1 L_b473
  s_cmp_gt_i32 s80, 116
  s_cbranch_scc0 L_n473
  s_waitcnt vmcnt(4)
L_n473:
  s_waitcnt vmcnt(5)
L_b473:
  buffer_load_dwordx4 v11, s[32:35], s65 offen offset:1024 nt lds
  s_cmp_eq_u32 s15, 0
  s_cselect_b32 s18, s16, 0x400000
  v_or_b32 v8, 116, v9
  buffer_store_dword v8, v6, s[44:47], s18 offen
  ds_read_b64_tr_b16 a[34:35], v16 offset:4096
  ds_read_b64_tr_b16 a[38:39], v17 offset:4096
  ds_read_b64_tr_b16 a[42:43], v18 offset:4096
  ds_read_b64_tr_b16 a[46:47], v19 offset:4096
  ds_read_b64_tr_b16 a[50:51], v20 offset:4096
  ds_read_b64_tr_b16 a[54:55], v21 offset:4096
  ds_read_b64_tr_b16 a[58:59], v22 offset:4096
  ds_read_b64_tr_b16 a[62:63], v23 offset:4096
  s_waitcnt vmcnt(8)
  s_cbranch_vccnz L_b474
  s_waitcnt vmcnt(7)
  s_bitcmp0_b32 s77, 31
  s_cbranch_scc1 L_b474
  s_cmp_gt_i32 s80, 116
  s_cbranch_scc0 L_n474
  s_waitcnt vmcnt(4)
L_n474:
  s_waitcnt vmcnt(6)
L_b474:
  buffer_load_dwordx4 v10, s[32:35], s65 offen offset:2048 nt lds
  v_xor_b32 v50, s17, v50
  v_lshrrev_b32 v51, 8, v50
  v_cmp_eq_u32 s[82:83], 0, v51
  v_mov_b32 v51, 112
  s_nop 0
  v_cndmask_b32 v50, v51, v50, s[82:83]
  s_nop 1
  v_add_u32_dpp v50, v50, v50 row_ror:1 row_mask:0xf bank_mask:0xf
  s_nop 1
  v_add_u32_dpp v50, v50, v50 row_ror:2 row_mask:0xf bank_mask:0xf
  s_nop 1
  v_add_u32_dpp v50, v50, v50 row_ror:4 row_mask:0xf bank_mask:0xf
  s_nop 1
  v_add_u32_dpp v50, v50, v50 row_ror:8 row_mask:0xf bank_mask:0xf
  s_nop 0
  v_readlane_b32 s100, v50, 0
  v_readlane_b32 s101, v50, 16
  s_add_u32 s100, s100, s101
  s_sub_i32 s100, s100, 3587
  s_ashr_i32 s37, s100, 1
  s_add_i32 s101, s100, 32
  s_mul_i32 s101, s101, -20
  s_ashr_i32 s101, s101, 8
  s_min_i32 s101, s101, 4
  s_add_i32 s80, s101, 117
  s_max_i32 s80, s80, s3
  s_mul_i32 s100, s100, 24
  s_ashr_i32 s100, s100, 8
  s_min_i32 s100, s100, 8
  s_add_i32 s14, s100, 117
  s_waitcnt lgkmcnt(0)
  v_mfma_f32_16x16x32_bf16 a[96:99], a[32:35], v[100:103], a[96:99]
  v_mfma_f32_16x16x32_bf16 a[100:103], a[36:39], v[100:103], a[100:103]
  v_mfma_f32_16x16x32_bf16 a[104:107], a[40:43], v[100:103], a[104:107]
  v_mfma_f32_16x16x32_bf16 a[108:111], a[44:47], v[100:103], a[108:111]
  s_waitcnt vmcnt(8)
  s_cbranch_vccnz L_b475
  s_waitcnt vmcnt(7)
  s_bitcmp0_b32 s77, 31
  s_cbranch_scc1 L_b475
  s_cmp_gt_i32 s80, 116
  s_cbranch_scc0 L_n475
  s_waitcnt vmcnt(4)
L_n475:
  s_waitcnt vmcnt(5)
L_b475:
  buffer_load_dwordx4 v11, s[32:35], s65 offen offset:3072 nt lds
  v_mfma_f32_16x16x32_bf16 a[112:115], a[48:51], v[100:103], a[112:115]
  v_mfma_f32_16x16x32_bf16 a[116:119], a[52:55], v[100:103], a[116:119]
  v_mfma_f32_16x16x32_bf16 a[120:123], a[56:59], v[100:103], a[120:123]
  v_mfma_f32_16x16x32_bf16 a[124:127], a[60:63], v[100:103], a[124:127]
  s_xor_b32 s65, s64, 0xa4000
  s_add_u32 m0, s66, 20480
  s_sub_i32 s77, s36, 118
  s_cmp_gt_i32 s14, 117
  s_cselect_b64 vcc, -1, 0
  s_waitcnt vmcnt(8)
  s_cbranch_vccnz L_b476
  s_waitcnt vmcnt(6)
  s_bitcmp0_b32 s77, 31
  s_cbranch_scc1 L_b476
  s_cmp_gt_i32 s80, 117
  s_cbranch_scc0 L_n476
  s_waitcnt vmcnt(4)
L_n476:
  s_waitcnt vmcnt(5)
L_b476:
  buffer_load_dwordx4 v10, s[32:35], s65 offen offset:0 nt lds
  ds_read_b64_tr_b16 a[32:33], v16 offset:8192
  ds_read_b64_tr_b16 a[36:37], v17 offset:8192
  ds_read_b64_tr_b16 a[40:41], v18 offset:8192
  ds_read_b64_tr_b16 a[44:45], v19 offset:8192
  ds_read_b64_tr_b16 a[48:49], v20 offset:8192
  ds_read_b64_tr_b16 a[52:53], v21 offset:8192
  ds_read_b64_tr_b16 a[56:57], v22 offset:8192
  ds_read_b64_tr_b16 a[60:61], v23 offset:8192
  s_waitcnt vmcnt(7)
  s_cbranch_vccnz L_b477
  s_waitcnt vmcnt(6)
  s_bitcmp0_b32 s77, 31
  s_cbranch_scc1 L_b477
  s_cmp_gt_i32 s80, 117
  s_cbranch_scc0 L_n477
  s_waitcnt vmcnt(4)
L_n477:
  s_waitcnt vmcnt(5)
L_b477:
  buffer_load_dwordx4 v11, s[32:35], s65 offen offset:1024 nt lds
  s_cmp_eq_u32 s15, 1
  s_cselect_b32 s18, s16, 0x400000
  v_or_b32 v8, 117, v9
  buffer_store_dword v8, v6, s[44:47], s18 offen
  s_waitcnt vmcnt(8)
  s_cbranch_vccnz L_b478
  s_waitcnt vmcnt(7)
  s_bitcmp0_b32 s77, 31
  s_cbranch_scc1 L_b478
  s_cmp_gt_i32 s80, 117
  s_cbranch_scc0 L_n478
  s_waitcnt vmcnt(4)
L_n478:
  s_waitcnt vmcnt(6)
L_b478:
  buffer_load_dwordx4 v10, s[32:35], s65 offen offset:2048 nt lds
  s_waitcnt vmcnt(8)
  s_cbranch_vccnz L_b479
  s_waitcnt vmcnt(7)
  s_bitcmp0_b32 s77, 31
  s_cbranch_scc1 L_b479
  s_cmp_gt_i32 s80, 117
  s_cbranch_scc0 L_n479
  s_waitcnt vmcnt(4)
L_n479:
  s_waitcnt vmcnt(5)
L_b479:
  buffer_load_dwordx4 v11, s[32:35], s65 offen offset:3072 nt lds
  s_xor_b32 s65, s64, 0x4a0000
  s_add_u32 m0, s66, 24576
  s_sub_i32 s77, s36, 119
  s_cmp_gt_i32 s14, 118
  s_cselect_b64 vcc, -1, 0
  s_waitcnt vmcnt(8)
  s_cbranch_vccnz L_b480
  s_waitcnt vmcnt(6)
  s_bitcmp0_b32 s77, 31
  s_cbranch_scc1 L_b480
  s_cmp_gt_i32 s80, 118
  s_cbranch_scc0 L_n480
  s_waitcnt vmcnt(4)
L_n480:
  s_waitcnt vmcnt(5)
L_b480:
  buffer_load_dwordx4 v10, s[32:35], s65 offen offset:0 nt lds
  ds_read_b64_tr_b16 a[34:35], v16 offset:12288
  ds_read_b64_tr_b16 a[38:39], v17 offset:12288
  ds_read_b64_tr_b16 a[42:43], v18 offset:12288
  ds_read_b64_tr_b16 a[46:47], v19 offset:12288
  ds_read_b64_tr_b16 a[50:51], v20 offset:12288
  ds_read_b64_tr_b16 a[54:55], v21 offset:12288
  ds_read_b64_tr_b16 a[58:59], v22 offset:12288
  ds_read_b64_tr_b16 a[62:63], v23 offset:12288
  s_waitcnt vmcnt(7)
  s_cbranch_vccnz L_b481
  s_waitcnt vmcnt(6)
  s_bitcmp0_b32 s77, 31
  s_cbranch_scc1 L_b481
  s_cmp_gt_i32 s80, 118
  s_cbranch_scc0 L_n481
  s_waitcnt vmcnt(4)
L_n481:
  s_waitcnt vmcnt(5)
L_b481:
  buffer_load_dwordx4 v11, s[32:35], s65 offen offset:1024 nt lds
  s_cmp_eq_u32 s15, 2
  s_cselect_b32 s18, s16, 0x400000
  v_or_b32 v8, 118, v9
  buffer_store_dword v8, v6, s[44:47], s18 offen
  s_waitcnt lgkmcnt(0)
  v_mfma_f32_16x16x32_bf16 a[96:99], a[32:35], v[104:107], a[96:99]
  v_mfma_f32_16x16x32_bf16 a[100:103], a[36:39], v[104:107], a[100:103]
  v_mfma_f32_16x16x32_bf16 a[104:107], a[40:43], v[104:107], a[104:107]
  v_mfma_f32_16x16x32_bf16 a[108:111], a[44:47], v[104:107], a[108:111]
  s_waitcnt vmcnt(8)
  s_cbranch_vccnz L_b482
  s_waitcnt vmcnt(7)
  s_bitcmp0_b32 s77, 31
  s_cbranch_scc1 L_b482
  s_cmp_gt_i32 s80, 118
  s_cbranch_scc0 L_n482
  s_waitcnt vmcnt(4)
L_n482:
  s_waitcnt vmcnt(6)
L_b482:
  buffer_load_dwordx4 v10, s[32:35], s65 offen offset:2048 nt lds
  buffer_load_dword v50, v7, s[44:47], 0 offen sc1
  v_mfma_f32_16x16x32_bf16 a[112:115], a[48:51], v[104:107], a[112:115]
  v_mfma_f32_16x16x32_bf16 a[116:119], a[52:55], v[104:107], a[116:119]
  v_mfma_f32_16x16x32_bf16 a[120:123], a[56:59], v[104:107], a[120:123]
  v_mfma_f32_16x16x32_bf16 a[124:127], a[60:63], v[104:107], a[124:127]
  s_waitcnt vmcnt(9)
  s_cbranch_vccnz L_b483
  s_waitcnt vmcnt(8)
  s_bitcmp0_b32 s77, 31
  s_cbranch_scc1 L_b483
  s_cmp_gt_i32 s80, 118
  s_cbranch_scc0 L_n483
  s_waitcnt vmcnt(5)
L_n483:
  s_waitcnt vmcnt(6)
L_b483:
  buffer_load_dwordx4 v11, s[32:35], s65 offen offset:3072 nt lds
  s_xor_b32 s65, s64, 0x4a4000
  s_add_u32 m0, s66, 0
  s_sub_i32 s77, s36, 120
  s_cmp_gt_i32 s14, 119
  s_cselect_b64 vcc, -1, 0
  s_waitcnt vmcnt(9)
  s_cbranch_vccnz L_b484
  s_waitcnt vmcnt(7)
  s_bitcmp0_b32 s77, 31
  s_cbranch_scc1 L_b484
  s_cmp_gt_i32 s80, 119
  s_cbranch_scc0 L_n484
  s_waitcnt vmcnt(5)
L_n484:
  s_waitcnt vmcnt(6)
L_b484:
  buffer_load_dwordx4 v10, s[32:35], s65 offen offset:0 nt lds
  buffer_load_dwordx2 v[140:141], v47, s[44:47], s10 offen sc1
  s_waitcnt vmcnt(9)
  s_cbranch_vccnz L_b485
  s_waitcnt vmcnt(8)
  s_bitcmp0_b32 s77, 31
  s_cbranch_scc1 L_b485
  s_cmp_gt_i32 s80, 119
  s_cbranch_scc0 L_n485
  s_waitcnt vmcnt(6)
L_n485:
  s_waitcnt vmcnt(7)
L_b485:
  buffer_load_dwordx4 v11, s[32:35], s65 offen offset:1024 nt lds
  s_cmp_eq_u32 s15, 3
  s_cselect_b32 s18, s16, 0x400000
  v_or_b32 v8, 119, v9
  buffer_store_dword v8, v6, s[44:47], s18 offen
  ds_read_b64_tr_b16 a[32:33], v16 offset:16384
  ds_read_b64_tr_b16 a[36:37], v17 offset:16384
  ds_read_b64_tr_b16 a[40:41], v18 offset:16384
  ds_read_b64_tr_b16 a[44:45], v19 offset:16384
  ds_read_b64_tr_b16 a[48:49], v20 offset:16384
  ds_read_b64_tr_b16 a[52:53], v21 offset:16384
  ds_read_b64_tr_b16 a[56:57], v22 offset:16384
  ds_read_b64_tr_b16 a[60:61], v23 offset:16384
  s_waitcnt vmcnt(10)
  s_cbranch_vccnz L_b486
  s_waitcnt vmcnt(9)
  s_bitcmp0_b32 s77, 31
  s_cbranch_scc1 L_b486
  s_cmp_gt_i32 s80, 119
  s_cbranch_scc0 L_n486
  s_waitcnt vmcnt(6)
L_n486:
  s_waitcnt vmcnt(8)
L_b486:
  buffer_load_dwordx4 v10, s[32:35], s65 offen offset:2048 nt lds
  s_waitcnt vmcnt(10)
  s_cbranch_vccnz L_b487
  s_waitcnt vmcnt(9)
  s_bitcmp0_b32 s77, 31
  s_cbranch_scc1 L_b487
  s_cmp_gt_i32 s80, 119
  s_cbranch_scc0 L_n487
  s_waitcnt vmcnt(5)
L_n487:
  s_waitcnt vmcnt(7)
L_b487:
  buffer_load_dwordx4 v11, s[32:35], s65 offen offset:3072 nt lds
  s_xor_b32 s65, s64, 0xc0000
  s_add_u32 m0, s66, 4096
  s_sub_i32 s77, s36, 121
  s_cmp_gt_i32 s14, 120
  s_cselect_b64 vcc, -1, 0
  s_waitcnt vmcnt(10)
  s_cbranch_vccnz L_b488
  s_waitcnt vmcnt(8)
  s_bitcmp0_b32 s77, 31
  s_cbranch_scc1 L_b488
  s_cmp_gt_i32 s80, 120
  s_cbranch_scc0 L_n488
  s_waitcnt vmcnt(5)
L_n488:
  s_waitcnt vmcnt(6)
L_b488:
  buffer_load_dwordx4 v10, s[32:35], s65 offen offset:0 nt lds
  s_waitcnt vmcnt(9)
  s_cbranch_vccnz L_b489
  s_waitcnt vmcnt(7)
  s_bitcmp0_b32 s77, 31
  s_cbranch_scc1 L_b489
  s_cmp_gt_i32 s80, 120
  s_cbranch_scc0 L_n489
  s_waitcnt vmcnt(4)
L_n489:
  s_waitcnt vmcnt(6)
L_b489:
  buffer_load_dwordx4 v11, s[32:35], s65 offen offset:1024 nt lds
  s_cmp_eq_u32 s15, 0
  s_cselect_b32 s18, s16, 0x400000
  v_or_b32 v8, 120, v9
  buffer_store_dword v8, v6, s[44:47], s18 offen
  ds_read_b64_tr_b16 a[34:35], v16 offset:20480
  ds_read_b64_tr_b16 a[38:39], v17 offset:20480
  ds_read_b64_tr_b16 a[42:43], v18 offset:20480
  ds_read_b64_tr_b16 a[46:47], v19 offset:20480
  ds_read_b64_tr_b16 a[50:51], v20 offset:20480
  ds_read_b64_tr_b16 a[54:55], v21 offset:20480
  ds_read_b64_tr_b16 a[58:59], v22 offset:20480
  ds_read_b64_tr_b16 a[62:63], v23 offset:20480
  s_waitcnt vmcnt(9)
  s_cbranch_vccnz L_b490
  s_waitcnt vmcnt(8)
  s_bitcmp0_b32 s77, 31
  s_cbranch_scc1 L_b490
  s_cmp_gt_i32 s80, 120
  s_cbranch_scc0 L_n490
  s_waitcnt vmcnt(4)
L_n490:
  s_waitcnt vmcnt(6)
L_b490:
  buffer_load_dwordx4 v10, s[32:35], s65 offen offset:2048 nt lds
  v_xor_b32 v50, s17, v50
  v_lshrrev_b32 v51, 8, v50
  v_cmp_eq_u32 s[82:83], 0, v51
  v_mov_b32 v51, 116
  s_nop 0
  v_cndmask_b32 v50, v51, v50, s[82:83]
  s_nop 1
  v_add_u32_dpp v50, v50, v50 row_ror:1 row_mask:0xf bank_mask:0xf
  s_nop 1
  v_add_u32_dpp v50, v50, v50 row_ror:2 row_mask:0xf bank_mask:0xf
  s_nop 1
  v_add_u32_dpp v50, v50, v50 row_ror:4 row_mask:0xf bank_mask:0xf
  s_nop 1
  v_add_u32_dpp v50, v50, v50 row_ror:8 row_mask:0xf bank_mask:0xf
  s_nop 0
  v_readlane_b32 s100, v50, 0
  v_readlane_b32 s101, v50, 16
  s_add_u32 s100, s100, s101
  s_sub_i32 s100, s100, 3715
  s_ashr_i32 s37, s100, 1
  s_add_i32 s101, s100, 32
  s_mul_i32 s101, s101, -20
  s_ashr_i32 s101, s101, 8
  s_min_i32 s101, s101, 4
  s_add_i32 s80, s101, 121
  s_max_i32 s80, s80, s3
  s_mul_i32 s100, s100, 24
  s_ashr_i32 s100, s100, 8
  s_min_i32 s100, s100, 8
  s_add_i32 s14, s100, 121
  s_waitcnt lgkmcnt(0)
  v_mfma_f32_16x16x32_bf16 a[96:99], a[32:35], v[108:111], a[96:99]
  v_mfma_f32_16x16x32_bf16 a[100:103], a[36:39], v[108:111], a[100:103]
  v_mfma_f32_16x16x32_bf16 a[104:107], a[40:43], v[108:111], a[104:107]
  v_mfma_f32_16x16x32_bf16 a[108:111], a[44:47], v[108:111], a[108:111]
  s_waitcnt vmcnt(9)
  s_cbranch_vccnz L_b491
  s_waitcnt vmcnt(7)
  s_bitcmp0_b32 s77, 31
  s_cbranch_scc1 L_b491
  s_cmp_gt_i32 s80, 120
  s_cbranch_scc0 L_n491
  s_waitcnt vmcnt(4)
L_n491:
  s_waitcnt vmcnt(5)
L_b491:
  buffer_load_dwordx4 v11, s[32:35], s65 offen offset:3072 nt lds
  v_mfma_f32_16x16x32_bf16 a[112:115], a[48:51], v[108:111], a[112:115]
  v_mfma_f32_16x16x32_bf16 a[116:119], a[52:55], v[108:111], a[116:119]
  v_mfma_f32_16x16x32_bf16 a[120:123], a[56:59], v[108:111], a[120:123]
  v_mfma_f32_16x16x32_bf16 a[124:127], a[60:63], v[108:111], a[124:127]
  s_xor_b32 s65, s64, 0xc4000
  s_add_u32 m0, s66, 8192
  s_sub_i32 s77, s36, 122
  s_cmp_gt_i32 s14, 121
  s_cselect_b64 vcc, -1, 0
  s_waitcnt vmcnt(8)
  s_cbranch_vccnz L_b492
  s_waitcnt vmcnt(6)
  s_bitcmp0_b32 s77, 31
  s_cbranch_scc1 L_b492
  s_cmp_gt_i32 s80, 121
  s_cbranch_scc0 L_n492
  s_waitcnt vmcnt(4)
L_n492:
  s_waitcnt vmcnt(5)
L_b492:
  buffer_load_dwordx4 v10, s[32:35], s65 offen offset:0 nt lds
  ds_read_b64_tr_b16 a[32:33], v16 offset:24576
  ds_read_b64_tr_b16 a[36:37], v17 offset:24576
  ds_read_b64_tr_b16 a[40:41], v18 offset:24576
  ds_read_b64_tr_b16 a[44:45], v19 offset:24576
  ds_read_b64_tr_b16 a[48:49], v20 offset:24576
  ds_read_b64_tr_b16 a[52:53], v21 offset:24576
  ds_read_b64_tr_b16 a[56:57], v22 offset:24576
  ds_read_b64_tr_b16 a[60:61], v23 offset:24576
  s_waitcnt vmcnt(7)
  s_cbranch_vccnz L_b493
  s_waitcnt vmcnt(6)
  s_bitcmp0_b32 s77, 31
  s_cbranch_scc1 L_b493
  s_cmp_gt_i32 s80, 121
  s_cbranch_scc0 L_n493
  s_waitcnt vmcnt(4)
L_n493:
  s_waitcnt vmcnt(5)
L_b493:
  buffer_load_dwordx4 v11, s[32:35], s65 offen offset:1024 nt lds
  s_cmp_eq_u32 s15, 1
  s_cselect_b32 s18, s16, 0x400000
  v_or_b32 v8, 121, v9
  buffer_store_dword v8, v6, s[44:47], s18 offen
L_lcheck:
  v_cmp_ne_u32 vcc, s68, v141
  s_cbranch_vccnz L_lretry
  v_max_f32_dpp v132, v140, v140 row_ror:1 row_mask:0xf bank_mask:0xf
  s_nop 1
  v_max_f32_dpp v132, v132, v132 row_ror:2 row_mask:0xf bank_mask:0xf
  s_nop 1
  v_max_f32_dpp v132, v132, v132 row_ror:4 row_mask:0xf bank_mask:0xf
  s_nop 1
  v_max_f32_dpp v132, v132, v132 row_ror:8 row_mask:0xf bank_mask:0xf
  v_sub_f32 v132, v140, v132
  v_exp_f32 v132, v132
  s_nop 1
  v_add_f32_dpp v133, v132, v132 row_ror:1 row_mask:0xf bank_mask:0xf
  s_nop 1
  v_add_f32_dpp v133, v133, v133 row_ror:2 row_mask:0xf bank_mask:0xf
  s_nop 1
  v_add_f32_dpp v133, v133, v133 row_ror:4 row_mask:0xf bank_mask:0xf
  s_nop 1
  v_add_f32_dpp v133, v133, v133 row_ror:8 row_mask:0xf bank_mask:0xf
  v_rcp_f32 v133, v133
  s_and_b32 s73, s2, 15
  v_mul_f32 v132, v132, v133
  s_add_u32 s74, s73, 16
  v_readlane_b32 s75, v132, s73
  v_readlane_b32 s76, v132, s74
  v_bfe_i32 v134, v1, 2, 1
  s_waitcnt vmcnt(8)
  s_cbranch_vccnz L_b494
  s_waitcnt vmcnt(7)
  s_bitcmp0_b32 s77, 31
  s_cbranch_scc1 L_b494
  s_cmp_gt_i32 s80, 121
  s_cbranch_scc0 L_n494
  s_waitcnt vmcnt(4)
L_n494:
  s_waitcnt vmcnt(6)
L_b494:
  buffer_load_dwordx4 v10, s[32:35], s65 offen offset:2048 nt lds
  s_add_u32 s74, s60, 4
  v_mov_b32 v132, s75
  v_mov_b32 v133, s76
  v_bfi_b32 v132, v134, v133, v132
  v_mul_f32 v176, v176, v132
  v_mul_f32 v177, v177, v132
  v_mul_f32 v178, v178, v132
  v_mul_f32 v179, v179, v132
  s_nop 0
  v_readlane_b32 s48, v176, s60
  v_readlane_b32 s52, v176, s74
  v_readlane_b32 s49, v177, s60
  v_readlane_b32 s53, v177, s74
  v_readlane_b32 s50, v178, s60
  v_readlane_b32 s54, v178, s74
  v_readlane_b32 s51, v179, s60
  v_readlane_b32 s55, v179, s74
  s_nop 1
  ds_read_b128 v[140:143], v38 offset:0
  ds_read_b128 v[144:147], v38 offset:2048
  ds_read_b128 v[148:151], v38 offset:4096
  ds_read_b128 v[152:155], v38 offset:6144
  s_waitcnt vmcnt(8)
  s_cbranch_vccnz L_b495
  s_waitcnt vmcnt(7)
  s_bitcmp0_b32 s77, 31
  s_cbranch_scc1 L_b495
  s_cmp_gt_i32 s80, 121
  s_cbranch_scc0 L_n495
  s_waitcnt vmcnt(4)
L_n495:
  s_waitcnt vmcnt(5)
L_b495:
  buffer_load_dwordx4 v11, s[32:35], s65 offen offset:3072 nt lds
  s_waitcnt lgkmcnt(0)
  v_mul_f32 v140, s48, v140
  v_mul_f32 v141, s48, v141
  v_mul_f32 v142, s48, v142
  v_mul_f32 v143, s48, v143
  v_fmac_f32 v140, s49, v144
  v_fmac_f32 v141, s49, v145
  v_fmac_f32 v142, s49, v146
  v_fmac_f32 v143, s49, v147
  v_fmac_f32 v140, s50, v148
  v_fmac_f32 v141, s50, v149
  v_fmac_f32 v142, s50, v150
  v_fmac_f32 v143, s50, v151
  v_fmac_f32 v140, s51, v152
  v_fmac_f32 v141, s51, v153
  v_fmac_f32 v142, s51, v154
  v_fmac_f32 v143, s51, v155
  v_add_u32 v140, 0x10000, v140
  v_add_u32 v141, 0x10000, v141
  v_add_u32 v142, 0x10000, v142
  v_add_u32 v143, 0x10000, v143
  v_perm_b32 v166, v141, v140, s4
  v_perm_b32 v167, v143, v142, s4
  v_and_or_b32 v166, v166, s11, v170
  v_and_or_b32 v167, v167, s11, v171
  s_xor_b32 s65, s64, 0x4c0000
  s_add_u32 m0, s66, 12288
  s_sub_i32 s77, s36, 123
  s_cmp_gt_i32 s14, 122
  s_cselect_b64 vcc, -1, 0
  s_waitcnt vmcnt(8)
  s_cbranch_vccnz L_b496
  s_waitcnt vmcnt(6)
  s_bitcmp0_b32 s77, 31
  s_cbranch_scc1 L_b496
  s_cmp_gt_i32 s80, 122
  s_cbranch_scc0 L_n496
  s_waitcnt vmcnt(4)
L_n496:
  s_waitcnt vmcnt(5)
L_b496:
  buffer_load_dwordx4 v10, s[32:35], s65 offen offset:0 nt lds
  ds_read_b64_tr_b16 a[34:35], v16 offset:0
  ds_read_b64_tr_b16 a[38:39], v17 offset:0
  ds_read_b64_tr_b16 a[42:43], v18 offset:0
  ds_read_b64_tr_b16 a[46:47], v19 offset:0
  ds_read_b64_tr_b16 a[50:51], v20 offset:0
  ds_read_b64_tr_b16 a[54:55], v21 offset:0
  ds_read_b64_tr_b16 a[58:59], v22 offset:0
  ds_read_b64_tr_b16 a[62:63], v23 offset:0
  s_waitcnt vmcnt(7)
  s_cbranch_vccnz L_b497
  s_waitcnt vmcnt(6)
  s_bitcmp0_b32 s77, 31
  s_cbranch_scc1 L_b497
  s_cmp_gt_i32 s80, 122
  s_cbranch_scc0 L_n497
  s_waitcnt vmcnt(4)
L_n497:
  s_waitcnt vmcnt(5)
L_b497:
  buffer_load_dwordx4 v11, s[32:35], s65 offen offset:1024 nt lds
  s_waitcnt lgkmcnt(0)
  v_mfma_f32_16x16x32_bf16 a[96:99], a[32:35], v[112:115], a[96:99]
  v_mfma_f32_16x16x32_bf16 a[100:103], a[36:39], v[112:115], a[100:103]
  v_mfma_f32_16x16x32_bf16 a[104:107], a[40:43], v[112:115], a[104:107]
  v_mfma_f32_16x16x32_bf16 a[108:111], a[44:47], v[112:115], a[108:111]
  s_waitcnt vmcnt(7)
  s_cbranch_vccnz L_b498
  s_waitcnt vmcnt(6)
  s_bitcmp0_b32 s77, 31
  s_cbranch_scc1 L_b498
  s_cmp_gt_i32 s80, 122
  s_cbranch_scc0 L_n498
  s_waitcnt vmcnt(3)
L_n498:
  s_waitcnt vmcnt(5)
L_b498:
  buffer_load_dwordx4 v10, s[32:35], s65 offen offset:2048 nt lds
  buffer_load_dword v50, v7, s[44:47], 0 offen sc1
  v_mfma_f32_16x16x32_bf16 a[112:115], a[48:51], v[112:115], a[112:115]
  v_mfma_f32_16x16x32_bf16 a[116:119], a[52:55], v[112:115], a[116:119]
  v_mfma_f32_16x16x32_bf16 a[120:123], a[56:59], v[112:115], a[120:123]
  v_mfma_f32_16x16x32_bf16 a[124:127], a[60:63], v[112:115], a[124:127]
  s_waitcnt vmcnt(8)
  s_cbranch_vccnz L_b499
  s_waitcnt vmcnt(7)
  s_bitcmp0_b32 s77, 31
  s_cbranch_scc1 L_b499
  s_cmp_gt_i32 s80, 122
  s_cbranch_scc0 L_n499
  s_waitcnt vmcnt(4)
L_n499:
  s_waitcnt vmcnt(5)
L_b499:
  buffer_load_dwordx4 v11, s[32:35], s65 offen offset:3072 nt lds
  s_xor_b32 s65, s64, 0x4c4000
  s_add_u32 m0, s66, 16384
  s_sub_i32 s77, s36, 124
  s_cmp_gt_i32 s14, 123
  s_cselect_b64 vcc, -1, 0
  s_waitcnt vmcnt(8)
  s_cbranch_vccnz L_b500
  s_waitcnt vmcnt(6)
  s_bitcmp0_b32 s77, 31
  s_cbranch_scc1 L_b500
  s_cmp_gt_i32 s80, 123
  s_cbranch_scc0 L_n500
  s_waitcnt vmcnt(4)
L_n500:
  s_waitcnt vmcnt(5)
L_b500:
  buffer_load_dwordx4 v10, s[32:35], s65 offen offset:0 nt lds
  ds_read_b64_tr_b16 a[32:33], v16 offset:4096
  ds_read_b64_tr_b16 a[36:37], v17 offset:4096
  ds_read_b64_tr_b16 a[40:41], v18 offset:4096
  ds_read_b64_tr_b16 a[44:45], v19 offset:4096
  ds_read_b64_tr_b16 a[48:49], v20 offset:4096
  ds_read_b64_tr_b16 a[52:53], v21 offset:4096
  ds_read_b64_tr_b16 a[56:57], v22 offset:4096
  ds_read_b64_tr_b16 a[60:61], v23 offset:4096
  s_waitcnt vmcnt(7)
  s_cbranch_vccnz L_b501
  s_waitcnt vmcnt(6)
  s_bitcmp0_b32 s77, 31
  s_cbranch_scc1 L_b501
  s_cmp_gt_i32 s80, 123
  s_cbranch_scc0 L_n501
  s_waitcnt vmcnt(4)
L_n501:
  s_waitcnt vmcnt(5)
L_b501:
  buffer_load_dwordx4 v11, s[32:35], s65 offen offset:1024 nt lds
  s_waitcnt vmcnt(7)
  s_cbranch_vccnz L_b502
  s_waitcnt vmcnt(6)
  s_bitcmp0_b32 s77, 31
  s_cbranch_scc1 L_b502
  s_cmp_gt_i32 s80, 123
  s_cbranch_scc0 L_n502
  s_waitcnt vmcnt(4)
L_n502:
  s_waitcnt vmcnt(5)
L_b502:
  buffer_load_dwordx4 v10, s[32:35], s65 offen offset:2048 nt lds
  s_waitcnt vmcnt(7)
  s_cbranch_vccnz L_b503
  s_waitcnt vmcnt(6)
  s_bitcmp0_b32 s77, 31
  s_cbranch_scc1 L_b503
  s_cmp_gt_i32 s80, 123
  s_cbranch_scc0 L_n503
  s_waitcnt vmcnt(3)
L_n503:
  s_waitcnt vmcnt(5)
L_b503:
  buffer_load_dwordx4 v11, s[32:35], s65 offen offset:3072 nt lds
  ds_read_b64_tr_b16 a[34:35], v16 offset:8192
  ds_read_b64_tr_b16 a[38:39], v17 offset:8192
  ds_read_b64_tr_b16 a[42:43], v18 offset:8192
  ds_read_b64_tr_b16 a[46:47], v19 offset:8192
  ds_read_b64_tr_b16 a[50:51], v20 offset:8192
  ds_read_b64_tr_b16 a[54:55], v21 offset:8192
  ds_read_b64_tr_b16 a[58:59], v22 offset:8192
  ds_read_b64_tr_b16 a[62:63], v23 offset:8192
  s_xor_b32 s65, s64, 0xe0000
  s_add_u32 m0, s66, 20480
  s_sub_i32 s77, s36, 125
  s_cmp_gt_i32 s14, 124
  s_cselect_b64 vcc, -1, 0
  s_waitcnt vmcnt(7)
  s_cbranch_vccnz L_b504
  s_waitcnt vmcnt(6)
  s_bitcmp0_b32 s77, 31
  s_cbranch_scc1 L_b504
  s_cmp_gt_i32 s80, 124
  s_cbranch_scc0 L_n504
  s_waitcnt vmcnt(3)
L_n504:
  s_waitcnt vmcnt(4)
L_b504:
  buffer_load_dwordx4 v10, s[32:35], s65 offen offset:0 nt lds
  s_waitcnt lgkmcnt(0)
  v_mfma_f32_16x16x32_bf16 a[96:99], a[32:35], v[116:119], a[96:99]
  v_mfma_f32_16x16x32_bf16 a[100:103], a[36:39], v[116:119], a[100:103]
  v_mfma_f32_16x16x32_bf16 a[104:107], a[40:43], v[116:119], a[104:107]
  v_mfma_f32_16x16x32_bf16 a[108:111], a[44:47], v[116:119], a[108:111]
  s_waitcnt vmcnt(7)
  s_cbranch_vccnz L_b505
  s_waitcnt vmcnt(5)
  s_bitcmp0_b32 s77, 31
  s_cbranch_scc1 L_b505
  s_cmp_gt_i32 s80, 124
  s_cbranch_scc0 L_n505
  s_waitcnt vmcnt(3)
L_n505:
  s_waitcnt vmcnt(4)
L_b505:
  buffer_load_dwordx4 v11, s[32:35], s65 offen offset:1024 nt lds
  v_mfma_f32_16x16x32_bf16 a[112:115], a[48:51], v[116:119], a[112:115]
  v_mfma_f32_16x16x32_bf16 a[116:119], a[52:55], v[116:119], a[116:119]
  v_mfma_f32_16x16x32_bf16 a[120:123], a[56:59], v[116:119], a[120:123]
  v_mfma_f32_16x16x32_bf16 a[124:127], a[60:63], v[116:119], a[124:127]
  s_waitcnt vmcnt(6)
  s_cbranch_vccnz L_b506
  s_waitcnt vmcnt(5)
  s_bitcmp0_b32 s77, 31
  s_cbranch_scc1 L_b506
  s_cmp_gt_i32 s80, 124
  s_cbranch_scc0 L_n506
  s_waitcnt vmcnt(3)
L_n506:
  s_waitcnt vmcnt(4)
L_b506:
  buffer_load_dwordx4 v10, s[32:35], s65 offen offset:2048 nt lds
  v_xor_b32 v50, s17, v50
  v_lshrrev_b32 v51, 8, v50
  v_cmp_eq_u32 s[82:83], 0, v51
  v_mov_b32 v51, 120
  s_nop 0
  v_cndmask_b32 v50, v51, v50, s[82:83]
  s_nop 1
  v_add_u32_dpp v50, v50, v50 row_ror:1 row_mask:0xf bank_mask:0xf
  s_nop 1
  v_add_u32_dpp v50, v50, v50 row_ror:2 row_mask:0xf bank_mask:0xf
  s_nop 1
  v_add_u32_dpp v50, v50, v50 row_ror:4 row_mask:0xf bank_mask:0xf
  s_nop 1
  v_add_u32_dpp v50, v50, v50 row_ror:8 row_mask:0xf bank_mask:0xf
  s_nop 0
  v_readlane_b32 s100, v50, 0
  v_readlane_b32 s101, v50, 16
  s_add_u32 s100, s100, s101
  s_sub_i32 s100, s100, 3843
  s_ashr_i32 s37, s100, 1
  s_add_i32 s101, s100, 32
  s_mul_i32 s101, s101, -20
  s_ashr_i32 s101, s101, 8
  s_min_i32 s101, s101, 4
  s_add_i32 s80, s101, 125
  s_max_i32 s80, s80, s3
  s_mul_i32 s100, s100, 24
  s_ashr_i32 s100, s100, 8
  s_min_i32 s100, s100, 8
  s_add_i32 s14, s100, 125
  ds_read_b64_tr_b16 a[32:33], v16 offset:12288
  ds_read_b64_tr_b16 a[36:37], v17 offset:12288
  ds_read_b64_tr_b16 a[40:41], v18 offset:12288
  ds_read_b64_tr_b16 a[44:45], v19 offset:12288
  ds_read_b64_tr_b16 a[48:49], v20 offset:12288
  ds_read_b64_tr_b16 a[52:53], v21 offset:12288
  ds_read_b64_tr_b16 a[56:57], v22 offset:12288
  ds_read_b64_tr_b16 a[60:61], v23 offset:12288
  s_waitcnt vmcnt(6)
  s_cbranch_vccnz L_b507
  s_waitcnt vmcnt(5)
  s_bitcmp0_b32 s77, 31
  s_cbranch_scc1 L_b507
  s_cmp_gt_i32 s80, 124
  s_cbranch_scc0 L_n507
  s_waitcnt vmcnt(3)
L_n507:
  s_waitcnt vmcnt(4)
L_b507:
  buffer_load_dwordx4 v11, s[32:35], s65 offen offset:3072 nt lds
  s_xor_b32 s65, s64, 0xe4000
  s_add_u32 m0, s66, 24576
  s_sub_i32 s77, s36, 126
  s_cmp_gt_i32 s14, 125
  s_cselect_b64 vcc, -1, 0
  s_waitcnt vmcnt(6)
  s_cbranch_vccnz L_b508
  s_waitcnt vmcnt(5)
  s_bitcmp0_b32 s77, 31
  s_cbranch_scc1 L_b508
  s_cmp_gt_i32 s80, 125
  s_cbranch_scc0 L_n508
  s_waitcnt vmcnt(3)
L_n508:
  s_waitcnt vmcnt(4)
L_b508:
  buffer_load_dwordx4 v10, s[32:35], s65 offen offset:0 nt lds
  s_waitcnt vmcnt(6)
  s_cbranch_vccnz L_b509
  s_waitcnt vmcnt(5)
  s_bitcmp0_b32 s77, 31
  s_cbranch_scc1 L_b509
  s_cmp_gt_i32 s80, 125
  s_cbranch_scc0 L_n509
  s_waitcnt vmcnt(3)
L_n509:
  s_waitcnt vmcnt(4)
L_b509:
  buffer_load_dwordx4 v11, s[32:35], s65 offen offset:1024 nt lds
  s_waitcnt vmcnt(6)
  s_cbranch_vccnz L_b510
  s_waitcnt vmcnt(5)
  s_bitcmp0_b32 s77, 31
  s_cbranch_scc1 L_b510
  s_cmp_gt_i32 s80, 125
  s_cbranch_scc0 L_n510
  s_waitcnt vmcnt(3)
L_n510:
  s_waitcnt vmcnt(4)
L_b510:
  buffer_load_dwordx4 v10, s[32:35], s65 offen offset:2048 nt lds
  ds_read_b64_tr_b16 a[34:35], v16 offset:16384
  ds_read_b64_tr_b16 a[38:39], v17 offset:16384
  ds_read_b64_tr_b16 a[42:43], v18 offset:16384
  ds_read_b64_tr_b16 a[46:47], v19 offset:16384
  ds_read_b64_tr_b16 a[50:51], v20 offset:16384
  ds_read_b64_tr_b16 a[54:55], v21 offset:16384
  ds_read_b64_tr_b16 a[58:59], v22 offset:16384
  ds_read_b64_tr_b16 a[62:63], v23 offset:16384
  s_waitcnt vmcnt(6)
  s_cbranch_vccnz L_b511
  s_waitcnt vmcnt(5)
  s_bitcmp0_b32 s77, 31
  s_cbranch_scc1 L_b511
  s_cmp_gt_i32 s80, 125
  s_cbranch_scc0 L_n511
  s_waitcnt vmcnt(3)
L_n511:
  s_waitcnt vmcnt(4)
L_b511:
  buffer_load_dwordx4 v11, s[32:35], s65 offen offset:3072 nt lds
  s_waitcnt lgkmcnt(0)
  v_mfma_f32_16x16x32_bf16 a[96:99], a[32:35], v[120:123], a[96:99]
  v_mfma_f32_16x16x32_bf16 a[100:103], a[36:39], v[120:123], a[100:103]
  v_mfma_f32_16x16x32_bf16 a[104:107], a[40:43], v[120:123], a[104:107]
  v_mfma_f32_16x16x32_bf16 a[108:111], a[44:47], v[120:123], a[108:111]
  s_xor_b32 s65, s64, 0x4e0000
  s_add_u32 m0, s66, 0
  s_sub_i32 s77, s36, 127
  s_cmp_gt_i32 s14, 126
  s_cselect_b64 vcc, -1, 0
  s_waitcnt vmcnt(6)
  s_cbranch_vccnz L_b512
  s_waitcnt vmcnt(5)
  s_bitcmp0_b32 s77, 31
  s_cbranch_scc1 L_b512
  s_cmp_gt_i32 s80, 126
  s_cbranch_scc0 L_n512
  s_waitcnt vmcnt(3)
L_n512:
  s_waitcnt vmcnt(4)
L_b512:
  buffer_load_dwordx4 v10, s[32:35], s65 offen offset:0 nt lds
  v_mfma_f32_16x16x32_bf16 a[112:115], a[48:51], v[120:123], a[112:115]
  v_mfma_f32_16x16x32_bf16 a[116:119], a[52:55], v[120:123], a[116:119]
  v_mfma_f32_16x16x32_bf16 a[120:123], a[56:59], v[120:123], a[120:123]
  v_mfma_f32_16x16x32_bf16 a[124:127], a[60:63], v[120:123], a[124:127]
  s_waitcnt vmcnt(6)
  s_cbranch_vccnz L_b513
  s_waitcnt vmcnt(5)
  s_bitcmp0_b32 s77, 31
  s_cbranch_scc1 L_b513
  s_cmp_gt_i32 s80, 126
  s_cbranch_scc0 L_n513
  s_waitcnt vmcnt(3)
L_n513:
  s_waitcnt vmcnt(4)
L_b513:
  buffer_load_dwordx4 v11, s[32:35], s65 offen offset:1024 nt lds
  s_waitcnt vmcnt(6)
  s_cbranch_vccnz L_b514
  s_waitcnt vmcnt(5)
  s_bitcmp0_b32 s77, 31
  s_cbranch_scc1 L_b514
  s_cmp_gt_i32 s80, 126
  s_cbranch_scc0 L_n514
  s_waitcnt vmcnt(3)
L_n514:
  s_waitcnt vmcnt(4)
L_b514:
  buffer_load_dwordx4 v10, s[32:35], s65 offen offset:2048 nt lds
  ds_read_b64_tr_b16 a[32:33], v16 offset:20480
  ds_read_b64_tr_b16 a[36:37], v17 offset:20480
  ds_read_b64_tr_b16 a[40:41], v18 offset:20480
  ds_read_b64_tr_b16 a[44:45], v19 offset:20480
  ds_read_b64_tr_b16 a[48:49], v20 offset:20480
  ds_read_b64_tr_b16 a[52:53], v21 offset:20480
  ds_read_b64_tr_b16 a[56:57], v22 offset:20480
  ds_read_b64_tr_b16 a[60:61], v23 offset:20480
  s_waitcnt vmcnt(6)
  s_cbranch_vccnz L_b515
  s_waitcnt vmcnt(5)
  s_bitcmp0_b32 s77, 31
  s_cbranch_scc1 L_b515
  s_cmp_gt_i32 s80, 126
  s_cbranch_scc0 L_n515
  s_waitcnt vmcnt(3)
L_n515:
  s_waitcnt vmcnt(4)
L_b515:
  buffer_load_dwordx4 v11, s[32:35], s65 offen offset:3072 nt lds
  s_xor_b32 s65, s64, 0x4e4000
  s_add_u32 m0, s66, 4096
  s_sub_i32 s77, s36, 128
  s_cmp_gt_i32 s14, 127
  s_cselect_b64 vcc, -1, 0
  s_waitcnt vmcnt(6)
  s_cbranch_vccnz L_b516
  s_waitcnt vmcnt(5)
  s_bitcmp0_b32 s77, 31
  s_cbranch_scc1 L_b516
  s_cmp_gt_i32 s80, 127
  s_cbranch_scc0 L_n516
  s_waitcnt vmcnt(3)
L_n516:
  s_waitcnt vmcnt(4)
L_b516:
  buffer_load_dwordx4 v10, s[32:35], s65 offen offset:0 nt lds
  s_waitcnt vmcnt(6)
  s_cbranch_vccnz L_b517
  s_waitcnt vmcnt(5)
  s_bitcmp0_b32 s77, 31
  s_cbranch_scc1 L_b517
  s_cmp_gt_i32 s80, 127
  s_cbranch_scc0 L_n517
  s_waitcnt vmcnt(3)
L_n517:
  s_waitcnt vmcnt(4)
L_b517:
  buffer_load_dwordx4 v11, s[32:35], s65 offen offset:1024 nt lds
  s_waitcnt vmcnt(6)
  s_cbranch_vccnz L_b518
  s_waitcnt vmcnt(5)
  s_bitcmp0_b32 s77, 31
  s_cbranch_scc1 L_b518
  s_cmp_gt_i32 s80, 127
  s_cbranch_scc0 L_n518
  s_waitcnt vmcnt(3)
L_n518:
  s_waitcnt vmcnt(4)
L_b518:
  buffer_load_dwordx4 v10, s[32:35], s65 offen offset:2048 nt lds
  ds_read_b64_tr_b16 a[34:35], v16 offset:24576
  ds_read_b64_tr_b16 a[38:39], v17 offset:24576
  ds_read_b64_tr_b16 a[42:43], v18 offset:24576
  ds_read_b64_tr_b16 a[46:47], v19 offset:24576
  ds_read_b64_tr_b16 a[50:51], v20 offset:24576
  ds_read_b64_tr_b16 a[54:55], v21 offset:24576
  ds_read_b64_tr_b16 a[58:59], v22 offset:24576
  ds_read_b64_tr_b16 a[62:63], v23 offset:24576
  s_waitcnt vmcnt(6)
  s_cbranch_vccnz L_b519
  s_waitcnt vmcnt(5)
  s_bitcmp0_b32 s77, 31
  s_cbranch_scc1 L_b519
  s_cmp_gt_i32 s80, 127
  s_cbranch_scc0 L_n519
  s_waitcnt vmcnt(3)
L_n519:
  s_waitcnt vmcnt(4)
L_b519:
  buffer_load_dwordx4 v11, s[32:35], s65 offen offset:3072 nt lds
  s_waitcnt lgkmcnt(0)
  v_mfma_f32_16x16x32_bf16 a[96:99], a[32:35], v[124:127], a[96:99]
  v_mfma_f32_16x16x32_bf16 a[100:103], a[36:39], v[124:127], a[100:103]
  v_mfma_f32_16x16x32_bf16 a[104:107], a[40:43], v[124:127], a[104:107]
  v_mfma_f32_16x16x32_bf16 a[108:111], a[44:47], v[124:127], a[108:111]
  v_mfma_f32_16x16x32_bf16 a[112:115], a[48:51], v[124:127], a[112:115]
  v_mfma_f32_16x16x32_bf16 a[116:119], a[52:55], v[124:127], a[116:119]
  v_mfma_f32_16x16x32_bf16 a[120:123], a[56:59], v[124:127], a[120:123]
  v_mfma_f32_16x16x32_bf16 a[124:127], a[60:63], v[124:127], a[124:127]
  s_waitcnt vmcnt(4)
  ds_read_b64_tr_b16 a[32:33], v16 offset:0
  ds_read_b64_tr_b16 a[36:37], v17 offset:0
  ds_read_b64_tr_b16 a[40:41], v18 offset:0
  ds_read_b64_tr_b16 a[44:45], v19 offset:0
  ds_read_b64_tr_b16 a[48:49], v20 offset:0
  ds_read_b64_tr_b16 a[52:53], v21 offset:0
  ds_read_b64_tr_b16 a[56:57], v22 offset:0
  ds_read_b64_tr_b16 a[60:61], v23 offset:0
  s_waitcnt vmcnt(0)
  ds_read_b64_tr_b16 a[34:35], v16 offset:4096
  ds_read_b64_tr_b16 a[38:39], v17 offset:4096
  ds_read_b64_tr_b16 a[42:43], v18 offset:4096
  ds_read_b64_tr_b16 a[46:47], v19 offset:4096
  ds_read_b64_tr_b16 a[50:51], v20 offset:4096
  ds_read_b64_tr_b16 a[54:55], v21 offset:4096
  ds_read_b64_tr_b16 a[58:59], v22 offset:4096
  ds_read_b64_tr_b16 a[62:63], v23 offset:4096
  s_add_u32 m0, s67, 0
  s_nop 0
  buffer_load_dwordx4 v29, s[40:43], s78 offen nt lds
  s_add_u32 s78, s78, 8192
  s_add_u32 m0, s67, 1024
  s_nop 0
  buffer_load_dwordx4 v29, s[40:43], s78 offen nt lds
  s_mov_b32 exec_lo, 0x000f000f
  s_mov_b32 exec_hi, 0x000f000f
  s_waitcnt lgkmcnt(7)
  v_mfma_f32_16x16x32_bf16 a[96:99], a[32:35], v[128:131], a[96:99]
  s_waitcnt lgkmcnt(6)
  v_mfma_f32_16x16x32_bf16 a[100:103], a[36:39], v[128:131], a[100:103]
  s_waitcnt lgkmcnt(5)
  v_mfma_f32_16x16x32_bf16 a[104:107], a[40:43], v[128:131], a[104:107]
  s_waitcnt lgkmcnt(4)
  v_mfma_f32_16x16x32_bf16 a[108:111], a[44:47], v[128:131], a[108:111]
  s_waitcnt lgkmcnt(3)
  v_mfma_f32_16x16x32_bf16 a[112:115], a[48:51], v[128:131], a[112:115]
  ds_write_b128 v36, a[96:99] offset:8192
  s_waitcnt lgkmcnt(3)
  v_mfma_f32_16x16x32_bf16 a[116:119], a[52:55], v[128:131], a[116:119]
  ds_write_b128 v36, a[100:103] offset:8256
  s_waitcnt lgkmcnt(3)
  v_mfma_f32_16x16x32_bf16 a[120:123], a[56:59], v[128:131], a[120:123]
  ds_write_b128 v36, a[104:107] offset:8320
  s_waitcnt lgkmcnt(3)
  v_mfma_f32_16x16x32_bf16 a[124:127], a[60:63], v[128:131], a[124:127]
  ds_write_b128 v36, a[108:111] offset:8384
  ds_write_b128 v36, a[112:115] offset:8448
  ds_write_b128 v36, a[116:119] offset:8512
  s_nop 1
  ds_write_b128 v36, a[120:123] offset:8576
  s_nop 1
  ds_write_b128 v36, a[124:127] offset:8640
  s_mov_b32 exec_lo, -1
  s_mov_b32 exec_hi, 0
  s_waitcnt lgkmcnt(0)
  s_barrier
  ds_read_b128 v[140:143], v39 offset:8192
  ds_read_b128 v[144:147], v39 offset:36864
  ds_read_b128 v[148:151], v40 offset:8192
  ds_read_b128 v[152:155], v40 offset:36864
  s_waitcnt lgkmcnt(3)
  v_mul_f32 v140, s52, v140
  v_mul_f32 v141, s52, v141
  v_mul_f32 v142, s52, v142
  v_mul_f32 v143, s52, v143
  s_waitcnt lgkmcnt(2)
  v_fmac_f32 v140, s53, v144
  v_fmac_f32 v141, s53, v145
  v_fmac_f32 v142, s53, v146
  v_fmac_f32 v143, s53, v147
  s_waitcnt lgkmcnt(1)
  v_fmac_f32 v140, s54, v148
  v_fmac_f32 v141, s54, v149
  v_fmac_f32 v142, s54, v150
  v_fmac_f32 v143, s54, v151
  s_waitcnt lgkmcnt(0)
  v_fmac_f32 v140, s55, v152
  v_fmac_f32 v141, s55, v153
  v_fmac_f32 v142, s55, v154
  v_fmac_f32 v143, s55, v155
  v_add_u32 v140, 0x10000, v140
  v_add_u32 v141, 0x10000, v141
  v_add_u32 v142, 0x10000, v142
  v_add_u32 v143, 0x10000, v143
  v_perm_b32 v164, v141, v140, s4
  v_perm_b32 v165, v143, v142, s4
  v_and_or_b32 v164, v164, s11, v168
  v_and_or_b32 v165, v165, s11, v169
  buffer_store_dwordx4 v[164:167], v42, s[44:47], s5 offen sc1
  s_mov_b64 exec, -1
  s_cmp_ge_u32 s12, 32
  s_cbranch_scc1 L_nowarm
  s_mov_b32 exec_lo, 0x01010101
  s_mov_b32 exec_hi, 0x01010101
  buffer_load_dword v180, v42, s[44:47], s8 offen offset:0 sc1
  buffer_load_dword v180, v42, s[44:47], s8 offen offset:1024 sc1
  buffer_load_dword v180, v42, s[44:47], s8 offen offset:2048 sc1
  buffer_load_dword v180, v42, s[44:47], s8 offen offset:3072 sc1
  s_mov_b64 exec, -1
L_nowarm:
  s_add_u32 s78, s78, 8192
  s_add_u32 m0, s67, 2048
  s_nop 0
  buffer_load_dwordx4 v29, s[40:43], s78 offen nt lds
  s_add_u32 s78, s78, 8192
  s_add_u32 m0, s67, 3072
  s_nop 0
  buffer_load_dwordx4 v29, s[40:43], s78 offen nt lds
  s_add_u32 s78, s78, 8192
  s_add_u32 m0, s67, 4096
  s_nop 0
  buffer_load_dwordx4 v29, s[40:43], s78 offen nt lds
  s_add_u32 s78, s78, 8192
  s_add_u32 m0, s67, 5120
  s_nop 0
  buffer_load_dwordx4 v29, s[40:43], s78 offen nt lds
  s_add_u32 s78, s78, 8192
  s_add_u32 m0, s67, 6144
  s_nop 0
  buffer_load_dwordx4 v29, s[40:43], s78 offen nt lds
  s_add_u32 s78, s78, 8192
  s_add_u32 m0, s67, 7168
  s_nop 0
  buffer_load_dwordx4 v29, s[40:43], s78 offen nt lds
  s_waitcnt vmcnt(4)
  buffer_load_dwordx4 v[140:143], v43, s[44:47], s6 offen offset:0 sc1
  buffer_load_dwordx4 v[144:147], v43, s[44:47], s6 offen offset:512 sc1
  buffer_load_dwordx4 v[148:151], v43, s[44:47], s6 offen offset:1024 sc1
  buffer_load_dwordx4 v[152:155], v43, s[44:47], s6 offen offset:1536 sc1
  s_waitcnt vmcnt(4)
  s_barrier
  ds_read_b64_tr_b16 a[64:65], v49 offset:0
  ds_read_b64_tr_b16 a[66:67], v49 offset:2048
  ds_read_b64_tr_b16 a[68:69], v49 offset:4096
  ds_read_b64_tr_b16 a[70:71], v49 offset:6144
  ds_read_b64_tr_b16 a[72:73], v49 offset:8192
  ds_read_b64_tr_b16 a[74:75], v49 offset:10240
  ds_read_b64_tr_b16 a[76:77], v49 offset:12288
  ds_read_b64_tr_b16 a[78:79], v49 offset:14336
  ds_read_b64_tr_b16 a[80:81], v49 offset:16384
  ds_read_b64_tr_b16 a[82:83], v49 offset:18432
  ds_read_b64_tr_b16 a[84:85], v49 offset:20480
  ds_read_b64_tr_b16 a[86:87], v49 offset:22528
  ds_read_b64_tr_b16 a[88:89], v49 offset:24576
  ds_read_b64_tr_b16 a[90:91], v49 offset:26624
  ds_read_b64_tr_b16 a[92:93], v49 offset:28672
  ds_read_b64_tr_b16 a[94:95], v49 offset:30720
  s_branch L_h1wait
L_h1poll:
  buffer_load_dwordx4 v[140:143], v43, s[44:47], s6 offen offset:0 sc1
  buffer_load_dwordx4 v[144:147], v43, s[44:47], s6 offen offset:512 sc1
  buffer_load_dwordx4 v[148:151], v43, s[44:47], s6 offen offset:1024 sc1
  buffer_load_dwordx4 v[152:155], v43, s[44:47], s6 offen offset:1536 sc1
  s_sub_u32 s79, s79, 1
  s_cbranch_scc1 L_end
L_h1wait:
  s_waitcnt vmcnt(3)
  v_xor_b32 v140, v168, v140
  v_xor_b32 v141, v169, v141
  v_xor_b32 v142, v170, v142
  v_xor_b32 v143, v171, v143
  v_or_b32 v132, v140, v141
  v_or3_b32 v132, v132, v142, v143
  v_mfma_f32_16x16x32_bf16 v[60:63], v[172:175], v[140:143], 0
  s_waitcnt vmcnt(2)
  v_xor_b32 v144, v168, v144
  v_xor_b32 v145, v169, v145
  v_xor_b32 v146, v170, v146
  v_xor_b32 v147, v171, v147
  v_or3_b32 v132, v132, v144, v145
  v_or3_b32 v132, v132, v146, v147
  v_mfma_f32_16x16x32_bf16 v[60:63], v[172:175], v[144:147], v[60:63]
  s_waitcnt vmcnt(1)
  v_xor_b32 v148, v168, v148
  v_xor_b32 v149, v169, v149
  v_xor_b32 v150, v170, v150
  v_xor_b32 v151, v171, v151
  v_or3_b32 v132, v132, v148, v149
  v_or3_b32 v132, v132, v150, v151
  v_mfma_f32_16x16x32_bf16 v[60:63], v[172:175], v[148:151], v[60:63]
  s_waitcnt vmcnt(0)
  v_xor_b32 v152, v168, v152
  v_xor_b32 v153, v169, v153
  v_xor_b32 v154, v170, v154
  v_xor_b32 v155, v171, v155
  v_or3_b32 v132, v132, v152, v153
  v_or3_b32 v132, v132, v154, v155
  v_mfma_f32_16x16x32_bf16 v[60:63], v[172:175], v[152:155], v[60:63]
  v_and_b32 v132, 0x00010001, v132
  v_cmp_ne_u32 vcc, 0, v132
  s_cbranch_vccnz L_h1poll
  s_mov_b32 exec_hi, 0
  s_nop 3
  v_cvt_pk_bf16_f32 v132, v60, v61
  v_cvt_pk_bf16_f32 v133, v62, v63
  ds_write_b64 v44, v[132:133]
  s_mov_b64 exec, -1
  s_waitcnt lgkmcnt(0)
  s_barrier
  ds_read_b128 v[68:71], v45 offset:0
  ds_read_b128 v[72:75], v45 offset:64
  ds_read_b128 v[76:79], v45 offset:128
  ds_read_b128 v[80:83], v45 offset:192
  ds_read_b128 v[84:87], v45 offset:512
  ds_read_b128 v[88:91], v45 offset:576
  ds_read_b128 v[92:95], v45 offset:640
  ds_read_b128 v[96:99], v45 offset:704
  v_mov_b32 v134, s70
  s_add_u32 s75, s7, 131072
  s_waitcnt lgkmcnt(7)
  v_mfma_f32_16x16x32_bf16 v[64:67], a[64:67], v[68:71], 0
  s_waitcnt lgkmcnt(6)
  v_mfma_f32_16x16x32_bf16 v[64:67], a[68:71], v[72:75], v[64:67]
  s_waitcnt lgkmcnt(5)
  v_mfma_f32_16x16x32_bf16 v[64:67], a[72:75], v[76:79], v[64:67]
  s_waitcnt lgkmcnt(4)
  v_mfma_f32_16x16x32_bf16 v[64:67], a[76:79], v[80:83], v[64:67]
  s_waitcnt lgkmcnt(3)
  v_mfma_f32_16x16x32_bf16 v[64:67], a[80:83], v[84:87], v[64:67]
  s_waitcnt lgkmcnt(2)
  v_mfma_f32_16x16x32_bf16 v[64:67], a[84:87], v[88:91], v[64:67]
  s_waitcnt lgkmcnt(1)
  v_mfma_f32_16x16x32_bf16 v[64:67], a[88:91], v[92:95], v[64:67]
  s_waitcnt lgkmcnt(0)
  v_mfma_f32_16x16x32_bf16 v[64:67], a[92:95], v[96:99], v[64:67]
  s_mov_b32 exec_lo, 0x00030003
  s_mov_b32 exec_hi, 0x00030003
  s_cmp_ge_u32 s12, 32
  s_nop 4
  v_add_u32 v64, 0x800, v64
  v_add_u32 v65, 0x800, v65
  v_add_u32 v66, 0x800, v66
  v_add_u32 v67, 0x800, v67
  v_and_or_b32 v64, v64, s81, v134
  v_and_or_b32 v65, v65, s81, v134
  v_and_or_b32 v66, v66, s81, v134
  v_and_or_b32 v67, v67, s81, v134
  buffer_store_dwordx4 v[64:67], v46, s[44:47], s7 offen
  s_cbranch_scc0 L_final
  buffer_store_dwordx4 v[64:67], v46, s[44:47], s75 offen sc1
  s_endpgm
L_final:
  s_mov_b64 exec, -1
  s_lshl_b32 s73, s12, 5
  s_mov_b32 s13, 20
L_h2poll:
  buffer_load_dwordx4 v[140:143], v42, s[44:47], s8 offen offset:0 sc1
  buffer_load_dwordx4 v[144:147], v42, s[44:47], s8 offen offset:1024 sc1
  buffer_load_dwordx4 v[148:151], v42, s[44:47], s8 offen offset:2048 sc1
  buffer_load_dwordx4 v[152:155], v42, s[44:47], s8 offen offset:3072 sc1
  s_sub_u32 s79, s79, 1
  s_cbranch_scc1 L_end
  s_sub_u32 s13, s13, 1
  s_cbranch_scc1 L_h2switch
L_h2wait:
  s_waitcnt vmcnt(3)
  v_xor_b32 v140, s70, v140
  v_xor_b32 v141, s70, v141
  v_xor_b32 v142, s70, v142
  v_xor_b32 v143, s70, v143
  v_or_b32 v132, v140, v141
  v_or3_b32 v132, v132, v142, v143
  s_waitcnt vmcnt(2)
  v_xor_b32 v144, s70, v144
  v_xor_b32 v145, s70, v145
  v_xor_b32 v146, s70, v146
  v_xor_b32 v147, s70, v147
  v_or3_b32 v132, v132, v144, v145
  v_or3_b32 v132, v132, v146, v147
  v_add_f32 v140, v140, v144
  v_add_f32 v141, v141, v145
  v_add_f32 v142, v142, v146
  v_add_f32 v143, v143, v147
  s_waitcnt vmcnt(1)
  v_xor_b32 v148, s70, v148
  v_xor_b32 v149, s70, v149
  v_xor_b32 v150, s70, v150
  v_xor_b32 v151, s70, v151
  v_or3_b32 v132, v132, v148, v149
  v_or3_b32 v132, v132, v150, v151
  v_add_f32 v140, v140, v148
  v_add_f32 v141, v141, v149
  v_add_f32 v142, v142, v150
  v_add_f32 v143, v143, v151
  s_waitcnt vmcnt(0)
  v_xor_b32 v152, s70, v152
  v_xor_b32 v153, s70, v153
  v_xor_b32 v154, s70, v154
  v_xor_b32 v155, s70, v155
  v_or3_b32 v132, v132, v152, v153
  v_or3_b32 v132, v132, v154, v155
  v_add_f32 v140, v140, v152
  v_add_f32 v141, v141, v153
  v_add_f32 v142, v142, v154
  v_add_f32 v143, v143, v155
  v_and_b32 v132, 0xfff, v132
  v_cmp_ne_u32 vcc, 0, v132
  s_cbranch_vccnz L_h2poll
  v_permlane32_swap_b32 v140, v141
  v_permlane32_swap_b32 v142, v143
  v_add_f32 v140, v140, v141
  v_add_f32 v142, v142, v143
  s_nop 1
  v_permlane16_swap_b32 v140, v142
  v_add_f32 v140, v140, v142
  s_nop 1
  v_add_f32_dpp v140, v140, v140 row_ror:8 row_mask:0xf bank_mask:0xf
  v_cvt_pk_bf16_f32 v140, v140, v140
  s_mov_b32 exec_lo, 0x00ff00ff
  s_mov_b32 exec_hi, 0x00ff00ff
  buffer_store_short v140, v48, s[56:59], s73 offen
  s_cmp_lg_u32 s12, 0
  s_cbranch_scc1 L_fin
  s_mov_b64 exec, 1
  v_mov_b32 v132, s68
  v_mov_b32 v133, 0
  buffer_store_dword v132, v133, s[44:47], 0 offen offset:0 sc1
L_fin:
L_end:
  s_endpgm
L_h2switch:
  s_waitcnt vmcnt(0)
  s_mov_b32 exec_lo, 0x00030003
  s_mov_b32 exec_hi, 0x00030003
  buffer_store_dwordx4 v[64:67], v46, s[44:47], s75 offen sc1
  s_mov_b64 exec, -1
  s_add_u32 s8, s8, 131072
  s_waitcnt vmcnt(0)
  s_branch L_h2poll
L_lretry:
  s_sub_u32 s79, s79, 1
  s_cbranch_scc1 L_end
  buffer_load_dwordx2 v[140:141], v47, s[44:47], s10 offen sc1
  s_waitcnt vmcnt(0)
  s_branch L_lcheck
L_qretry:
  s_sub_u32 s79, s79, 1
  s_cbranch_scc1 L_end
  buffer_load_dwordx4 v[140:143], v30, s[44:47], s3 offen sc1
  s_waitcnt vmcnt(0)
  s_branch L_qcheck
.section .rodata,"a"
.p2align 6
.amdhsa_kernel gated_mix__gqa_block_cached__gqa_block_cached__decode_kernel
  .amdhsa_next_free_vgpr 408
  .amdhsa_next_free_sgpr 102
  .amdhsa_accum_offset 196
  .amdhsa_group_segment_fixed_size 0
  .amdhsa_kernarg_size 112
  .amdhsa_user_sgpr_count 2
  .amdhsa_user_sgpr_kernarg_segment_ptr 1
  .amdhsa_system_sgpr_workgroup_id_x 1
  .amdhsa_float_denorm_mode_32 3
.end_amdhsa_kernel
```
